```python
import torch

def _softmax(x, axis=-1):
    return torch.softmax(x, dim=axis)
def _gelu(x):
    return torch.nn.functional.gelu(x, approximate="tanh")
def _silu(x):
    return torch.nn.functional.silu(x)
def _sigmoid(x):
    return torch.sigmoid(x)
def _layernorm(x, axis=-1, eps=1e-5):
    m = x.mean(dim=axis, keepdim=True)
    v = x.var(dim=axis, keepdim=True, unbiased=False)
    return (x - m) / torch.sqrt(v + eps)
def _scatter_add(tgt, idx, src, axis=0):
    return tgt.clone().index_add_(axis, idx, src)
def _segment_sum(src, seg, n):
    out = torch.zeros((n,) + src.shape[1:], dtype=src.dtype)
    return out.index_add_(0, seg, src)
def _pad(x, pw):
    flat = tuple(v for pair in reversed(pw) for v in pair)
    return torch.nn.functional.pad(x, flat)

kernel_name = 'standalone__mha_block_cached__near_ridge'

def setup_inputs():

    _w = (lambda a: (lambda t: t.to(torch.bfloat16) if t.is_floating_point() else t)(torch.as_tensor(a)))
    B, Sq, D = 16, 144, 512
    H, Sk, Dh = 32, 512, 128
    return {
        "x": _w((lambda *s: torch.randn(*s, dtype=torch.bfloat16) * 0.8)(B, Sq, D)),
        "k_cache": _w((lambda *s: torch.randn(*s, dtype=torch.bfloat16) * 0.8)(B, H, Sk, Dh)),
        "v_cache": _w((lambda *s: torch.randn(*s, dtype=torch.bfloat16) * 0.05)(B, H, Sk, Dh)),
        "wq": _w((lambda *s: torch.randn(*s, dtype=torch.bfloat16) * 0.8)(D, H * Dh) * (D ** -0.5)),
        "wo": _w((lambda *s: torch.randn(*s, dtype=torch.bfloat16) * 0.05)(H * Dh, D) * ((H * Dh) ** -0.5)),
    }

def reference(x, k_cache, v_cache, wq, wo):
    B, Sq, D = x.shape
    H, Dh = 32, 128
    q = (lambda x, *d: x.permute(*d))((x @ wq).reshape(B, Sq, H, Dh), 0, 2, 1, 3)
    scores = torch.einsum("bhqd,bhkd->bhqk", q, k_cache) * (Dh ** -0.5)
    p = _softmax(scores, axis=-1)
    o = torch.einsum("bhqk,bhkd->bhqd", p, v_cache)
    return (lambda x, *d: x.permute(*d))(o, 0, 2, 1, 3).reshape(B, Sq, H * Dh) @ wo
```

```asm
; @launch grid=(256,1,1) block=(256,1,1) lds=163840
.amdgcn_target "amdgcn-amd-amdhsa--gfx950"
.text
.globl standalone__mha_block_cached__near_ridge_kernel
.p2align 12
.p2align 8
.type standalone__mha_block_cached__near_ridge_kernel,@function
standalone__mha_block_cached__near_ridge_kernel:
s_cmp_ge_u32 s2, 256
s_cbranch_scc1 Lend
s_load_dwordx16 s[4:19], s[0:1], 0
v_lshrrev_b32 v1, 6, v0
s_bfe_u32 s62, s2, 196611
v_lshrrev_b32 v3, 2, v0
v_lshl_add_u32 v3, v3, 3, s62
v_lshlrev_b32 v8, 7, v3
s_getpc_b64 s[52:53]
Lpc1:
v_min_u32 v8, Lcode_end-Lpc1-4, v8
v_mov_b32 v9, 0
v_lshl_add_u64 v[8:9], v[8:9], 0, s[52:53]
global_load_dword v253, v[8:9], off
v_readfirstlane_b32 s3, v1
v_mov_b32 v2, 0xff800000
s_mov_b32 s54, 0
v_accvgpr_write_b32 a248, v2
v_accvgpr_write_b32 a249, v2
v_accvgpr_write_b32 a250, v2
v_accvgpr_write_b32 a251, v2
v_accvgpr_write_b32 a252, v2
Lrestart:
v_mbcnt_lo_u32_b32 v0, -1, 0
v_mbcnt_hi_u32_b32 v0, -1, v0
s_and_b32 s52, s2, 1
s_bfe_u32 s53, s2, 196611
s_lshl3_add_u32 s50, s52, s53
s_bfe_u32 s52, s2, 131073
s_lshr_b32 s53, s2, 6
s_lshl2_add_u32 s51, s52, s53
s_lshr_b32 s48, s3, 1
s_and_b32 s49, s3, 1
s_mul_i32 s44, s3, 4224
s_mul_i32 s55, s3, 1056
s_add_u32 s56, s50, s51
s_lshl_b32 s52, s56, 1
s_and_b32 s52, s52, 2
s_lshl_b32 s96, s52, 8
s_lshl_b32 s97, s52, 20
v_and_b32 v1, 7, v0
v_lshlrev_b32 v1, 4, v1
v_lshrrev_b32 v2, 3, v0
v_lshl_add_u32 v3, v2, 12, v1
s_lshl_b32 s52, s3, 15
s_add_u32 s52, s52, 128
v_add_u32 v229, s52, v3
v_subrev_u32 v230, 32, v229
v_subrev_u32 v231, 64, v229
v_subrev_u32 v232, 96, v229
v_and_b32 v4, 3, v2
v_lshl_add_u32 v3, v4, 12, v1
v_lshrrev_b32 v2, 5, v0
v_lshl_add_u32 v3, v2, 7, v3
s_lshl_b32 s52, s3, 10
s_add_u32 s52, s52, 131200
v_add_u32 v233, s52, v3
v_lshl_add_u32 v3, v4, 16, v1
v_lshl_add_u32 v3, v2, 15, v3
s_lshl_b32 s52, s49, 18
s_lshl_b32 s53, s48, 8
s_add_u32 s52, s52, s53
v_add_u32 v225, s52, v3
v_add_u32 v226, 7136, v225
v_add_u32 v227, 14272, v225
v_add_u32 v228, 21408, v225
s_mov_b32 s22, 147584
s_mov_b32 s23, 0x20000
s_mov_b32 s27, 0x20000
s_mul_i32 s62, s50, 147456
s_lshl_b32 s53, s51, 9
s_sub_u32 s26, 4194304, s53
s_waitcnt lgkmcnt(0)
s_add_u32 s20, s4, s62
s_addc_u32 s21, s5, 0
s_sub_u32 s20, s20, 128
s_subb_u32 s21, s21, 0
s_add_u32 s24, s10, s53
s_addc_u32 s25, s11, 0
s_add_u32 m0, s44, 34048
s_add_u32 s45, s96, 0
s_and_b32 s45, s45, 1023
buffer_load_dwordx4 v229, s[20:23], s45 offen offset:0 lds
buffer_load_dwordx4 v230, s[20:23], s45 offen offset:1056 lds
buffer_load_dwordx4 v231, s[20:23], s45 offen offset:2112 lds
buffer_load_dwordx4 v232, s[20:23], s45 offen offset:3168 lds
s_add_u32 m0, s55, 153216
s_add_u32 s45, s96, 0
s_and_b32 s45, s45, 1023
buffer_load_dwordx4 v233, s[20:23], s45 offen offset:0 lds
s_add_u32 m0, s44, 85120
s_add_u32 s45, s97, 0
s_and_b32 s45, s45, 4194303
buffer_load_dwordx4 v225, s[24:27], s45 offen offset:0 lds
buffer_load_dwordx4 v226, s[24:27], s45 offen offset:1056 lds
buffer_load_dwordx4 v227, s[24:27], s45 offen offset:2112 lds
buffer_load_dwordx4 v228, s[24:27], s45 offen offset:3168 lds
s_add_u32 m0, s44, 51072
s_add_u32 s45, s97, 128
s_and_b32 s45, s45, 4194303
buffer_load_dwordx4 v225, s[24:27], s45 offen offset:0 lds
buffer_load_dwordx4 v226, s[24:27], s45 offen offset:1056 lds
buffer_load_dwordx4 v227, s[24:27], s45 offen offset:2112 lds
buffer_load_dwordx4 v228, s[24:27], s45 offen offset:3168 lds
s_lshl4_add_u32 s53, s50, s51
s_lshl_b32 s52, s53, 18
s_add_u32 s28, s6, s52
s_addc_u32 s29, s7, 0
s_sub_u32 s28, s28, 128
s_subb_u32 s29, s29, 0
s_mov_b32 s30, 262272
s_mov_b32 s31, 0x20000
s_add_u32 s32, s8, s52
s_addc_u32 s33, s9, 0
s_sub_u32 s32, s32, 128
s_subb_u32 s33, s33, 0
s_mov_b32 s34, 262272
s_mov_b32 s35, 0x20000
s_mul_i32 s52, s53, 147456
s_add_u32 s40, s18, s52
s_addc_u32 s41, s19, 0
s_mov_b32 s42, 147456
s_mov_b32 s43, 0x20000
s_lshl_b32 s52, s51, 18
s_add_u32 s36, s12, s52
s_addc_u32 s37, s13, 0
s_sub_u32 s36, s36, 128
s_subb_u32 s37, s37, 0
s_mov_b32 s38, 262272
s_mov_b32 s39, 0x20000
s_add_u32 s12, s14, s62
s_addc_u32 s13, s15, 0
s_mov_b32 s14, 147456
s_mov_b32 s15, 0x20000
s_lshl_b32 s52, s62, 4
s_add_u32 s8, s18, s52
s_addc_u32 s9, s19, 0
s_mov_b32 s10, 2359296
s_mov_b32 s11, 0x20000
s_lshl_b32 s52, s50, 15
s_add_u32 s52, s52, 37748736
s_add_u32 s4, s18, s52
s_addc_u32 s5, s19, 0
s_mov_b32 s6, 32768
s_mov_b32 s7, 0x20000
s_mov_b32 s18, 256
s_mov_b32 s19, 0x20000
s_mov_b32 s46, 0x3e0293ee
s_bitcmp1_b32 s50, 1
s_cselect_b64 vcc, -1, 0
s_lshr_b32 s56, s51, 2
s_lshl_b32 s52, s50, 0
s_sub_u32 s56, s56, s52
s_add_u32 s52, s56, 1
s_and_b32 s52, s52, 3
s_lshl_b32 s98, s52, 8
s_add_u32 s52, s56, 2
s_and_b32 s52, s52, 3
s_lshl_b32 s99, s52, 8
s_add_u32 s52, s56, 3
s_and_b32 s52, s52, 3
s_lshl_b32 s100, s52, 8
s_add_u32 s52, s56, 0
s_and_b32 s52, s52, 3
s_lshl_b32 s101, s52, 8
s_and_b32 s52, s56, 3
s_and_b32 s53, s51, 3
s_lshl2_add_u32 s56, s52, s53
v_and_b32 v1, 15, v0
v_lshlrev_b32 v1, 4, v1
v_lshrrev_b32 v5, 4, v0
s_add_u32 s52, s3, 0
s_lshl4_add_u32 s63, s52, s50
s_lshl_b32 s63, s63, 4
s_lshl_b32 s52, s54, 6
s_add_u32 s52, s52, s3
s_lshl_b32 s52, s52, 9
v_lshl_add_u32 v6, v0, 3, s52
s_lshl_b32 s45, s56, 11
v_mov_b64 v[8:9], 0
buffer_store_dwordx2 v[8:9], v6, s[4:7], s45 offen offset:0 sc1
v_lshl_add_u32 v3, v5, 13, v1
s_lshl_b32 s52, s48, 15
s_lshl_b32 s53, s49, 12
s_add_u32 s52, s52, s53
s_add_u32 s52, s52, 128
v_add_u32 v3, s52, v3
v_accvgpr_write_b32 a254, v3
v_lshlrev_b32 v252, 4, v0
s_lshl_b32 s52, s48, 17
s_lshl_b32 s53, s49, 12
s_add_u32 s52, s52, s53
s_add_u32 s52, s52, 128
v_add_u32 v244, s52, v252
v_accvgpr_write_b32 a255, v244
v_subrev_u32 v245, 32, v244
v_subrev_u32 v246, 64, v244
v_subrev_u32 v247, 96, v244
s_xor_b32 s52, s3, 1
s_mul_i32 s47, s52, 4224
s_add_u32 s59, s44, 136192
s_add_u32 s60, s47, 136192
v_add_u32 v234, s59, v252
v_add_u32 v235, s60, v252
v_and_b32 v1, 3, v0
v_mul_u32_u24 v1, 1056, v1
v_lshl_add_u32 v1, v5, 4, v1
v_bfe_u32 v3, v0, 2, 2
v_lshl_add_u32 v3, v3, 7, v1
v_add_u32 v222, 153216, v3
s_mul_i32 s52, s49, 8448
v_add_u32 v220, s52, v3
v_add_u32 v221, 119168, v220
v_bfe_u32 v3, v0, 2, 1
v_mul_u32_u24 v3, 17024, v3
v_add_u32 v1, v1, v3
v_bfe_u32 v3, v0, 3, 1
v_lshl_add_u32 v1, v3, 8, v1
s_lshl_b32 s52, s49, 6
s_xor_b32 s53, s52, 64
v_add_u32 v3, s52, v1
v_add_u32 v6, s53, v1
v_add_u32 v236, s44, v3
v_add_u32 v237, s44, v6
v_add_u32 v238, s47, v3
v_add_u32 v239, s47, v6
v_bfe_u32 v1, v0, 2, 2
v_mul_u32_u24 v1, 1056, v1
v_and_b32 v3, 1, v0
v_lshl_add_u32 v6, v3, 4, v1
v_bfe_u32 v3, v0, 1, 1
v_lshl_add_u32 v6, v3, 3, v6
v_lshl_add_u32 v3, v5, 7, v6
s_mul_i32 s62, s48, 8448
s_add_u32 s62, s62, 17024
v_add_u32 v3, s62, v3
v_add_u32 v216, s52, v3
v_add_u32 v217, s53, v3
v_add_u32 v218, 68096, v216
v_add_u32 v219, 68096, v217
v_and_b32 v4, 1, v5
v_lshl_add_u32 v6, v2, 8, v6
v_mul_u32_u24 v3, 4224, v4
v_add_u32 v6, v6, v3
s_lshl_b32 s62, s3, 6
v_add_u32 v6, s62, v6
v_accvgpr_write_b32 a253, v6
v_lshl_add_u32 v1, v2, 8, v1
v_and_b32 v3, 3, v0
v_lshl_add_u32 v1, v3, 3, v1
v_mul_u32_u24 v3, 17024, v4
v_add_u32 v1, v1, v3
v_add_u32 v1, 68096, v1
s_lshl_b32 s52, s52, 1
s_lshl_b32 s53, s53, 1
v_add_u32 v3, s52, v1
v_add_u32 v6, s53, v1
v_add_u32 v240, s44, v3
v_add_u32 v241, s44, v6
v_add_u32 v242, s47, v3
v_add_u32 v243, s47, v6
s_and_b32 s47, s48, 1
s_lshl_b32 s47, s47, 13
s_lshl1_add_u32 s62, s49, s48
s_lshl_b32 s62, s62, 12
s_add_u32 s62, s62, 102144
s_lshl4_add_u32 s57, s52, s62
s_lshl4_add_u32 s58, s53, s62
v_mov_b32 v223, 0
v_mov_b32 v224, 0
v_mov_b32 v1, 0x3f803f80
v_accvgpr_write_b32 a196, v1
v_accvgpr_write_b32 a197, v1
v_accvgpr_write_b32 a198, v1
v_accvgpr_write_b32 a199, v1
s_cmp_eq_u32 s3, 0
s_cbranch_scc1 Lisl1_0
s_cmp_eq_u32 s3, 1
s_cbranch_scc1 Lisl2_0
s_cmp_eq_u32 s3, 2
s_cbranch_scc1 Lisl3_0
Lret0:
s_branch Lpage0
.p2alignl 12, 0xbf810000
Lpage0:
s_waitcnt vmcnt(5)
s_barrier
ds_read_b64_tr_b16 a[96:97], v218 offset:0
ds_read_b64_tr_b16 a[98:99], v218 offset:512
ds_read_b64_tr_b16 a[100:101], v218 offset:4224
ds_read_b64_tr_b16 a[102:103], v218 offset:4736
ds_read_b128 a[128:131], v220 offset:34048
ds_read_b128 a[144:147], v220 offset:34112
ds_read_b128 a[132:135], v220 offset:34560
ds_read_b128 a[148:151], v220 offset:34624
ds_read_b128 a[136:139], v220 offset:38272
ds_read_b128 a[152:155], v220 offset:38336
s_waitcnt lgkmcnt(5)
v_mfma_f32_16x16x32_bf16 v[0:3], a[96:99], a[128:131], 0
s_waitcnt lgkmcnt(4)
ds_read_b128 a[140:143], v220 offset:38784
ds_read_b128 a[156:159], v220 offset:38848
s_add_u32 m0, s44, 119168
v_mfma_f32_16x16x32_bf16 v[0:3], a[100:103], a[144:147], v[0:3]
s_waitcnt lgkmcnt(5)
ds_read_b128 a[232:235], v222 offset:0
ds_read_b128 a[236:239], v222 offset:64
s_add_u32 s45, s96, 128
s_and_b32 s45, s45, 1023
buffer_load_dwordx4 v229, s[20:23], s45 offen offset:0 lds
v_mfma_f32_16x16x32_bf16 v[32:35], a[96:99], a[132:135], 0
s_waitcnt lgkmcnt(6)
buffer_load_dwordx4 v230, s[20:23], s45 offen offset:1056 lds
ds_read_b64_tr_b16 a[104:105], v218 offset:32
v_mfma_f32_16x16x32_bf16 v[32:35], a[100:103], a[148:151], v[32:35]
s_waitcnt lgkmcnt(6)
buffer_load_dwordx4 v231, s[20:23], s45 offen offset:2112 lds
ds_read_b64_tr_b16 a[106:107], v218 offset:544
v_mfma_f32_16x16x32_bf16 v[64:67], a[96:99], a[136:139], 0
s_waitcnt lgkmcnt(6)
buffer_load_dwordx4 v232, s[20:23], s45 offen offset:3168 lds
ds_read_b64_tr_b16 a[108:109], v218 offset:4256
s_add_u32 m0, s44, 102144
s_add_u32 s45, s97, 524288
v_mfma_f32_16x16x32_bf16 v[64:67], a[100:103], a[152:155], v[64:67]
s_waitcnt lgkmcnt(6)
ds_read_b64_tr_b16 a[110:111], v218 offset:4768
ds_read_b64_tr_b16 a[112:113], v219 offset:0
s_and_b32 s45, s45, 4194303
buffer_load_dwordx4 v225, s[24:27], s45 offen offset:0 lds
v_mfma_f32_16x16x32_bf16 v[96:99], a[96:99], a[140:143], 0
s_waitcnt lgkmcnt(7)
buffer_load_dwordx4 v226, s[24:27], s45 offen offset:1056 lds
ds_read_b64_tr_b16 a[114:115], v219 offset:512
v_mfma_f32_16x16x32_bf16 v[96:99], a[100:103], a[156:159], v[96:99]
s_waitcnt lgkmcnt(7)
ds_read_b64_tr_b16 a[116:117], v219 offset:4224
ds_read_b64_tr_b16 a[118:119], v219 offset:4736
ds_read_b64_tr_b16 a[120:121], v219 offset:32
ds_read_b64_tr_b16 a[122:123], v219 offset:544
ds_read_b64_tr_b16 a[124:125], v219 offset:4256
ds_read_b64_tr_b16 a[126:127], v219 offset:4768
buffer_load_dwordx4 v227, s[24:27], s45 offen offset:2112 lds
v_mfma_f32_16x16x32_bf16 v[192:195], a[96:99], a[232:235], 0
s_waitcnt lgkmcnt(12)
buffer_load_dwordx4 v228, s[24:27], s45 offen offset:3168 lds
v_mfma_f32_16x16x32_bf16 v[192:195], a[100:103], a[236:239], v[192:195]
s_waitcnt lgkmcnt(10)
s_add_u32 m0, s44, 136192
s_add_u32 s45, s97, 524416
v_mfma_f32_16x16x32_bf16 v[4:7], a[104:107], a[128:131], 0
s_waitcnt lgkmcnt(8)
s_and_b32 s45, s45, 4194303
buffer_load_dwordx4 v225, s[24:27], s45 offen offset:0 lds
v_mfma_f32_16x16x32_bf16 v[4:7], a[108:111], a[144:147], v[4:7]
v_mfma_f32_16x16x32_bf16 v[36:39], a[104:107], a[132:135], 0
buffer_load_dwordx4 v226, s[24:27], s45 offen offset:1056 lds
v_mfma_f32_16x16x32_bf16 v[36:39], a[108:111], a[148:151], v[36:39]
v_mfma_f32_16x16x32_bf16 v[68:71], a[104:107], a[136:139], 0
buffer_load_dwordx4 v227, s[24:27], s45 offen offset:2112 lds
s_waitcnt vmcnt(12) lgkmcnt(0)
s_barrier
v_mfma_f32_16x16x32_bf16 v[68:71], a[108:111], a[152:155], v[68:71]
ds_read_b64_tr_b16 a[96:97], v216 offset:34048
v_mfma_f32_16x16x32_bf16 v[100:103], a[104:107], a[140:143], 0
buffer_load_dwordx4 v228, s[24:27], s45 offen offset:3168 lds
v_mfma_f32_16x16x32_bf16 v[100:103], a[108:111], a[156:159], v[100:103]
s_add_u32 m0, s44, 0
ds_read_b64_tr_b16 a[98:99], v216 offset:34560
s_add_u32 s45, s96, 256
v_mfma_f32_16x16x32_bf16 v[196:199], a[104:107], a[232:235], 0
s_and_b32 s45, s45, 1023
buffer_load_dwordx4 v229, s[20:23], s45 offen offset:0 lds
v_mfma_f32_16x16x32_bf16 v[196:199], a[108:111], a[236:239], v[196:199]
ds_read_b64_tr_b16 a[100:101], v216 offset:38272
v_mfma_f32_16x16x32_bf16 v[8:11], a[112:115], a[128:131], 0
ds_read_b64_tr_b16 a[102:103], v216 offset:38784
v_mfma_f32_16x16x32_bf16 v[8:11], a[116:119], a[144:147], v[8:11]
buffer_load_dwordx4 v230, s[20:23], s45 offen offset:1056 lds
v_mfma_f32_16x16x32_bf16 v[40:43], a[112:115], a[132:135], 0
ds_read_b64_tr_b16 a[104:105], v216 offset:34080
v_mfma_f32_16x16x32_bf16 v[40:43], a[116:119], a[148:151], v[40:43]
ds_read_b64_tr_b16 a[106:107], v216 offset:34592
v_mfma_f32_16x16x32_bf16 v[72:75], a[112:115], a[136:139], 0
ds_read_b64_tr_b16 a[108:109], v216 offset:38304
v_mfma_f32_16x16x32_bf16 v[72:75], a[116:119], a[152:155], v[72:75]
ds_read_b64_tr_b16 a[110:111], v216 offset:38816
v_mfma_f32_16x16x32_bf16 v[104:107], a[112:115], a[140:143], 0
buffer_load_dwordx4 v231, s[20:23], s45 offen offset:2112 lds
v_mfma_f32_16x16x32_bf16 v[104:107], a[116:119], a[156:159], v[104:107]
ds_read_b64_tr_b16 a[112:113], v217 offset:34048
v_mfma_f32_16x16x32_bf16 v[12:15], a[120:123], a[128:131], 0
ds_read_b64_tr_b16 a[114:115], v217 offset:34560
v_mfma_f32_16x16x32_bf16 v[12:15], a[124:127], a[144:147], v[12:15]
ds_read_b64_tr_b16 a[116:117], v217 offset:38272
v_mfma_f32_16x16x32_bf16 v[44:47], a[120:123], a[132:135], 0
ds_read_b64_tr_b16 a[118:119], v217 offset:38784
v_mfma_f32_16x16x32_bf16 v[44:47], a[124:127], a[148:151], v[44:47]
buffer_load_dwordx4 v232, s[20:23], s45 offen offset:3168 lds
v_mfma_f32_16x16x32_bf16 v[76:79], a[120:123], a[136:139], 0
v_mfma_f32_16x16x32_bf16 v[76:79], a[124:127], a[152:155], v[76:79]
v_mfma_f32_16x16x32_bf16 v[108:111], a[120:123], a[140:143], 0
s_add_u32 m0, s55, 157440
ds_read_b64_tr_b16 a[120:121], v217 offset:34080
s_add_u32 s45, s96, 256
v_mfma_f32_16x16x32_bf16 v[108:111], a[124:127], a[156:159], v[108:111]
s_waitcnt lgkmcnt(3)
ds_read_b64_tr_b16 a[122:123], v217 offset:34592
s_and_b32 s45, s45, 1023
v_mfma_f32_16x16x32_bf16 v[16:19], a[96:99], a[128:131], 0
ds_read_b64_tr_b16 a[124:125], v217 offset:38304
v_mfma_f32_16x16x32_bf16 v[16:19], a[100:103], a[144:147], v[16:19]
ds_read_b64_tr_b16 a[126:127], v217 offset:38816
v_mfma_f32_16x16x32_bf16 v[48:51], a[96:99], a[132:135], 0
buffer_load_dwordx4 v233, s[20:23], s45 offen offset:0 lds
v_mfma_f32_16x16x32_bf16 v[48:51], a[100:103], a[148:151], v[48:51]
s_add_u32 m0, s44, 17024
s_add_u32 s45, s97, 1048576
s_and_b32 s45, s45, 4194303
v_mfma_f32_16x16x32_bf16 v[80:83], a[96:99], a[136:139], 0
v_mfma_f32_16x16x32_bf16 v[80:83], a[100:103], a[152:155], v[80:83]
v_mfma_f32_16x16x32_bf16 v[112:115], a[96:99], a[140:143], 0
buffer_load_dwordx4 v225, s[24:27], s45 offen offset:0 lds
v_mfma_f32_16x16x32_bf16 v[112:115], a[100:103], a[156:159], v[112:115]
v_mfma_f32_16x16x32_bf16 v[200:203], a[96:99], a[232:235], 0
v_mfma_f32_16x16x32_bf16 v[200:203], a[100:103], a[236:239], v[200:203]
s_waitcnt vmcnt(10) lgkmcnt(0)
s_barrier
ds_read_b128 a[200:203], v221 offset:0
v_mfma_f32_16x16x32_bf16 v[20:23], a[104:107], a[128:131], 0
ds_read_b64_tr_b16 a[96:97], v218 offset:17024
v_mfma_f32_16x16x32_bf16 v[20:23], a[108:111], a[144:147], v[20:23]
buffer_load_dwordx4 v226, s[24:27], s45 offen offset:1056 lds
v_mfma_f32_16x16x32_bf16 v[52:55], a[104:107], a[132:135], 0
ds_read_b64_tr_b16 a[98:99], v218 offset:17536
v_mfma_f32_16x16x32_bf16 v[52:55], a[108:111], a[148:151], v[52:55]
ds_read_b128 a[216:219], v221 offset:64
v_mfma_f32_16x16x32_bf16 v[84:87], a[104:107], a[136:139], 0
ds_read_b64_tr_b16 a[100:101], v218 offset:21248
v_mfma_f32_16x16x32_bf16 v[84:87], a[108:111], a[152:155], v[84:87]
ds_read_b64_tr_b16 a[102:103], v218 offset:21760
v_mfma_f32_16x16x32_bf16 v[116:119], a[104:107], a[140:143], 0
ds_read_b128 a[204:207], v221 offset:512
v_mfma_f32_16x16x32_bf16 v[116:119], a[108:111], a[156:159], v[116:119]
buffer_load_dwordx4 v227, s[24:27], s45 offen offset:2112 lds
v_mfma_f32_16x16x32_bf16 v[204:207], a[104:107], a[232:235], 0
ds_read_b128 a[220:223], v221 offset:576
v_mfma_f32_16x16x32_bf16 v[204:207], a[108:111], a[236:239], v[204:207]
ds_read_b128 a[208:211], v221 offset:4224
v_mfma_f32_16x16x32_bf16 v[24:27], a[112:115], a[128:131], 0
ds_read_b128 a[224:227], v221 offset:4288
v_mfma_f32_16x16x32_bf16 v[24:27], a[116:119], a[144:147], v[24:27]
ds_read_b128 a[212:215], v221 offset:4736
v_mfma_f32_16x16x32_bf16 v[56:59], a[112:115], a[132:135], 0
buffer_load_dwordx4 v228, s[24:27], s45 offen offset:3168 lds
v_mfma_f32_16x16x32_bf16 v[56:59], a[116:119], a[148:151], v[56:59]
ds_read_b128 a[228:231], v221 offset:4800
v_mfma_f32_16x16x32_bf16 v[88:91], a[112:115], a[136:139], 0
s_add_u32 m0, s44, 68096
ds_read_b128 a[240:243], v222 offset:512
s_add_u32 s45, s97, 1048704
v_mfma_f32_16x16x32_bf16 v[88:91], a[116:119], a[152:155], v[88:91]
s_and_b32 s45, s45, 4194303
ds_read_b128 a[244:247], v222 offset:576
v_mfma_f32_16x16x32_bf16 v[120:123], a[112:115], a[140:143], 0
ds_read_b64_tr_b16 a[104:105], v218 offset:17056
v_mfma_f32_16x16x32_bf16 v[120:123], a[116:119], a[156:159], v[120:123]
buffer_load_dwordx4 v225, s[24:27], s45 offen offset:0 lds
v_mfma_f32_16x16x32_bf16 v[28:31], a[120:123], a[128:131], 0
ds_read_b64_tr_b16 a[106:107], v218 offset:17568
v_mfma_f32_16x16x32_bf16 v[28:31], a[124:127], a[144:147], v[28:31]
ds_read_b64_tr_b16 a[108:109], v218 offset:21280
v_mfma_f32_16x16x32_bf16 v[60:63], a[120:123], a[132:135], 0
ds_read_b64_tr_b16 a[110:111], v218 offset:21792
v_mfma_f32_16x16x32_bf16 v[60:63], a[124:127], a[148:151], v[60:63]
ds_read_b64_tr_b16 a[112:113], v219 offset:17024
v_mfma_f32_16x16x32_bf16 v[92:95], a[120:123], a[136:139], 0
buffer_load_dwordx4 v226, s[24:27], s45 offen offset:1056 lds
v_mfma_f32_16x16x32_bf16 v[92:95], a[124:127], a[152:155], v[92:95]
ds_read_b64_tr_b16 a[114:115], v219 offset:17536
v_mfma_f32_16x16x32_bf16 v[124:127], a[120:123], a[140:143], 0
ds_read_b64_tr_b16 a[116:117], v219 offset:21248
v_mfma_f32_16x16x32_bf16 v[124:127], a[124:127], a[156:159], v[124:127]
s_waitcnt lgkmcnt(5)
ds_read_b64_tr_b16 a[118:119], v219 offset:21760
v_mfma_f32_16x16x32_bf16 v[0:3], a[96:99], a[200:203], v[0:3]
ds_read_b64_tr_b16 a[120:121], v219 offset:17056
v_mfma_f32_16x16x32_bf16 v[0:3], a[100:103], a[216:219], v[0:3]
ds_read_b64_tr_b16 a[122:123], v219 offset:17568
v_mfma_f32_16x16x32_bf16 v[32:35], a[96:99], a[204:207], v[32:35]
ds_read_b64_tr_b16 a[124:125], v219 offset:21280
v_mfma_f32_16x16x32_bf16 v[32:35], a[100:103], a[220:223], v[32:35]
ds_read_b64_tr_b16 a[126:127], v219 offset:21792
v_mfma_f32_16x16x32_bf16 v[64:67], a[96:99], a[208:211], v[64:67]
buffer_load_dwordx4 v227, s[24:27], s45 offen offset:2112 lds
v_mfma_f32_16x16x32_bf16 v[64:67], a[100:103], a[224:227], v[64:67]
v_mfma_f32_16x16x32_bf16 v[96:99], a[96:99], a[212:215], v[96:99]
v_mfma_f32_16x16x32_bf16 v[96:99], a[100:103], a[228:231], v[96:99]
buffer_load_dwordx4 v228, s[24:27], s45 offen offset:3168 lds
v_mfma_f32_16x16x32_bf16 v[192:195], a[96:99], a[240:243], v[192:195]
v_mfma_f32_16x16x32_bf16 v[192:195], a[100:103], a[244:247], v[192:195]
s_add_u32 m0, s44, 34048
s_waitcnt vmcnt(13) lgkmcnt(0)
s_barrier
v_mfma_f32_16x16x32_bf16 v[4:7], a[104:107], a[200:203], v[4:7]
s_add_u32 s45, s96, 384
ds_read_b64_tr_b16 a[96:97], v218 offset:51072
s_and_b32 s45, s45, 1023
v_mfma_f32_16x16x32_bf16 v[4:7], a[108:111], a[216:219], v[4:7]
ds_read_b64_tr_b16 a[98:99], v218 offset:51584
v_mfma_f32_16x16x32_bf16 v[36:39], a[104:107], a[204:207], v[36:39]
buffer_load_dwordx4 v229, s[20:23], s45 offen offset:0 lds
v_mfma_f32_16x16x32_bf16 v[36:39], a[108:111], a[220:223], v[36:39]
ds_read_b64_tr_b16 a[100:101], v218 offset:55296
v_mfma_f32_16x16x32_bf16 v[68:71], a[104:107], a[208:211], v[68:71]
ds_read_b64_tr_b16 a[102:103], v218 offset:55808
v_mfma_f32_16x16x32_bf16 v[68:71], a[108:111], a[224:227], v[68:71]
v_mfma_f32_16x16x32_bf16 v[100:103], a[104:107], a[212:215], v[100:103]
v_mfma_f32_16x16x32_bf16 v[100:103], a[108:111], a[228:231], v[100:103]
v_mfma_f32_16x16x32_bf16 v[196:199], a[104:107], a[240:243], v[196:199]
buffer_load_dwordx4 v230, s[20:23], s45 offen offset:1056 lds
v_mfma_f32_16x16x32_bf16 v[196:199], a[108:111], a[244:247], v[196:199]
ds_read_b64_tr_b16 a[104:105], v218 offset:51104
v_mfma_f32_16x16x32_bf16 v[8:11], a[112:115], a[200:203], v[8:11]
ds_read_b64_tr_b16 a[106:107], v218 offset:51616
v_mfma_f32_16x16x32_bf16 v[8:11], a[116:119], a[216:219], v[8:11]
ds_read_b64_tr_b16 a[108:109], v218 offset:55328
v_mfma_f32_16x16x32_bf16 v[40:43], a[112:115], a[204:207], v[40:43]
ds_read_b64_tr_b16 a[110:111], v218 offset:55840
v_mfma_f32_16x16x32_bf16 v[40:43], a[116:119], a[220:223], v[40:43]
buffer_load_dwordx4 v231, s[20:23], s45 offen offset:2112 lds
v_mfma_f32_16x16x32_bf16 v[72:75], a[112:115], a[208:211], v[72:75]
v_mfma_f32_16x16x32_bf16 v[72:75], a[116:119], a[224:227], v[72:75]
v_mfma_f32_16x16x32_bf16 v[104:107], a[112:115], a[212:215], v[104:107]
ds_read_b64_tr_b16 a[112:113], v219 offset:51072
v_mfma_f32_16x16x32_bf16 v[104:107], a[116:119], a[228:231], v[104:107]
ds_read_b64_tr_b16 a[114:115], v219 offset:51584
v_mfma_f32_16x16x32_bf16 v[12:15], a[120:123], a[200:203], v[12:15]
buffer_load_dwordx4 v232, s[20:23], s45 offen offset:3168 lds
v_mfma_f32_16x16x32_bf16 v[12:15], a[124:127], a[216:219], v[12:15]
ds_read_b64_tr_b16 a[116:117], v219 offset:55296
v_mfma_f32_16x16x32_bf16 v[44:47], a[120:123], a[204:207], v[44:47]
ds_read_b64_tr_b16 a[118:119], v219 offset:55808
v_mfma_f32_16x16x32_bf16 v[44:47], a[124:127], a[220:223], v[44:47]
s_bfe_u32 s52, s50, 65537
s_lshl_b32 s52, s52, 24
s_lshl_b32 s53, s49, 12
v_mfma_f32_16x16x32_bf16 v[76:79], a[120:123], a[208:211], v[76:79]
s_add_u32 s52, s52, s53
v_mul_u32_u24 v254, 7, v252
v_accvgpr_read_b32 v255, a255
v_mfma_f32_16x16x32_bf16 v[76:79], a[124:127], a[224:227], v[76:79]
v_add3_u32 v254, v254, v255, s52
v_mfma_f32_16x16x32_bf16 v[108:111], a[120:123], a[212:215], v[108:111]
ds_read_b64_tr_b16 a[120:121], v219 offset:51104
ds_read_b64_tr_b16 a[122:123], v219 offset:51616
v_mfma_f32_16x16x32_bf16 v[108:111], a[124:127], a[228:231], v[108:111]
s_waitcnt lgkmcnt(4)
ds_read_b64_tr_b16 a[124:125], v219 offset:55328
v_mfma_f32_16x16x32_bf16 v[16:19], a[96:99], a[200:203], v[16:19]
ds_read_b64_tr_b16 a[126:127], v219 offset:55840
v_mfma_f32_16x16x32_bf16 v[16:19], a[100:103], a[216:219], v[16:19]
buffer_load_dword v253, v254, s[28:31], 0 offen
v_mfma_f32_16x16x32_bf16 v[48:51], a[96:99], a[204:207], v[48:51]
v_mfma_f32_16x16x32_bf16 v[48:51], a[100:103], a[220:223], v[48:51]
buffer_load_dword v253, v254, s[32:35], 0 offen
s_add_u32 m0, s44, 85120
s_add_u32 s45, s97, 1572864
s_and_b32 s45, s45, 4194303
buffer_load_dwordx4 v225, s[24:27], s45 offen offset:0 lds
v_mfma_f32_16x16x32_bf16 v[80:83], a[96:99], a[208:211], v[80:83]
v_mfma_f32_16x16x32_bf16 v[80:83], a[100:103], a[224:227], v[80:83]
buffer_load_dwordx4 v226, s[24:27], s45 offen offset:1056 lds
v_mfma_f32_16x16x32_bf16 v[112:115], a[96:99], a[212:215], v[112:115]
v_mfma_f32_16x16x32_bf16 v[112:115], a[100:103], a[228:231], v[112:115]
v_mfma_f32_16x16x32_bf16 v[200:203], a[96:99], a[240:243], v[200:203]
buffer_load_dwordx4 v227, s[24:27], s45 offen offset:2112 lds
v_mfma_f32_16x16x32_bf16 v[200:203], a[100:103], a[244:247], v[200:203]
s_waitcnt vmcnt(13) lgkmcnt(0)
s_barrier
ds_read_b128 a[128:131], v220 offset:0
v_mfma_f32_16x16x32_bf16 v[20:23], a[104:107], a[200:203], v[20:23]
ds_read_b64_tr_b16 a[96:97], v216 offset:0
v_mfma_f32_16x16x32_bf16 v[20:23], a[108:111], a[216:219], v[20:23]
ds_read_b64_tr_b16 a[98:99], v216 offset:512
v_mfma_f32_16x16x32_bf16 v[52:55], a[104:107], a[204:207], v[52:55]
ds_read_b128 a[144:147], v220 offset:64
v_mfma_f32_16x16x32_bf16 v[52:55], a[108:111], a[220:223], v[52:55]
buffer_load_dwordx4 v228, s[24:27], s45 offen offset:3168 lds
v_mfma_f32_16x16x32_bf16 v[84:87], a[104:107], a[208:211], v[84:87]
ds_read_b64_tr_b16 a[100:101], v216 offset:4224
v_mfma_f32_16x16x32_bf16 v[84:87], a[108:111], a[224:227], v[84:87]
ds_read_b64_tr_b16 a[102:103], v216 offset:4736
v_mfma_f32_16x16x32_bf16 v[116:119], a[104:107], a[212:215], v[116:119]
s_add_u32 m0, s44, 51072
ds_read_b128 a[132:135], v220 offset:512
s_add_u32 s45, s97, 1572992
v_mfma_f32_16x16x32_bf16 v[116:119], a[108:111], a[228:231], v[116:119]
s_and_b32 s45, s45, 4194303
ds_read_b128 a[148:151], v220 offset:576
v_mfma_f32_16x16x32_bf16 v[204:207], a[104:107], a[240:243], v[204:207]
ds_read_b128 a[136:139], v220 offset:4224
v_mfma_f32_16x16x32_bf16 v[204:207], a[108:111], a[244:247], v[204:207]
buffer_load_dwordx4 v225, s[24:27], s45 offen offset:0 lds
v_mfma_f32_16x16x32_bf16 v[24:27], a[112:115], a[200:203], v[24:27]
ds_read_b128 a[152:155], v220 offset:4288
v_mfma_f32_16x16x32_bf16 v[24:27], a[116:119], a[216:219], v[24:27]
ds_read_b128 a[140:143], v220 offset:4736
v_mfma_f32_16x16x32_bf16 v[56:59], a[112:115], a[204:207], v[56:59]
ds_read_b128 a[156:159], v220 offset:4800
v_mfma_f32_16x16x32_bf16 v[56:59], a[116:119], a[220:223], v[56:59]
ds_read_b128 a[232:235], v222 offset:4224
v_mfma_f32_16x16x32_bf16 v[88:91], a[112:115], a[208:211], v[88:91]
buffer_load_dwordx4 v226, s[24:27], s45 offen offset:1056 lds
v_mfma_f32_16x16x32_bf16 v[88:91], a[116:119], a[224:227], v[88:91]
ds_read_b128 a[236:239], v222 offset:4288
v_mfma_f32_16x16x32_bf16 v[120:123], a[112:115], a[212:215], v[120:123]
ds_read_b64_tr_b16 a[104:105], v216 offset:32
v_mfma_f32_16x16x32_bf16 v[120:123], a[116:119], a[228:231], v[120:123]
ds_read_b64_tr_b16 a[106:107], v216 offset:544
v_mfma_f32_16x16x32_bf16 v[28:31], a[120:123], a[200:203], v[28:31]
ds_read_b64_tr_b16 a[108:109], v216 offset:4256
v_mfma_f32_16x16x32_bf16 v[28:31], a[124:127], a[216:219], v[28:31]
buffer_load_dwordx4 v227, s[24:27], s45 offen offset:2112 lds
v_mfma_f32_16x16x32_bf16 v[60:63], a[120:123], a[204:207], v[60:63]
ds_read_b64_tr_b16 a[110:111], v216 offset:4768
v_mfma_f32_16x16x32_bf16 v[60:63], a[124:127], a[220:223], v[60:63]
ds_read_b64_tr_b16 a[112:113], v217 offset:0
v_mfma_f32_16x16x32_bf16 v[92:95], a[120:123], a[208:211], v[92:95]
ds_read_b64_tr_b16 a[114:115], v217 offset:512
v_mfma_f32_16x16x32_bf16 v[92:95], a[124:127], a[224:227], v[92:95]
ds_read_b64_tr_b16 a[116:117], v217 offset:4224
v_mfma_f32_16x16x32_bf16 v[124:127], a[120:123], a[212:215], v[124:127]
ds_read_b64_tr_b16 a[118:119], v217 offset:4736
v_mfma_f32_16x16x32_bf16 v[124:127], a[124:127], a[228:231], v[124:127]
s_waitcnt lgkmcnt(5)
ds_read_b64_tr_b16 a[120:121], v217 offset:32
v_mfma_f32_16x16x32_bf16 v[0:3], a[96:99], a[128:131], v[0:3]
ds_read_b64_tr_b16 a[122:123], v217 offset:544
v_mfma_f32_16x16x32_bf16 v[0:3], a[100:103], a[144:147], v[0:3]
ds_read_b64_tr_b16 a[124:125], v217 offset:4256
v_mfma_f32_16x16x32_bf16 v[32:35], a[96:99], a[132:135], v[32:35]
ds_read_b64_tr_b16 a[126:127], v217 offset:4768
v_mfma_f32_16x16x32_bf16 v[32:35], a[100:103], a[148:151], v[32:35]
buffer_load_dwordx4 v228, s[24:27], s45 offen offset:3168 lds
v_mfma_f32_16x16x32_bf16 v[64:67], a[96:99], a[136:139], v[64:67]
s_add_u32 m0, s44, 119168
s_add_u32 s45, s96, 512
s_and_b32 s45, s45, 1023
v_mfma_f32_16x16x32_bf16 v[64:67], a[100:103], a[152:155], v[64:67]
buffer_load_dwordx4 v229, s[20:23], s45 offen offset:0 lds
v_mfma_f32_16x16x32_bf16 v[96:99], a[96:99], a[140:143], v[96:99]
v_mfma_f32_16x16x32_bf16 v[96:99], a[100:103], a[156:159], v[96:99]
v_mfma_f32_16x16x32_bf16 v[192:195], a[96:99], a[232:235], v[192:195]
v_mfma_f32_16x16x32_bf16 v[192:195], a[100:103], a[236:239], v[192:195]
s_waitcnt vmcnt(15) lgkmcnt(0)
s_barrier
ds_read_b64_tr_b16 a[96:97], v216 offset:51072
v_mfma_f32_16x16x32_bf16 v[4:7], a[104:107], a[128:131], v[4:7]
buffer_load_dwordx4 v230, s[20:23], s45 offen offset:1056 lds
v_mfma_f32_16x16x32_bf16 v[4:7], a[108:111], a[144:147], v[4:7]
ds_read_b64_tr_b16 a[98:99], v216 offset:51584
v_mfma_f32_16x16x32_bf16 v[36:39], a[104:107], a[132:135], v[36:39]
ds_read_b64_tr_b16 a[100:101], v216 offset:55296
v_mfma_f32_16x16x32_bf16 v[36:39], a[108:111], a[148:151], v[36:39]
ds_read_b64_tr_b16 a[102:103], v216 offset:55808
v_mfma_f32_16x16x32_bf16 v[68:71], a[104:107], a[136:139], v[68:71]
v_mfma_f32_16x16x32_bf16 v[68:71], a[108:111], a[152:155], v[68:71]
buffer_load_dwordx4 v231, s[20:23], s45 offen offset:2112 lds
v_mfma_f32_16x16x32_bf16 v[100:103], a[104:107], a[140:143], v[100:103]
v_mfma_f32_16x16x32_bf16 v[100:103], a[108:111], a[156:159], v[100:103]
v_mfma_f32_16x16x32_bf16 v[196:199], a[104:107], a[232:235], v[196:199]
ds_read_b64_tr_b16 a[104:105], v216 offset:51104
v_mfma_f32_16x16x32_bf16 v[196:199], a[108:111], a[236:239], v[196:199]
ds_read_b64_tr_b16 a[106:107], v216 offset:51616
v_mfma_f32_16x16x32_bf16 v[8:11], a[112:115], a[128:131], v[8:11]
buffer_load_dwordx4 v232, s[20:23], s45 offen offset:3168 lds
v_mfma_f32_16x16x32_bf16 v[8:11], a[116:119], a[144:147], v[8:11]
ds_read_b64_tr_b16 a[108:109], v216 offset:55328
v_mfma_f32_16x16x32_bf16 v[40:43], a[112:115], a[132:135], v[40:43]
s_add_u32 m0, s55, 153216
ds_read_b64_tr_b16 a[110:111], v216 offset:55840
s_add_u32 s45, s96, 512
v_mfma_f32_16x16x32_bf16 v[40:43], a[116:119], a[148:151], v[40:43]
s_and_b32 s45, s45, 1023
v_mfma_f32_16x16x32_bf16 v[72:75], a[112:115], a[136:139], v[72:75]
v_mfma_f32_16x16x32_bf16 v[72:75], a[116:119], a[152:155], v[72:75]
buffer_load_dwordx4 v233, s[20:23], s45 offen offset:0 lds
v_mfma_f32_16x16x32_bf16 v[104:107], a[112:115], a[140:143], v[104:107]
ds_read_b64_tr_b16 a[112:113], v217 offset:51072
v_mfma_f32_16x16x32_bf16 v[104:107], a[116:119], a[156:159], v[104:107]
ds_read_b64_tr_b16 a[114:115], v217 offset:51584
v_mfma_f32_16x16x32_bf16 v[12:15], a[120:123], a[128:131], v[12:15]
s_add_u32 m0, s44, 102144
ds_read_b64_tr_b16 a[116:117], v217 offset:55296
s_add_u32 s45, s97, 2097152
v_mfma_f32_16x16x32_bf16 v[12:15], a[124:127], a[144:147], v[12:15]
s_and_b32 s45, s45, 4194303
ds_read_b64_tr_b16 a[118:119], v217 offset:55808
v_mfma_f32_16x16x32_bf16 v[44:47], a[120:123], a[132:135], v[44:47]
v_mfma_f32_16x16x32_bf16 v[44:47], a[124:127], a[148:151], v[44:47]
buffer_load_dwordx4 v225, s[24:27], s45 offen offset:0 lds
v_mfma_f32_16x16x32_bf16 v[76:79], a[120:123], a[136:139], v[76:79]
v_mfma_f32_16x16x32_bf16 v[76:79], a[124:127], a[152:155], v[76:79]
v_mfma_f32_16x16x32_bf16 v[108:111], a[120:123], a[140:143], v[108:111]
ds_read_b64_tr_b16 a[120:121], v217 offset:51104
v_mfma_f32_16x16x32_bf16 v[108:111], a[124:127], a[156:159], v[108:111]
s_waitcnt lgkmcnt(2)
ds_read_b64_tr_b16 a[122:123], v217 offset:51616
v_mfma_f32_16x16x32_bf16 v[16:19], a[96:99], a[128:131], v[16:19]
ds_read_b64_tr_b16 a[124:125], v217 offset:55328
v_mfma_f32_16x16x32_bf16 v[16:19], a[100:103], a[144:147], v[16:19]
ds_read_b64_tr_b16 a[126:127], v217 offset:55840
v_mfma_f32_16x16x32_bf16 v[48:51], a[96:99], a[132:135], v[48:51]
buffer_load_dwordx4 v226, s[24:27], s45 offen offset:1056 lds
v_mfma_f32_16x16x32_bf16 v[48:51], a[100:103], a[148:151], v[48:51]
v_mfma_f32_16x16x32_bf16 v[80:83], a[96:99], a[136:139], v[80:83]
v_mfma_f32_16x16x32_bf16 v[80:83], a[100:103], a[152:155], v[80:83]
buffer_load_dwordx4 v227, s[24:27], s45 offen offset:2112 lds
v_mfma_f32_16x16x32_bf16 v[112:115], a[96:99], a[140:143], v[112:115]
v_mfma_f32_16x16x32_bf16 v[112:115], a[100:103], a[156:159], v[112:115]
v_mfma_f32_16x16x32_bf16 v[200:203], a[96:99], a[232:235], v[200:203]
v_mfma_f32_16x16x32_bf16 v[200:203], a[100:103], a[236:239], v[200:203]
s_waitcnt vmcnt(12) lgkmcnt(0)
s_barrier
ds_read_b128 a[200:203], v220 offset:34048
v_mfma_f32_16x16x32_bf16 v[20:23], a[104:107], a[128:131], v[20:23]
buffer_load_dwordx4 v228, s[24:27], s45 offen offset:3168 lds
v_mfma_f32_16x16x32_bf16 v[20:23], a[108:111], a[144:147], v[20:23]
ds_read_b64_tr_b16 a[96:97], v218 offset:0
ds_read_b64_tr_b16 a[98:99], v218 offset:512
v_mfma_f32_16x16x32_bf16 v[52:55], a[104:107], a[132:135], v[52:55]
ds_read_b128 a[216:219], v220 offset:34112
v_mfma_f32_16x16x32_bf16 v[52:55], a[108:111], a[148:151], v[52:55]
s_add_u32 m0, s44, 136192
ds_read_b64_tr_b16 a[100:101], v218 offset:4224
s_add_u32 s45, s97, 2097280
v_mfma_f32_16x16x32_bf16 v[84:87], a[104:107], a[136:139], v[84:87]
s_and_b32 s45, s45, 4194303
ds_read_b64_tr_b16 a[102:103], v218 offset:4736
v_mfma_f32_16x16x32_bf16 v[84:87], a[108:111], a[152:155], v[84:87]
ds_read_b128 a[204:207], v220 offset:34560
v_mfma_f32_16x16x32_bf16 v[116:119], a[104:107], a[140:143], v[116:119]
buffer_load_dwordx4 v225, s[24:27], s45 offen offset:0 lds
v_mfma_f32_16x16x32_bf16 v[116:119], a[108:111], a[156:159], v[116:119]
ds_read_b128 a[220:223], v220 offset:34624
v_mfma_f32_16x16x32_bf16 v[204:207], a[104:107], a[232:235], v[204:207]
ds_read_b128 a[208:211], v220 offset:38272
v_mfma_f32_16x16x32_bf16 v[204:207], a[108:111], a[236:239], v[204:207]
ds_read_b128 a[224:227], v220 offset:38336
v_mfma_f32_16x16x32_bf16 v[24:27], a[112:115], a[128:131], v[24:27]
buffer_load_dwordx4 v226, s[24:27], s45 offen offset:1056 lds
v_mfma_f32_16x16x32_bf16 v[24:27], a[116:119], a[144:147], v[24:27]
ds_read_b128 a[212:215], v220 offset:38784
v_mfma_f32_16x16x32_bf16 v[56:59], a[112:115], a[132:135], v[56:59]
ds_read_b128 a[228:231], v220 offset:38848
v_mfma_f32_16x16x32_bf16 v[56:59], a[116:119], a[148:151], v[56:59]
ds_read_b128 a[240:243], v222 offset:4736
v_mfma_f32_16x16x32_bf16 v[88:91], a[112:115], a[136:139], v[88:91]
buffer_load_dwordx4 v227, s[24:27], s45 offen offset:2112 lds
v_mfma_f32_16x16x32_bf16 v[88:91], a[116:119], a[152:155], v[88:91]
ds_read_b128 a[244:247], v222 offset:4800
v_mfma_f32_16x16x32_bf16 v[120:123], a[112:115], a[140:143], v[120:123]
ds_read_b64_tr_b16 a[104:105], v218 offset:32
v_mfma_f32_16x16x32_bf16 v[120:123], a[116:119], a[156:159], v[120:123]
ds_read_b64_tr_b16 a[106:107], v218 offset:544
v_mfma_f32_16x16x32_bf16 v[28:31], a[120:123], a[128:131], v[28:31]
buffer_load_dwordx4 v228, s[24:27], s45 offen offset:3168 lds
v_mfma_f32_16x16x32_bf16 v[28:31], a[124:127], a[144:147], v[28:31]
ds_read_b64_tr_b16 a[108:109], v218 offset:4256
v_mfma_f32_16x16x32_bf16 v[60:63], a[120:123], a[132:135], v[60:63]
s_add_u32 m0, s44, 0
ds_read_b64_tr_b16 a[110:111], v218 offset:4768
s_add_u32 s45, s96, 640
v_mfma_f32_16x16x32_bf16 v[60:63], a[124:127], a[148:151], v[60:63]
s_and_b32 s45, s45, 1023
ds_read_b64_tr_b16 a[112:113], v219 offset:0
v_mfma_f32_16x16x32_bf16 v[92:95], a[120:123], a[136:139], v[92:95]
ds_read_b64_tr_b16 a[114:115], v219 offset:512
v_mfma_f32_16x16x32_bf16 v[92:95], a[124:127], a[152:155], v[92:95]
buffer_load_dwordx4 v229, s[20:23], s45 offen offset:0 lds
v_mfma_f32_16x16x32_bf16 v[124:127], a[120:123], a[140:143], v[124:127]
ds_read_b64_tr_b16 a[116:117], v219 offset:4224
v_mfma_f32_16x16x32_bf16 v[124:127], a[124:127], a[156:159], v[124:127]
s_waitcnt lgkmcnt(5)
ds_read_b64_tr_b16 a[118:119], v219 offset:4736
v_mfma_f32_16x16x32_bf16 v[0:3], a[96:99], a[200:203], v[0:3]
ds_read_b64_tr_b16 a[120:121], v219 offset:32
v_mfma_f32_16x16x32_bf16 v[0:3], a[100:103], a[216:219], v[0:3]
ds_read_b64_tr_b16 a[122:123], v219 offset:544
v_mfma_f32_16x16x32_bf16 v[32:35], a[96:99], a[204:207], v[32:35]
ds_read_b64_tr_b16 a[124:125], v219 offset:4256
v_mfma_f32_16x16x32_bf16 v[32:35], a[100:103], a[220:223], v[32:35]
ds_read_b64_tr_b16 a[126:127], v219 offset:4768
v_mfma_f32_16x16x32_bf16 v[64:67], a[96:99], a[208:211], v[64:67]
buffer_load_dwordx4 v230, s[20:23], s45 offen offset:1056 lds
v_mfma_f32_16x16x32_bf16 v[64:67], a[100:103], a[224:227], v[64:67]
v_mfma_f32_16x16x32_bf16 v[96:99], a[96:99], a[212:215], v[96:99]
buffer_load_dwordx4 v231, s[20:23], s45 offen offset:2112 lds
v_mfma_f32_16x16x32_bf16 v[96:99], a[100:103], a[228:231], v[96:99]
v_mfma_f32_16x16x32_bf16 v[192:195], a[96:99], a[240:243], v[192:195]
v_mfma_f32_16x16x32_bf16 v[192:195], a[100:103], a[244:247], v[192:195]
s_waitcnt vmcnt(16) lgkmcnt(0)
s_barrier
ds_read_b64_tr_b16 a[96:97], v216 offset:34048
v_mfma_f32_16x16x32_bf16 v[4:7], a[104:107], a[200:203], v[4:7]
buffer_load_dwordx4 v232, s[20:23], s45 offen offset:3168 lds
v_mfma_f32_16x16x32_bf16 v[4:7], a[108:111], a[216:219], v[4:7]
s_add_u32 m0, s44, 17024
ds_read_b64_tr_b16 a[98:99], v216 offset:34560
s_add_u32 s45, s97, 2621440
v_mfma_f32_16x16x32_bf16 v[36:39], a[104:107], a[204:207], v[36:39]
s_and_b32 s45, s45, 4194303
ds_read_b64_tr_b16 a[100:101], v216 offset:38272
v_mfma_f32_16x16x32_bf16 v[36:39], a[108:111], a[220:223], v[36:39]
buffer_load_dwordx4 v225, s[24:27], s45 offen offset:0 lds
v_mfma_f32_16x16x32_bf16 v[68:71], a[104:107], a[208:211], v[68:71]
s_cmp_lg_u32 0, 0
Lisl1_0:
s_cbranch_scc1 Lisl1_1
ds_read_b64_tr_b16 a[102:103], v216 offset:38784
v_mfma_f32_16x16x32_bf16 v[68:71], a[108:111], a[224:227], v[68:71]
v_mfma_f32_16x16x32_bf16 v[100:103], a[104:107], a[212:215], v[100:103]
v_mfma_f32_16x16x32_bf16 v[100:103], a[108:111], a[228:231], v[100:103]
v_mfma_f32_16x16x32_bf16 v[196:199], a[104:107], a[240:243], v[196:199]
buffer_load_dwordx4 v226, s[24:27], s45 offen offset:1056 lds
v_mfma_f32_16x16x32_bf16 v[196:199], a[108:111], a[244:247], v[196:199]
ds_read_b64_tr_b16 a[104:105], v216 offset:34080
v_mfma_f32_16x16x32_bf16 v[8:11], a[112:115], a[200:203], v[8:11]
ds_read_b64_tr_b16 a[106:107], v216 offset:34592
v_mfma_f32_16x16x32_bf16 v[8:11], a[116:119], a[216:219], v[8:11]
ds_read_b64_tr_b16 a[108:109], v216 offset:38304
v_mfma_f32_16x16x32_bf16 v[40:43], a[112:115], a[204:207], v[40:43]
buffer_load_dwordx4 v227, s[24:27], s45 offen offset:2112 lds
v_mfma_f32_16x16x32_bf16 v[40:43], a[116:119], a[220:223], v[40:43]
s_cmp_lg_u32 0, 0
Lisl1_1:
s_cbranch_scc1 Lret0
ds_read_b64_tr_b16 a[110:111], v216 offset:38816
v_mfma_f32_16x16x32_bf16 v[72:75], a[112:115], a[208:211], v[72:75]
v_mfma_f32_16x16x32_bf16 v[72:75], a[116:119], a[224:227], v[72:75]
v_mfma_f32_16x16x32_bf16 v[104:107], a[112:115], a[212:215], v[104:107]
buffer_load_dwordx4 v228, s[24:27], s45 offen offset:3168 lds
v_mfma_f32_16x16x32_bf16 v[104:107], a[116:119], a[228:231], v[104:107]
s_add_u32 m0, s44, 68096
ds_read_b64_tr_b16 a[112:113], v217 offset:34048
s_add_u32 s45, s97, 2621568
v_mfma_f32_16x16x32_bf16 v[12:15], a[120:123], a[200:203], v[12:15]
s_and_b32 s45, s45, 4194303
ds_read_b64_tr_b16 a[114:115], v217 offset:34560
v_mfma_f32_16x16x32_bf16 v[12:15], a[124:127], a[216:219], v[12:15]
ds_read_b64_tr_b16 a[116:117], v217 offset:38272
v_mfma_f32_16x16x32_bf16 v[44:47], a[120:123], a[204:207], v[44:47]
buffer_load_dwordx4 v225, s[24:27], s45 offen offset:0 lds
v_mfma_f32_16x16x32_bf16 v[44:47], a[124:127], a[220:223], v[44:47]
ds_read_b64_tr_b16 a[118:119], v217 offset:38784
v_mfma_f32_16x16x32_bf16 v[76:79], a[120:123], a[208:211], v[76:79]
v_mfma_f32_16x16x32_bf16 v[76:79], a[124:127], a[224:227], v[76:79]
v_mfma_f32_16x16x32_bf16 v[108:111], a[120:123], a[212:215], v[108:111]
buffer_load_dwordx4 v226, s[24:27], s45 offen offset:1056 lds
v_mfma_f32_16x16x32_bf16 v[108:111], a[124:127], a[228:231], v[108:111]
s_waitcnt lgkmcnt(2)
ds_read_b64_tr_b16 a[120:121], v217 offset:34080
v_mfma_f32_16x16x32_bf16 v[16:19], a[96:99], a[200:203], v[16:19]
ds_read_b64_tr_b16 a[122:123], v217 offset:34592
v_mfma_f32_16x16x32_bf16 v[16:19], a[100:103], a[216:219], v[16:19]
ds_read_b64_tr_b16 a[124:125], v217 offset:38304
v_mfma_f32_16x16x32_bf16 v[48:51], a[96:99], a[204:207], v[48:51]
ds_read_b64_tr_b16 a[126:127], v217 offset:38816
v_mfma_f32_16x16x32_bf16 v[48:51], a[100:103], a[220:223], v[48:51]
buffer_load_dwordx4 v227, s[24:27], s45 offen offset:2112 lds
v_mfma_f32_16x16x32_bf16 v[80:83], a[96:99], a[208:211], v[80:83]
v_mfma_f32_16x16x32_bf16 v[80:83], a[100:103], a[224:227], v[80:83]
v_mfma_f32_16x16x32_bf16 v[112:115], a[96:99], a[212:215], v[112:115]
v_mfma_f32_16x16x32_bf16 v[112:115], a[100:103], a[228:231], v[112:115]
buffer_load_dwordx4 v228, s[24:27], s45 offen offset:3168 lds
v_mfma_f32_16x16x32_bf16 v[200:203], a[96:99], a[240:243], v[200:203]
s_add_u32 m0, s44, 34048
s_add_u32 s45, s96, 768
s_and_b32 s45, s45, 1023
v_mfma_f32_16x16x32_bf16 v[200:203], a[100:103], a[244:247], v[200:203]
s_waitcnt vmcnt(16) lgkmcnt(0)
s_barrier
ds_read_b128 a[128:131], v221 offset:0
v_mfma_f32_16x16x32_bf16 v[20:23], a[104:107], a[200:203], v[20:23]
ds_read_b64_tr_b16 a[96:97], v218 offset:17024
ds_read_b64_tr_b16 a[98:99], v218 offset:17536
v_mfma_f32_16x16x32_bf16 v[20:23], a[108:111], a[216:219], v[20:23]
buffer_load_dwordx4 v229, s[20:23], s45 offen offset:0 lds
v_mfma_f32_16x16x32_bf16 v[52:55], a[104:107], a[204:207], v[52:55]
ds_read_b128 a[144:147], v221 offset:64
v_mfma_f32_16x16x32_bf16 v[52:55], a[108:111], a[220:223], v[52:55]
ds_read_b64_tr_b16 a[100:101], v218 offset:21248
v_mfma_f32_16x16x32_bf16 v[84:87], a[104:107], a[208:211], v[84:87]
ds_read_b64_tr_b16 a[102:103], v218 offset:21760
v_mfma_f32_16x16x32_bf16 v[84:87], a[108:111], a[224:227], v[84:87]
buffer_load_dwordx4 v230, s[20:23], s45 offen offset:1056 lds
v_mfma_f32_16x16x32_bf16 v[116:119], a[104:107], a[212:215], v[116:119]
ds_read_b128 a[132:135], v221 offset:512
v_mfma_f32_16x16x32_bf16 v[116:119], a[108:111], a[228:231], v[116:119]
ds_read_b128 a[148:151], v221 offset:576
v_mfma_f32_16x16x32_bf16 v[204:207], a[104:107], a[240:243], v[204:207]
ds_read_b128 a[136:139], v221 offset:4224
v_mfma_f32_16x16x32_bf16 v[204:207], a[108:111], a[244:247], v[204:207]
buffer_load_dwordx4 v231, s[20:23], s45 offen offset:2112 lds
v_mfma_f32_16x16x32_bf16 v[24:27], a[112:115], a[200:203], v[24:27]
ds_read_b128 a[152:155], v221 offset:4288
v_mfma_f32_16x16x32_bf16 v[24:27], a[116:119], a[216:219], v[24:27]
ds_read_b128 a[140:143], v221 offset:4736
v_mfma_f32_16x16x32_bf16 v[56:59], a[112:115], a[204:207], v[56:59]
ds_read_b128 a[156:159], v221 offset:4800
v_mfma_f32_16x16x32_bf16 v[56:59], a[116:119], a[220:223], v[56:59]
buffer_load_dwordx4 v232, s[20:23], s45 offen offset:3168 lds
v_mfma_f32_16x16x32_bf16 v[88:91], a[112:115], a[208:211], v[88:91]
ds_read_b128 a[232:235], v222 offset:0
v_mfma_f32_16x16x32_bf16 v[88:91], a[116:119], a[224:227], v[88:91]
s_add_u32 m0, s55, 157440
ds_read_b128 a[236:239], v222 offset:64
s_add_u32 s45, s96, 768
v_mfma_f32_16x16x32_bf16 v[120:123], a[112:115], a[212:215], v[120:123]
s_and_b32 s45, s45, 1023
ds_read_b64_tr_b16 a[104:105], v218 offset:17056
v_mfma_f32_16x16x32_bf16 v[120:123], a[116:119], a[228:231], v[120:123]
ds_read_b64_tr_b16 a[106:107], v218 offset:17568
v_mfma_f32_16x16x32_bf16 v[28:31], a[120:123], a[200:203], v[28:31]
buffer_load_dwordx4 v233, s[20:23], s45 offen offset:0 lds
v_mfma_f32_16x16x32_bf16 v[28:31], a[124:127], a[216:219], v[28:31]
s_add_u32 m0, s44, 85120
ds_read_b64_tr_b16 a[108:109], v218 offset:21280
s_add_u32 s45, s97, 3145728
v_mfma_f32_16x16x32_bf16 v[60:63], a[120:123], a[204:207], v[60:63]
s_and_b32 s45, s45, 4194303
ds_read_b64_tr_b16 a[110:111], v218 offset:21792
v_mfma_f32_16x16x32_bf16 v[60:63], a[124:127], a[220:223], v[60:63]
ds_read_b64_tr_b16 a[112:113], v219 offset:17024
v_mfma_f32_16x16x32_bf16 v[92:95], a[120:123], a[208:211], v[92:95]
buffer_load_dwordx4 v225, s[24:27], s45 offen offset:0 lds
v_mfma_f32_16x16x32_bf16 v[92:95], a[124:127], a[224:227], v[92:95]
ds_read_b64_tr_b16 a[114:115], v219 offset:17536
v_mfma_f32_16x16x32_bf16 v[124:127], a[120:123], a[212:215], v[124:127]
ds_read_b64_tr_b16 a[116:117], v219 offset:21248
v_mfma_f32_16x16x32_bf16 v[124:127], a[124:127], a[228:231], v[124:127]
s_waitcnt lgkmcnt(5)
ds_read_b64_tr_b16 a[118:119], v219 offset:21760
v_mfma_f32_16x16x32_bf16 v[0:3], a[96:99], a[128:131], v[0:3]
ds_read_b64_tr_b16 a[120:121], v219 offset:17056
v_mfma_f32_16x16x32_bf16 v[0:3], a[100:103], a[144:147], v[0:3]
ds_read_b64_tr_b16 a[122:123], v219 offset:17568
v_mfma_f32_16x16x32_bf16 v[32:35], a[96:99], a[132:135], v[32:35]
ds_read_b64_tr_b16 a[124:125], v219 offset:21280
v_mfma_f32_16x16x32_bf16 v[32:35], a[100:103], a[148:151], v[32:35]
ds_read_b64_tr_b16 a[126:127], v219 offset:21792
v_mfma_f32_16x16x32_bf16 v[64:67], a[96:99], a[136:139], v[64:67]
buffer_load_dwordx4 v226, s[24:27], s45 offen offset:1056 lds
v_mfma_f32_16x16x32_bf16 v[64:67], a[100:103], a[152:155], v[64:67]
v_mfma_f32_16x16x32_bf16 v[96:99], a[96:99], a[140:143], v[96:99]
buffer_load_dwordx4 v227, s[24:27], s45 offen offset:2112 lds
v_mfma_f32_16x16x32_bf16 v[96:99], a[100:103], a[156:159], v[96:99]
v_mfma_f32_16x16x32_bf16 v[192:195], a[96:99], a[232:235], v[192:195]
buffer_load_dwordx4 v228, s[24:27], s45 offen offset:3168 lds
v_mfma_f32_16x16x32_bf16 v[192:195], a[100:103], a[236:239], v[192:195]
s_waitcnt vmcnt(21) lgkmcnt(0)
s_barrier
ds_read_b64_tr_b16 a[96:97], v218 offset:51072
v_mfma_f32_16x16x32_bf16 v[4:7], a[104:107], a[128:131], v[4:7]
s_add_u32 m0, s44, 119168
ds_read_b64_tr_b16 a[98:99], v218 offset:51584
s_add_u32 s45, s96, 896
v_mfma_f32_16x16x32_bf16 v[4:7], a[108:111], a[144:147], v[4:7]
s_and_b32 s45, s45, 1023
ds_read_b64_tr_b16 a[100:101], v218 offset:55296
v_mfma_f32_16x16x32_bf16 v[36:39], a[104:107], a[132:135], v[36:39]
ds_read_b64_tr_b16 a[102:103], v218 offset:55808
v_mfma_f32_16x16x32_bf16 v[36:39], a[108:111], a[148:151], v[36:39]
buffer_load_dwordx4 v229, s[20:23], s45 offen offset:0 lds
v_mfma_f32_16x16x32_bf16 v[68:71], a[104:107], a[136:139], v[68:71]
v_mfma_f32_16x16x32_bf16 v[68:71], a[108:111], a[152:155], v[68:71]
v_mfma_f32_16x16x32_bf16 v[100:103], a[104:107], a[140:143], v[100:103]
v_mfma_f32_16x16x32_bf16 v[100:103], a[108:111], a[156:159], v[100:103]
buffer_load_dwordx4 v230, s[20:23], s45 offen offset:1056 lds
v_mfma_f32_16x16x32_bf16 v[196:199], a[104:107], a[232:235], v[196:199]
ds_read_b64_tr_b16 a[104:105], v218 offset:51104
v_mfma_f32_16x16x32_bf16 v[196:199], a[108:111], a[236:239], v[196:199]
ds_read_b64_tr_b16 a[106:107], v218 offset:51616
v_mfma_f32_16x16x32_bf16 v[8:11], a[112:115], a[128:131], v[8:11]
ds_read_b64_tr_b16 a[108:109], v218 offset:55328
v_mfma_f32_16x16x32_bf16 v[8:11], a[116:119], a[144:147], v[8:11]
buffer_load_dwordx4 v231, s[20:23], s45 offen offset:2112 lds
v_mfma_f32_16x16x32_bf16 v[40:43], a[112:115], a[132:135], v[40:43]
ds_read_b64_tr_b16 a[110:111], v218 offset:55840
v_mfma_f32_16x16x32_bf16 v[40:43], a[116:119], a[148:151], v[40:43]
v_mfma_f32_16x16x32_bf16 v[72:75], a[112:115], a[136:139], v[72:75]
v_mfma_f32_16x16x32_bf16 v[72:75], a[116:119], a[152:155], v[72:75]
buffer_load_dwordx4 v232, s[20:23], s45 offen offset:3168 lds
v_mfma_f32_16x16x32_bf16 v[104:107], a[112:115], a[140:143], v[104:107]
s_add_u32 m0, s44, 51072
ds_read_b64_tr_b16 a[112:113], v219 offset:51072
s_add_u32 s45, s97, 3670016
v_mfma_f32_16x16x32_bf16 v[104:107], a[116:119], a[156:159], v[104:107]
s_and_b32 s45, s45, 4194303
ds_read_b64_tr_b16 a[114:115], v219 offset:51584
v_mfma_f32_16x16x32_bf16 v[12:15], a[120:123], a[128:131], v[12:15]
ds_read_b64_tr_b16 a[116:117], v219 offset:55296
v_mfma_f32_16x16x32_bf16 v[12:15], a[124:127], a[144:147], v[12:15]
buffer_load_dwordx4 v225, s[24:27], s45 offen offset:0 lds
v_mfma_f32_16x16x32_bf16 v[44:47], a[120:123], a[132:135], v[44:47]
ds_read_b64_tr_b16 a[118:119], v219 offset:55808
v_mfma_f32_16x16x32_bf16 v[44:47], a[124:127], a[148:151], v[44:47]
v_mfma_f32_16x16x32_bf16 v[76:79], a[120:123], a[136:139], v[76:79]
v_mfma_f32_16x16x32_bf16 v[76:79], a[124:127], a[152:155], v[76:79]
v_mfma_f32_16x16x32_bf16 v[108:111], a[120:123], a[140:143], v[108:111]
buffer_load_dwordx4 v226, s[24:27], s45 offen offset:1056 lds
v_mfma_f32_16x16x32_bf16 v[108:111], a[124:127], a[156:159], v[108:111]
s_waitcnt lgkmcnt(1)
ds_read_b64_tr_b16 a[120:121], v219 offset:51104
v_mfma_f32_16x16x32_bf16 v[16:19], a[96:99], a[128:131], v[16:19]
ds_read_b64_tr_b16 a[122:123], v219 offset:51616
v_mfma_f32_16x16x32_bf16 v[16:19], a[100:103], a[144:147], v[16:19]
ds_read_b64_tr_b16 a[124:125], v219 offset:55328
v_mfma_f32_16x16x32_bf16 v[48:51], a[96:99], a[132:135], v[48:51]
ds_read_b64_tr_b16 a[126:127], v219 offset:55840
v_mfma_f32_16x16x32_bf16 v[48:51], a[100:103], a[148:151], v[48:51]
buffer_load_dwordx4 v227, s[24:27], s45 offen offset:2112 lds
v_mfma_f32_16x16x32_bf16 v[80:83], a[96:99], a[136:139], v[80:83]
v_mfma_f32_16x16x32_bf16 v[80:83], a[100:103], a[152:155], v[80:83]
v_mfma_f32_16x16x32_bf16 v[112:115], a[96:99], a[140:143], v[112:115]
buffer_load_dwordx4 v228, s[24:27], s45 offen offset:3168 lds
v_mfma_f32_16x16x32_bf16 v[112:115], a[100:103], a[156:159], v[112:115]
s_add_u32 m0, s44, 102144
s_add_u32 s45, s97, 3145856
s_and_b32 s45, s45, 4194303
v_mfma_f32_16x16x32_bf16 v[200:203], a[96:99], a[232:235], v[200:203]
v_mfma_f32_16x16x32_bf16 v[200:203], a[100:103], a[236:239], v[200:203]
s_waitcnt vmcnt(21) lgkmcnt(0)
s_barrier
ds_read_b128 a[200:203], v220 offset:0
v_mfma_f32_16x16x32_bf16 v[20:23], a[104:107], a[128:131], v[20:23]
buffer_load_dwordx4 v225, s[24:27], s45 offen offset:0 lds
v_mfma_f32_16x16x32_bf16 v[20:23], a[108:111], a[144:147], v[20:23]
ds_read_b64_tr_b16 a[96:97], v216 offset:0
ds_read_b64_tr_b16 a[98:99], v216 offset:512
v_mfma_f32_16x16x32_bf16 v[52:55], a[104:107], a[132:135], v[52:55]
ds_read_b128 a[216:219], v220 offset:64
v_mfma_f32_16x16x32_bf16 v[52:55], a[108:111], a[148:151], v[52:55]
ds_read_b64_tr_b16 a[100:101], v216 offset:4224
v_mfma_f32_16x16x32_bf16 v[84:87], a[104:107], a[136:139], v[84:87]
buffer_load_dwordx4 v226, s[24:27], s45 offen offset:1056 lds
v_mfma_f32_16x16x32_bf16 v[84:87], a[108:111], a[152:155], v[84:87]
ds_read_b64_tr_b16 a[102:103], v216 offset:4736
v_mfma_f32_16x16x32_bf16 v[116:119], a[104:107], a[140:143], v[116:119]
ds_read_b128 a[204:207], v220 offset:512
v_mfma_f32_16x16x32_bf16 v[116:119], a[108:111], a[156:159], v[116:119]
ds_read_b128 a[220:223], v220 offset:576
v_mfma_f32_16x16x32_bf16 v[204:207], a[104:107], a[232:235], v[204:207]
ds_read_b128 a[208:211], v220 offset:4224
v_mfma_f32_16x16x32_bf16 v[204:207], a[108:111], a[236:239], v[204:207]
buffer_load_dwordx4 v227, s[24:27], s45 offen offset:2112 lds
v_mfma_f32_16x16x32_bf16 v[24:27], a[112:115], a[128:131], v[24:27]
ds_read_b128 a[224:227], v220 offset:4288
v_mfma_f32_16x16x32_bf16 v[24:27], a[116:119], a[144:147], v[24:27]
ds_read_b128 a[212:215], v220 offset:4736
v_mfma_f32_16x16x32_bf16 v[56:59], a[112:115], a[132:135], v[56:59]
ds_read_b128 a[228:231], v220 offset:4800
v_mfma_f32_16x16x32_bf16 v[56:59], a[116:119], a[148:151], v[56:59]
buffer_load_dwordx4 v228, s[24:27], s45 offen offset:3168 lds
v_mfma_f32_16x16x32_bf16 v[88:91], a[112:115], a[136:139], v[88:91]
s_add_u32 m0, s44, 136192
ds_read_b128 a[240:243], v222 offset:512
s_add_u32 s45, s97, 3670144
v_mfma_f32_16x16x32_bf16 v[88:91], a[116:119], a[152:155], v[88:91]
s_and_b32 s45, s45, 4194303
ds_read_b128 a[244:247], v222 offset:576
v_mfma_f32_16x16x32_bf16 v[120:123], a[112:115], a[140:143], v[120:123]
ds_read_b64_tr_b16 a[104:105], v216 offset:32
v_mfma_f32_16x16x32_bf16 v[120:123], a[116:119], a[156:159], v[120:123]
buffer_load_dwordx4 v225, s[24:27], s45 offen offset:0 lds
v_mfma_f32_16x16x32_bf16 v[28:31], a[120:123], a[128:131], v[28:31]
ds_read_b64_tr_b16 a[106:107], v216 offset:544
v_mfma_f32_16x16x32_bf16 v[28:31], a[124:127], a[144:147], v[28:31]
ds_read_b64_tr_b16 a[108:109], v216 offset:4256
v_mfma_f32_16x16x32_bf16 v[60:63], a[120:123], a[132:135], v[60:63]
ds_read_b64_tr_b16 a[110:111], v216 offset:4768
v_mfma_f32_16x16x32_bf16 v[60:63], a[124:127], a[148:151], v[60:63]
buffer_load_dwordx4 v226, s[24:27], s45 offen offset:1056 lds
v_mfma_f32_16x16x32_bf16 v[92:95], a[120:123], a[136:139], v[92:95]
ds_read_b64_tr_b16 a[112:113], v217 offset:0
v_mfma_f32_16x16x32_bf16 v[92:95], a[124:127], a[152:155], v[92:95]
ds_read_b64_tr_b16 a[114:115], v217 offset:512
v_mfma_f32_16x16x32_bf16 v[124:127], a[120:123], a[140:143], v[124:127]
ds_read_b64_tr_b16 a[116:117], v217 offset:4224
v_mfma_f32_16x16x32_bf16 v[124:127], a[124:127], a[156:159], v[124:127]
s_waitcnt lgkmcnt(5)
ds_read_b64_tr_b16 a[118:119], v217 offset:4736
v_mfma_f32_16x16x32_bf16 v[0:3], a[96:99], a[200:203], v[0:3]
ds_read_b64_tr_b16 a[120:121], v217 offset:32
v_mfma_f32_16x16x32_bf16 v[0:3], a[100:103], a[216:219], v[0:3]
ds_read_b64_tr_b16 a[122:123], v217 offset:544
v_mfma_f32_16x16x32_bf16 v[32:35], a[96:99], a[204:207], v[32:35]
ds_read_b64_tr_b16 a[124:125], v217 offset:4256
v_mfma_f32_16x16x32_bf16 v[32:35], a[100:103], a[220:223], v[32:35]
ds_read_b64_tr_b16 a[126:127], v217 offset:4768
v_mfma_f32_16x16x32_bf16 v[64:67], a[96:99], a[208:211], v[64:67]
buffer_load_dwordx4 v227, s[24:27], s45 offen offset:2112 lds
v_mfma_f32_16x16x32_bf16 v[64:67], a[100:103], a[224:227], v[64:67]
v_mfma_f32_16x16x32_bf16 v[96:99], a[96:99], a[212:215], v[96:99]
buffer_load_dwordx4 v228, s[24:27], s45 offen offset:3168 lds
v_mfma_f32_16x16x32_bf16 v[96:99], a[100:103], a[228:231], v[96:99]
v_mfma_f32_16x16x32_bf16 v[192:195], a[96:99], a[240:243], v[192:195]
v_mfma_f32_16x16x32_bf16 v[192:195], a[100:103], a[244:247], v[192:195]
s_waitcnt vmcnt(25) lgkmcnt(0)
s_barrier
s_add_u32 m0, s44, 0
v_mfma_f32_16x16x32_bf16 v[4:7], a[104:107], a[200:203], v[4:7]
s_xor_b32 s45, s47, 0
s_waitcnt vmcnt(10)
buffer_load_dwordx4 v244, s[28:31], s45 offen offset:0 nt lds
v_mfma_f32_16x16x32_bf16 v[4:7], a[108:111], a[216:219], v[4:7]
ds_read_b64_tr_b16 a[96:97], v216 offset:51072
v_mfma_f32_16x16x32_bf16 v[36:39], a[104:107], a[204:207], v[36:39]
s_waitcnt vmcnt(10)
buffer_load_dwordx4 v245, s[28:31], s45 offen offset:1056 nt lds
v_mfma_f32_16x16x32_bf16 v[36:39], a[108:111], a[220:223], v[36:39]
ds_read_b64_tr_b16 a[98:99], v216 offset:51584
v_mfma_f32_16x16x32_bf16 v[68:71], a[104:107], a[208:211], v[68:71]
s_waitcnt vmcnt(10)
buffer_load_dwordx4 v246, s[28:31], s45 offen offset:2112 nt lds
v_mfma_f32_16x16x32_bf16 v[68:71], a[108:111], a[224:227], v[68:71]
ds_read_b64_tr_b16 a[100:101], v216 offset:55296
v_mfma_f32_16x16x32_bf16 v[100:103], a[104:107], a[212:215], v[100:103]
s_waitcnt vmcnt(10)
buffer_load_dwordx4 v247, s[28:31], s45 offen offset:3168 nt lds
v_mfma_f32_16x16x32_bf16 v[100:103], a[108:111], a[228:231], v[100:103]
s_add_u32 m0, s44, 17024
ds_read_b64_tr_b16 a[102:103], v216 offset:55808
s_xor_b32 s45, s47, 8192
v_mfma_f32_16x16x32_bf16 v[196:199], a[104:107], a[240:243], v[196:199]
s_waitcnt vmcnt(10)
buffer_load_dwordx4 v244, s[28:31], s45 offen offset:0 nt lds
v_mfma_f32_16x16x32_bf16 v[196:199], a[108:111], a[244:247], v[196:199]
ds_read_b64_tr_b16 a[104:105], v216 offset:51104
v_mfma_f32_16x16x32_bf16 v[8:11], a[112:115], a[200:203], v[8:11]
s_waitcnt vmcnt(10)
buffer_load_dwordx4 v245, s[28:31], s45 offen offset:1056 nt lds
v_mfma_f32_16x16x32_bf16 v[8:11], a[116:119], a[216:219], v[8:11]
ds_read_b64_tr_b16 a[106:107], v216 offset:51616
v_mfma_f32_16x16x32_bf16 v[40:43], a[112:115], a[204:207], v[40:43]
s_waitcnt vmcnt(10)
buffer_load_dwordx4 v246, s[28:31], s45 offen offset:2112 nt lds
v_mfma_f32_16x16x32_bf16 v[40:43], a[116:119], a[220:223], v[40:43]
ds_read_b64_tr_b16 a[108:109], v216 offset:55328
v_mfma_f32_16x16x32_bf16 v[72:75], a[112:115], a[208:211], v[72:75]
s_waitcnt vmcnt(10)
buffer_load_dwordx4 v247, s[28:31], s45 offen offset:3168 nt lds
v_mfma_f32_16x16x32_bf16 v[72:75], a[116:119], a[224:227], v[72:75]
ds_read_b64_tr_b16 a[110:111], v216 offset:55840
v_mfma_f32_16x16x32_bf16 v[104:107], a[112:115], a[212:215], v[104:107]
ds_read_b64_tr_b16 a[112:113], v217 offset:51072
v_mfma_f32_16x16x32_bf16 v[104:107], a[116:119], a[228:231], v[104:107]
ds_read_b64_tr_b16 a[114:115], v217 offset:51584
v_mfma_f32_16x16x32_bf16 v[12:15], a[120:123], a[200:203], v[12:15]
ds_read_b64_tr_b16 a[116:117], v217 offset:55296
v_mfma_f32_16x16x32_bf16 v[12:15], a[124:127], a[216:219], v[12:15]
ds_read_b64_tr_b16 a[118:119], v217 offset:55808
v_mfma_f32_16x16x32_bf16 v[44:47], a[120:123], a[204:207], v[44:47]
v_mfma_f32_16x16x32_bf16 v[44:47], a[124:127], a[220:223], v[44:47]
v_mfma_f32_16x16x32_bf16 v[76:79], a[120:123], a[208:211], v[76:79]
v_mfma_f32_16x16x32_bf16 v[76:79], a[124:127], a[224:227], v[76:79]
v_mfma_f32_16x16x32_bf16 v[108:111], a[120:123], a[212:215], v[108:111]
ds_read_b64_tr_b16 a[120:121], v217 offset:51104
v_mfma_f32_16x16x32_bf16 v[108:111], a[124:127], a[228:231], v[108:111]
s_waitcnt lgkmcnt(2)
ds_read_b64_tr_b16 a[122:123], v217 offset:51616
v_mfma_f32_16x16x32_bf16 v[16:19], a[96:99], a[200:203], v[16:19]
ds_read_b64_tr_b16 a[124:125], v217 offset:55328
v_mfma_f32_16x16x32_bf16 v[16:19], a[100:103], a[216:219], v[16:19]
ds_read_b64_tr_b16 a[126:127], v217 offset:55840
v_mfma_f32_16x16x32_bf16 v[48:51], a[96:99], a[204:207], v[48:51]
v_mfma_f32_16x16x32_bf16 v[48:51], a[100:103], a[220:223], v[48:51]
v_mfma_f32_16x16x32_bf16 v[80:83], a[96:99], a[208:211], v[80:83]
v_mfma_f32_16x16x32_bf16 v[80:83], a[100:103], a[224:227], v[80:83]
v_mfma_f32_16x16x32_bf16 v[112:115], a[96:99], a[212:215], v[112:115]
v_mfma_f32_16x16x32_bf16 v[112:115], a[100:103], a[228:231], v[112:115]
v_mfma_f32_16x16x32_bf16 v[200:203], a[96:99], a[240:243], v[200:203]
v_mfma_f32_16x16x32_bf16 v[200:203], a[100:103], a[244:247], v[200:203]
s_waitcnt vmcnt(24) lgkmcnt(0)
s_barrier
s_add_u32 m0, s44, 68096
v_mfma_f32_16x16x32_bf16 v[20:23], a[104:107], a[200:203], v[20:23]
s_xor_b32 s45, s47, 0
s_waitcnt vmcnt(10)
buffer_load_dwordx4 v244, s[32:35], s45 offen offset:0 nt lds
v_mfma_f32_16x16x32_bf16 v[20:23], a[108:111], a[216:219], v[20:23]
ds_read_b128 a[128:131], v220 offset:34048
v_mfma_f32_16x16x32_bf16 v[52:55], a[104:107], a[204:207], v[52:55]
s_waitcnt vmcnt(10)
buffer_load_dwordx4 v245, s[32:35], s45 offen offset:1056 nt lds
v_mfma_f32_16x16x32_bf16 v[52:55], a[108:111], a[220:223], v[52:55]
ds_read_b64_tr_b16 a[96:97], v218 offset:0
v_mfma_f32_16x16x32_bf16 v[84:87], a[104:107], a[208:211], v[84:87]
s_waitcnt vmcnt(10)
buffer_load_dwordx4 v246, s[32:35], s45 offen offset:2112 nt lds
v_mfma_f32_16x16x32_bf16 v[84:87], a[108:111], a[224:227], v[84:87]
ds_read_b64_tr_b16 a[98:99], v218 offset:512
v_mfma_f32_16x16x32_bf16 v[116:119], a[104:107], a[212:215], v[116:119]
s_waitcnt vmcnt(10)
buffer_load_dwordx4 v247, s[32:35], s45 offen offset:3168 nt lds
v_mfma_f32_16x16x32_bf16 v[116:119], a[108:111], a[228:231], v[116:119]
ds_read_b128 a[144:147], v220 offset:34112
v_mfma_f32_16x16x32_bf16 v[204:207], a[104:107], a[240:243], v[204:207]
ds_read_b64_tr_b16 a[100:101], v218 offset:4224
v_mfma_f32_16x16x32_bf16 v[204:207], a[108:111], a[244:247], v[204:207]
ds_read_b64_tr_b16 a[102:103], v218 offset:4736
v_mfma_f32_16x16x32_bf16 v[24:27], a[112:115], a[200:203], v[24:27]
ds_read_b128 a[132:135], v220 offset:34560
v_mfma_f32_16x16x32_bf16 v[24:27], a[116:119], a[216:219], v[24:27]
ds_read_b128 a[148:151], v220 offset:34624
v_mfma_f32_16x16x32_bf16 v[56:59], a[112:115], a[204:207], v[56:59]
ds_read_b128 a[136:139], v220 offset:38272
v_mfma_f32_16x16x32_bf16 v[56:59], a[116:119], a[220:223], v[56:59]
ds_read_b128 a[152:155], v220 offset:38336
v_mfma_f32_16x16x32_bf16 v[88:91], a[112:115], a[208:211], v[88:91]
ds_read_b128 a[140:143], v220 offset:38784
v_mfma_f32_16x16x32_bf16 v[88:91], a[116:119], a[224:227], v[88:91]
ds_read_b128 a[156:159], v220 offset:38848
v_mfma_f32_16x16x32_bf16 v[120:123], a[112:115], a[212:215], v[120:123]
ds_read_b128 a[232:235], v222 offset:4224
v_mfma_f32_16x16x32_bf16 v[120:123], a[116:119], a[228:231], v[120:123]
ds_read_b128 a[236:239], v222 offset:4288
v_mfma_f32_16x16x32_bf16 v[28:31], a[120:123], a[200:203], v[28:31]
ds_read_b64_tr_b16 a[104:105], v218 offset:32
v_mfma_f32_16x16x32_bf16 v[28:31], a[124:127], a[216:219], v[28:31]
ds_read_b64_tr_b16 a[106:107], v218 offset:544
v_mfma_f32_16x16x32_bf16 v[60:63], a[120:123], a[204:207], v[60:63]
ds_read_b64_tr_b16 a[108:109], v218 offset:4256
v_mfma_f32_16x16x32_bf16 v[60:63], a[124:127], a[220:223], v[60:63]
ds_read_b64_tr_b16 a[110:111], v218 offset:4768
v_mfma_f32_16x16x32_bf16 v[92:95], a[120:123], a[208:211], v[92:95]
ds_read_b64_tr_b16 a[112:113], v219 offset:0
v_mfma_f32_16x16x32_bf16 v[92:95], a[124:127], a[224:227], v[92:95]
ds_read_b64_tr_b16 a[114:115], v219 offset:512
v_mfma_f32_16x16x32_bf16 v[124:127], a[120:123], a[212:215], v[124:127]
ds_read_b64_tr_b16 a[116:117], v219 offset:4224
v_mfma_f32_16x16x32_bf16 v[124:127], a[124:127], a[228:231], v[124:127]
s_waitcnt lgkmcnt(6)
ds_read_b64_tr_b16 a[118:119], v219 offset:4736
v_mfma_f32_16x16x32_bf16 v[0:3], a[96:99], a[128:131], v[0:3]
ds_read_b64_tr_b16 a[120:121], v219 offset:32
v_mfma_f32_16x16x32_bf16 v[0:3], a[100:103], a[144:147], v[0:3]
ds_read_b64_tr_b16 a[122:123], v219 offset:544
v_mfma_f32_16x16x32_bf16 v[32:35], a[96:99], a[132:135], v[32:35]
ds_read_b64_tr_b16 a[124:125], v219 offset:4256
v_mfma_f32_16x16x32_bf16 v[32:35], a[100:103], a[148:151], v[32:35]
ds_read_b64_tr_b16 a[126:127], v219 offset:4768
v_mfma_f32_16x16x32_bf16 v[64:67], a[96:99], a[136:139], v[64:67]
v_mfma_f32_16x16x32_bf16 v[64:67], a[100:103], a[152:155], v[64:67]
v_mfma_f32_16x16x32_bf16 v[96:99], a[96:99], a[140:143], v[96:99]
v_mfma_f32_16x16x32_bf16 v[96:99], a[100:103], a[156:159], v[96:99]
v_mfma_f32_16x16x32_bf16 v[192:195], a[96:99], a[232:235], v[192:195]
v_mfma_f32_16x16x32_bf16 v[192:195], a[100:103], a[236:239], v[192:195]
s_waitcnt lgkmcnt(1)
s_waitcnt vmcnt(20) lgkmcnt(0)
s_barrier
v_mfma_f32_16x16x32_bf16 v[4:7], a[104:107], a[128:131], v[4:7]
s_add_u32 m0, s44, 85120
ds_read_b128 a[200:203], v221 offset:0
s_xor_b32 s45, s47, 8192
v_mfma_f32_16x16x32_bf16 v[4:7], a[108:111], a[144:147], v[4:7]
s_waitcnt vmcnt(10)
buffer_load_dwordx4 v244, s[32:35], s45 offen offset:0 nt lds
v_mfma_f32_16x16x32_bf16 v[36:39], a[104:107], a[132:135], v[36:39]
ds_read_b64_tr_b16 a[96:97], v216 offset:34048
ds_read_b64_tr_b16 a[98:99], v216 offset:34560
v_mfma_f32_16x16x32_bf16 v[36:39], a[108:111], a[148:151], v[36:39]
s_waitcnt vmcnt(10)
buffer_load_dwordx4 v245, s[32:35], s45 offen offset:1056 nt lds
v_mfma_f32_16x16x32_bf16 v[68:71], a[104:107], a[136:139], v[68:71]
ds_read_b128 a[216:219], v221 offset:64
ds_read_b64_tr_b16 a[100:101], v216 offset:38272
v_mfma_f32_16x16x32_bf16 v[68:71], a[108:111], a[152:155], v[68:71]
s_waitcnt vmcnt(10)
buffer_load_dwordx4 v246, s[32:35], s45 offen offset:2112 nt lds
v_mfma_f32_16x16x32_bf16 v[100:103], a[104:107], a[140:143], v[100:103]
ds_read_b64_tr_b16 a[102:103], v216 offset:38784
ds_read_b128 a[204:207], v221 offset:512
v_mfma_f32_16x16x32_bf16 v[100:103], a[108:111], a[156:159], v[100:103]
ds_read_b128 a[220:223], v221 offset:576
ds_read_b128 a[208:211], v221 offset:4224
v_mfma_f32_16x16x32_bf16 v[196:199], a[104:107], a[232:235], v[196:199]
s_waitcnt vmcnt(10)
buffer_load_dwordx4 v247, s[32:35], s45 offen offset:3168 nt lds
v_mfma_f32_16x16x32_bf16 v[196:199], a[108:111], a[236:239], v[196:199]
s_add_u32 m0, s44, 34048
ds_read_b128 a[224:227], v221 offset:4288
s_xor_b32 s45, s47, 16384
v_mfma_f32_16x16x32_bf16 v[8:11], a[112:115], a[128:131], v[8:11]
ds_read_b128 a[212:215], v221 offset:4736
v_mfma_f32_16x16x32_bf16 v[8:11], a[116:119], a[144:147], v[8:11]
s_waitcnt vmcnt(10)
buffer_load_dwordx4 v244, s[28:31], s45 offen offset:0 nt lds
v_mfma_f32_16x16x32_bf16 v[40:43], a[112:115], a[132:135], v[40:43]
ds_read_b128 a[228:231], v221 offset:4800
v_mfma_f32_16x16x32_bf16 v[40:43], a[116:119], a[148:151], v[40:43]
ds_read_b128 a[240:243], v222 offset:4736
v_mfma_f32_16x16x32_bf16 v[72:75], a[112:115], a[136:139], v[72:75]
s_waitcnt vmcnt(10)
buffer_load_dwordx4 v245, s[28:31], s45 offen offset:1056 nt lds
v_mfma_f32_16x16x32_bf16 v[72:75], a[116:119], a[152:155], v[72:75]
ds_read_b128 a[244:247], v222 offset:4800
v_mfma_f32_16x16x32_bf16 v[104:107], a[112:115], a[140:143], v[104:107]
ds_read_b64_tr_b16 a[104:105], v216 offset:34080
v_mfma_f32_16x16x32_bf16 v[104:107], a[116:119], a[156:159], v[104:107]
s_waitcnt vmcnt(10)
buffer_load_dwordx4 v246, s[28:31], s45 offen offset:2112 nt lds
v_mfma_f32_16x16x32_bf16 v[12:15], a[120:123], a[128:131], v[12:15]
ds_read_b64_tr_b16 a[106:107], v216 offset:34592
v_mfma_f32_16x16x32_bf16 v[12:15], a[124:127], a[144:147], v[12:15]
ds_read_b64_tr_b16 a[108:109], v216 offset:38304
v_mfma_f32_16x16x32_bf16 v[44:47], a[120:123], a[132:135], v[44:47]
s_waitcnt vmcnt(10)
buffer_load_dwordx4 v247, s[28:31], s45 offen offset:3168 nt lds
v_mfma_f32_16x16x32_bf16 v[44:47], a[124:127], a[148:151], v[44:47]
ds_read_b64_tr_b16 a[110:111], v216 offset:38816
v_mfma_f32_16x16x32_bf16 v[76:79], a[120:123], a[136:139], v[76:79]
ds_read_b64_tr_b16 a[112:113], v217 offset:34048
v_mfma_f32_16x16x32_bf16 v[76:79], a[124:127], a[152:155], v[76:79]
ds_read_b64_tr_b16 a[114:115], v217 offset:34560
v_mfma_f32_16x16x32_bf16 v[108:111], a[120:123], a[140:143], v[108:111]
ds_read_b64_tr_b16 a[116:117], v217 offset:38272
v_mfma_f32_16x16x32_bf16 v[108:111], a[124:127], a[156:159], v[108:111]
s_waitcnt lgkmcnt(5)
ds_read_b64_tr_b16 a[118:119], v217 offset:38784
v_mfma_f32_16x16x32_bf16 v[0:3], a[96:99], a[200:203], v[0:3]
ds_read_b64_tr_b16 a[120:121], v217 offset:34080
v_mfma_f32_16x16x32_bf16 v[0:3], a[100:103], a[216:219], v[0:3]
ds_read_b64_tr_b16 a[122:123], v217 offset:34592
v_mfma_f32_16x16x32_bf16 v[32:35], a[96:99], a[204:207], v[32:35]
ds_read_b64_tr_b16 a[124:125], v217 offset:38304
v_mfma_f32_16x16x32_bf16 v[32:35], a[100:103], a[220:223], v[32:35]
ds_read_b64_tr_b16 a[126:127], v217 offset:38816
v_mfma_f32_16x16x32_bf16 v[64:67], a[96:99], a[208:211], v[64:67]
v_mfma_f32_16x16x32_bf16 v[64:67], a[100:103], a[224:227], v[64:67]
v_mfma_f32_16x16x32_bf16 v[96:99], a[96:99], a[212:215], v[96:99]
v_mfma_f32_16x16x32_bf16 v[96:99], a[100:103], a[228:231], v[96:99]
v_mfma_f32_16x16x32_bf16 v[192:195], a[96:99], a[240:243], v[192:195]
v_mfma_f32_16x16x32_bf16 v[192:195], a[100:103], a[244:247], v[192:195]
s_waitcnt vmcnt(24) lgkmcnt(0)
s_barrier
s_add_u32 m0, s44, 51072
v_mfma_f32_16x16x32_bf16 v[4:7], a[104:107], a[200:203], v[4:7]
s_xor_b32 s45, s47, 24576
s_waitcnt vmcnt(9)
buffer_load_dwordx4 v244, s[28:31], s45 offen offset:0 nt lds
v_mfma_f32_16x16x32_bf16 v[4:7], a[108:111], a[216:219], v[4:7]
ds_read_b64_tr_b16 a[96:97], v218 offset:17024
v_mfma_f32_16x16x32_bf16 v[36:39], a[104:107], a[204:207], v[36:39]
ds_read_b64_tr_b16 a[98:99], v218 offset:17536
v_mfma_f32_16x16x32_bf16 v[36:39], a[108:111], a[220:223], v[36:39]
s_cmp_lg_u32 0, 0
Lisl2_0:
s_cbranch_scc1 Lisl2_1
ds_read_b64_tr_b16 a[100:101], v218 offset:21248
v_mfma_f32_16x16x32_bf16 v[68:71], a[104:107], a[208:211], v[68:71]
s_waitcnt vmcnt(9)
buffer_load_dwordx4 v245, s[28:31], s45 offen offset:1056 nt lds
v_mfma_f32_16x16x32_bf16 v[68:71], a[108:111], a[224:227], v[68:71]
ds_read_b64_tr_b16 a[102:103], v218 offset:21760
v_mfma_f32_16x16x32_bf16 v[100:103], a[104:107], a[212:215], v[100:103]
v_mfma_f32_16x16x32_bf16 v[100:103], a[108:111], a[228:231], v[100:103]
v_mfma_f32_16x16x32_bf16 v[196:199], a[104:107], a[240:243], v[196:199]
ds_read_b64_tr_b16 a[104:105], v218 offset:17056
v_mfma_f32_16x16x32_bf16 v[196:199], a[108:111], a[244:247], v[196:199]
s_waitcnt vmcnt(9)
buffer_load_dwordx4 v246, s[28:31], s45 offen offset:2112 nt lds
v_mfma_f32_16x16x32_bf16 v[8:11], a[112:115], a[200:203], v[8:11]
ds_read_b64_tr_b16 a[106:107], v218 offset:17568
v_mfma_f32_16x16x32_bf16 v[8:11], a[116:119], a[216:219], v[8:11]
s_cmp_lg_u32 0, 0
Lisl2_1:
s_cbranch_scc1 Lret0
ds_read_b64_tr_b16 a[108:109], v218 offset:21280
v_mfma_f32_16x16x32_bf16 v[40:43], a[112:115], a[204:207], v[40:43]
ds_read_b64_tr_b16 a[110:111], v218 offset:21792
v_mul_f32 v192, s46, v192
v_mfma_f32_16x16x32_bf16 v[40:43], a[116:119], a[220:223], v[40:43]
v_mul_f32 v193, s46, v193
v_mul_f32 v194, s46, v194
v_mfma_f32_16x16x32_bf16 v[72:75], a[112:115], a[208:211], v[72:75]
s_waitcnt vmcnt(9)
buffer_load_dwordx4 v247, s[28:31], s45 offen offset:3168 nt lds
v_mfma_f32_16x16x32_bf16 v[72:75], a[116:119], a[224:227], v[72:75]
v_mul_f32 v195, s46, v195
v_mul_f32 v196, s46, v196
v_mfma_f32_16x16x32_bf16 v[104:107], a[112:115], a[212:215], v[104:107]
ds_read_b64_tr_b16 a[112:113], v219 offset:17024
v_mul_f32 v197, s46, v197
v_mfma_f32_16x16x32_bf16 v[104:107], a[116:119], a[228:231], v[104:107]
ds_read_b64_tr_b16 a[114:115], v219 offset:17536
v_mul_f32 v198, s46, v198
v_mfma_f32_16x16x32_bf16 v[12:15], a[120:123], a[200:203], v[12:15]
ds_read_b64_tr_b16 a[116:117], v219 offset:21248
v_mul_f32 v199, s46, v199
v_mfma_f32_16x16x32_bf16 v[12:15], a[124:127], a[216:219], v[12:15]
ds_read_b64_tr_b16 a[118:119], v219 offset:21760
v_cvt_pk_bf16_f32 v208, v192, v193
v_mfma_f32_16x16x32_bf16 v[44:47], a[120:123], a[204:207], v[44:47]
v_cvt_pk_bf16_f32 v210, v196, v197
v_cvt_pk_bf16_f32 v209, v194, v195
v_mfma_f32_16x16x32_bf16 v[44:47], a[124:127], a[220:223], v[44:47]
v_cvt_pk_bf16_f32 v211, v198, v199
v_mfma_f32_16x16x32_bf16 v[76:79], a[120:123], a[208:211], v[76:79]
v_permlane32_swap_b32 v208, v210
v_mfma_f32_16x16x32_bf16 v[76:79], a[124:127], a[224:227], v[76:79]
v_permlane32_swap_b32 v209, v211
v_mfma_f32_16x16x32_bf16 v[108:111], a[120:123], a[212:215], v[108:111]
ds_read_b64_tr_b16 a[120:121], v219 offset:17056
v_mul_f32 v0, s46, v0
v_mfma_f32_16x16x32_bf16 v[108:111], a[124:127], a[228:231], v[108:111]
s_waitcnt lgkmcnt(2)
ds_read_b64_tr_b16 a[122:123], v219 offset:17568
v_mul_f32 v1, s46, v1
v_mfma_f32_16x16x32_bf16 v[16:19], a[96:99], a[128:131], v[16:19]
ds_read_b64_tr_b16 a[124:125], v219 offset:21280
v_mul_f32 v2, s46, v2
v_mfma_f32_16x16x32_bf16 v[16:19], a[100:103], a[144:147], v[16:19]
ds_read_b64_tr_b16 a[126:127], v219 offset:21792
v_mul_f32 v3, s46, v3
v_mfma_f32_16x16x32_bf16 v[48:51], a[96:99], a[132:135], v[48:51]
v_mul_f32 v4, s46, v4
v_mul_f32 v5, s46, v5
v_mfma_f32_16x16x32_bf16 v[48:51], a[100:103], a[148:151], v[48:51]
v_mul_f32 v6, s46, v6
v_mul_f32 v7, s46, v7
v_mfma_f32_16x16x32_bf16 v[80:83], a[96:99], a[136:139], v[80:83]
v_cvt_pk_bf16_f32 v128, v0, v1
v_cvt_pk_bf16_f32 v130, v4, v5
v_mfma_f32_16x16x32_bf16 v[80:83], a[100:103], a[152:155], v[80:83]
v_cvt_pk_bf16_f32 v129, v2, v3
v_cvt_pk_bf16_f32 v131, v6, v7
v_mfma_f32_16x16x32_bf16 v[112:115], a[96:99], a[140:143], v[112:115]
v_permlane32_swap_b32 v128, v130
v_mfma_f32_16x16x32_bf16 v[112:115], a[100:103], a[156:159], v[112:115]
v_permlane32_swap_b32 v129, v131
v_mfma_f32_16x16x32_bf16 v[200:203], a[96:99], a[232:235], v[200:203]
v_mul_f32 v32, s46, v32
v_mul_f32 v33, s46, v33
v_mfma_f32_16x16x32_bf16 v[200:203], a[100:103], a[236:239], v[200:203]
s_waitcnt vmcnt(24) lgkmcnt(0)
s_barrier
s_add_u32 m0, s44, 102144
v_mfma_f32_16x16x32_bf16 v[20:23], a[104:107], a[128:131], v[20:23]
s_xor_b32 s45, s47, 16384
s_waitcnt vmcnt(8)
buffer_load_dwordx4 v244, s[32:35], s45 offen offset:0 nt lds
v_mfma_f32_16x16x32_bf16 v[20:23], a[108:111], a[144:147], v[20:23]
ds_read_b64_tr_b16 a[96:97], v218 offset:51072
v_mul_f32 v34, s46, v34
v_mfma_f32_16x16x32_bf16 v[52:55], a[104:107], a[132:135], v[52:55]
ds_read_b64_tr_b16 a[98:99], v218 offset:51584
v_mul_f32 v35, s46, v35
v_mfma_f32_16x16x32_bf16 v[52:55], a[108:111], a[148:151], v[52:55]
ds_read_b64_tr_b16 a[100:101], v218 offset:55296
v_mul_f32 v36, s46, v36
v_mfma_f32_16x16x32_bf16 v[84:87], a[104:107], a[136:139], v[84:87]
ds_read_b64_tr_b16 a[102:103], v218 offset:55808
v_mul_f32 v37, s46, v37
v_mfma_f32_16x16x32_bf16 v[84:87], a[108:111], a[152:155], v[84:87]
v_mul_f32 v38, s46, v38
v_mul_f32 v39, s46, v39
v_mfma_f32_16x16x32_bf16 v[116:119], a[104:107], a[140:143], v[116:119]
v_cvt_pk_bf16_f32 v144, v32, v33
v_cvt_pk_bf16_f32 v146, v36, v37
v_mfma_f32_16x16x32_bf16 v[116:119], a[108:111], a[156:159], v[116:119]
v_cvt_pk_bf16_f32 v145, v34, v35
v_cvt_pk_bf16_f32 v147, v38, v39
v_mfma_f32_16x16x32_bf16 v[204:207], a[104:107], a[232:235], v[204:207]
s_waitcnt vmcnt(8)
buffer_load_dwordx4 v245, s[32:35], s45 offen offset:1056 nt lds
v_mfma_f32_16x16x32_bf16 v[204:207], a[108:111], a[236:239], v[204:207]
ds_read_b64_tr_b16 a[104:105], v218 offset:51104
v_mfma_f32_16x16x32_bf16 v[24:27], a[112:115], a[128:131], v[24:27]
ds_read_b64_tr_b16 a[106:107], v218 offset:51616
v_mfma_f32_16x16x32_bf16 v[24:27], a[116:119], a[144:147], v[24:27]
ds_read_b64_tr_b16 a[108:109], v218 offset:55328
v_mfma_f32_16x16x32_bf16 v[56:59], a[112:115], a[132:135], v[56:59]
ds_read_b64_tr_b16 a[110:111], v218 offset:55840
v_mfma_f32_16x16x32_bf16 v[56:59], a[116:119], a[148:151], v[56:59]
v_permlane32_swap_b32 v144, v146
v_mfma_f32_16x16x32_bf16 v[88:91], a[112:115], a[136:139], v[88:91]
v_permlane32_swap_b32 v145, v147
v_mfma_f32_16x16x32_bf16 v[88:91], a[116:119], a[152:155], v[88:91]
v_mul_f32 v64, s46, v64
v_mul_f32 v65, s46, v65
v_mfma_f32_16x16x32_bf16 v[120:123], a[112:115], a[140:143], v[120:123]
ds_read_b64_tr_b16 a[112:113], v219 offset:51072
v_mul_f32 v66, s46, v66
v_mfma_f32_16x16x32_bf16 v[120:123], a[116:119], a[156:159], v[120:123]
s_waitcnt vmcnt(8)
buffer_load_dwordx4 v246, s[32:35], s45 offen offset:2112 nt lds
v_mfma_f32_16x16x32_bf16 v[28:31], a[120:123], a[128:131], v[28:31]
ds_read_b64_tr_b16 a[114:115], v219 offset:51584
v_mul_f32 v67, s46, v67
v_mfma_f32_16x16x32_bf16 v[28:31], a[124:127], a[144:147], v[28:31]
ds_read_b64_tr_b16 a[116:117], v219 offset:55296
v_mul_f32 v68, s46, v68
v_mfma_f32_16x16x32_bf16 v[60:63], a[120:123], a[132:135], v[60:63]
ds_read_b64_tr_b16 a[118:119], v219 offset:55808
v_mul_f32 v69, s46, v69
v_mul_f32 v70, s46, v70
v_mfma_f32_16x16x32_bf16 v[60:63], a[124:127], a[148:151], v[60:63]
v_mul_f32 v71, s46, v71
v_cvt_pk_bf16_f32 v160, v64, v65
v_cvt_pk_bf16_f32 v162, v68, v69
v_mfma_f32_16x16x32_bf16 v[92:95], a[120:123], a[136:139], v[92:95]
v_cvt_pk_bf16_f32 v161, v66, v67
v_cvt_pk_bf16_f32 v163, v70, v71
v_permlane32_swap_b32 v160, v162
v_mfma_f32_16x16x32_bf16 v[92:95], a[124:127], a[152:155], v[92:95]
v_permlane32_swap_b32 v161, v163
v_mul_f32 v96, s46, v96
v_mul_f32 v97, s46, v97
v_mfma_f32_16x16x32_bf16 v[124:127], a[120:123], a[140:143], v[124:127]
ds_read_b64_tr_b16 a[120:121], v219 offset:51104
v_mul_f32 v98, s46, v98
v_mul_f32 v99, s46, v99
v_mfma_f32_16x16x32_bf16 v[124:127], a[124:127], a[156:159], v[124:127]
s_waitcnt lgkmcnt(3)
ds_read_b64_tr_b16 a[122:123], v219 offset:51616
v_mul_f32 v100, s46, v100
v_mul_f32 v101, s46, v101
v_mul_f32 v102, s46, v102
v_mfma_f32_16x16x32_bf16 v[200:203], a[96:99], a[240:243], v[200:203]
ds_read_b64_tr_b16 a[124:125], v219 offset:55328
v_mul_f32 v103, s46, v103
v_cvt_pk_bf16_f32 v176, v96, v97
v_cvt_pk_bf16_f32 v178, v100, v101
v_mfma_f32_16x16x32_bf16 v[200:203], a[100:103], a[244:247], v[200:203]
ds_read_b64_tr_b16 a[126:127], v219 offset:55840
v_cvt_pk_bf16_f32 v177, v98, v99
v_cvt_pk_bf16_f32 v179, v102, v103
v_permlane32_swap_b32 v176, v178
v_mfma_f32_16x16x32_bf16 v[204:207], a[104:107], a[240:243], v[204:207]
s_waitcnt vmcnt(8)
buffer_load_dwordx4 v247, s[32:35], s45 offen offset:3168 nt lds
v_permlane32_swap_b32 v177, v179
v_mfma_f32_16x16x32_bf16 v[204:207], a[108:111], a[244:247], v[204:207]
v_mul_f32 v8, s46, v8
v_mul_f32 v9, s46, v9
v_mul_f32 v10, s46, v10
v_mul_f32 v11, s46, v11
v_mul_f32 v12, s46, v12
v_mfma_f32_16x16x32_bf16 v[16:19], a[96:99], a[200:203], v[16:19]
v_mul_f32 v13, s46, v13
v_mul_f32 v14, s46, v14
v_mul_f32 v15, s46, v15
v_cvt_pk_bf16_f32 v132, v8, v9
v_mfma_f32_16x16x32_bf16 v[16:19], a[100:103], a[216:219], v[16:19]
v_cvt_pk_bf16_f32 v134, v12, v13
v_cvt_pk_bf16_f32 v133, v10, v11
v_cvt_pk_bf16_f32 v135, v14, v15
v_permlane32_swap_b32 v132, v134
v_mfma_f32_16x16x32_bf16 v[20:23], a[104:107], a[200:203], v[20:23]
s_add_u32 m0, s44, 119168
s_xor_b32 s45, s47, 24576
v_permlane32_swap_b32 v133, v135
v_mul_f32 v40, s46, v40
v_mfma_f32_16x16x32_bf16 v[20:23], a[108:111], a[216:219], v[20:23]
v_mul_f32 v41, s46, v41
v_mul_f32 v42, s46, v42
v_mul_f32 v43, s46, v43
v_mul_f32 v44, s46, v44
v_mul_f32 v45, s46, v45
v_mfma_f32_16x16x32_bf16 v[24:27], a[112:115], a[200:203], v[24:27]
s_waitcnt lgkmcnt(0)
v_mul_f32 v46, s46, v46
v_mul_f32 v47, s46, v47
v_cvt_pk_bf16_f32 v148, v40, v41
v_cvt_pk_bf16_f32 v150, v44, v45
v_cvt_pk_bf16_f32 v149, v42, v43
v_mfma_f32_16x16x32_bf16 v[24:27], a[116:119], a[216:219], v[24:27]
s_barrier
s_waitcnt vmcnt(8)
buffer_load_dwordx4 v244, s[32:35], s45 offen offset:0 nt lds
v_cvt_pk_bf16_f32 v151, v46, v47
v_permlane32_swap_b32 v148, v150
v_mfma_f32_16x16x32_bf16 v[28:31], a[120:123], a[200:203], v[28:31]
v_permlane32_swap_b32 v149, v151
v_mul_f32 v72, s46, v72
v_mul_f32 v73, s46, v73
v_mul_f32 v74, s46, v74
v_mfma_f32_16x16x32_bf16 v[28:31], a[124:127], a[216:219], v[28:31]
v_mul_f32 v75, s46, v75
v_mul_f32 v76, s46, v76
v_mul_f32 v77, s46, v77
v_mul_f32 v78, s46, v78
v_mfma_f32_16x16x32_bf16 v[48:51], a[96:99], a[204:207], v[48:51]
v_mul_f32 v79, s46, v79
v_cvt_pk_bf16_f32 v164, v72, v73
v_cvt_pk_bf16_f32 v166, v76, v77
v_cvt_pk_bf16_f32 v165, v74, v75
v_mfma_f32_16x16x32_bf16 v[48:51], a[100:103], a[220:223], v[48:51]
v_cvt_pk_bf16_f32 v167, v78, v79
v_permlane32_swap_b32 v164, v166
s_nop 0
v_permlane32_swap_b32 v165, v167
v_mfma_f32_16x16x32_bf16 v[52:55], a[104:107], a[204:207], v[52:55]
v_mul_f32 v104, s46, v104
v_mul_f32 v105, s46, v105
v_mul_f32 v106, s46, v106
v_mul_f32 v107, s46, v107
v_mfma_f32_16x16x32_bf16 v[52:55], a[108:111], a[220:223], v[52:55]
v_mul_f32 v108, s46, v108
v_mul_f32 v109, s46, v109
v_mul_f32 v110, s46, v110
v_mul_f32 v111, s46, v111
v_cvt_pk_bf16_f32 v180, v104, v105
v_mfma_f32_16x16x32_bf16 v[56:59], a[112:115], a[204:207], v[56:59]
s_waitcnt vmcnt(21)
s_barrier
ds_read_b128 a[0:3], v236 offset:0
v_cvt_pk_bf16_f32 v182, v108, v109
v_cvt_pk_bf16_f32 v181, v106, v107
v_mfma_f32_16x16x32_bf16 v[56:59], a[116:119], a[220:223], v[56:59]
ds_read_b128 a[4:7], v237 offset:0
v_cvt_pk_bf16_f32 v183, v110, v111
v_permlane32_swap_b32 v180, v182
s_nop 0
v_permlane32_swap_b32 v181, v183
v_mfma_f32_16x16x32_bf16 v[60:63], a[120:123], a[204:207], v[60:63]
s_waitcnt vmcnt(8)
buffer_load_dwordx4 v245, s[32:35], s45 offen offset:1056 nt lds
v_mul_f32 v200, s46, v200
v_mul_f32 v201, s46, v201
v_mfma_f32_16x16x32_bf16 v[60:63], a[124:127], a[220:223], v[60:63]
ds_read_b128 a[8:11], v236 offset:128
v_mul_f32 v202, s46, v202
v_mul_f32 v203, s46, v203
v_mul_f32 v204, s46, v204
v_mfma_f32_16x16x32_bf16 v[80:83], a[96:99], a[208:211], v[80:83]
ds_read_b128 a[12:15], v237 offset:128
v_mul_f32 v205, s46, v205
v_mul_f32 v206, s46, v206
v_mul_f32 v207, s46, v207
v_cvt_pk_bf16_f32 v212, v200, v201
v_mfma_f32_16x16x32_bf16 v[80:83], a[100:103], a[224:227], v[80:83]
ds_read_b128 a[16:19], v236 offset:512
v_cvt_pk_bf16_f32 v214, v204, v205
v_cvt_pk_bf16_f32 v213, v202, v203
v_cvt_pk_bf16_f32 v215, v206, v207
v_mfma_f32_16x16x32_bf16 v[84:87], a[104:107], a[208:211], v[84:87]
ds_read_b128 a[20:23], v237 offset:512
ds_read_b128 a[24:27], v236 offset:640
v_permlane32_swap_b32 v212, v214
v_mfma_f32_16x16x32_bf16 v[84:87], a[108:111], a[224:227], v[84:87]
ds_read_b128 a[28:31], v237 offset:640
ds_read_b128 a[32:35], v238 offset:0
v_permlane32_swap_b32 v213, v215
v_mul_f32 v16, s46, v16
v_mfma_f32_16x16x32_bf16 v[88:91], a[112:115], a[208:211], v[88:91]
ds_write_b128 v234, v[208:211] offset:0
v_mul_f32 v17, s46, v17
v_mul_f32 v18, s46, v18
v_mul_f32 v19, s46, v19
v_mfma_f32_16x16x32_bf16 v[88:91], a[116:119], a[224:227], v[88:91]
v_mul_f32 v20, s46, v20
v_mul_f32 v21, s46, v21
v_mul_f32 v22, s46, v22
v_mul_f32 v23, s46, v23
v_mfma_f32_16x16x32_bf16 v[92:95], a[120:123], a[208:211], v[92:95]
ds_read_b128 a[36:39], v239 offset:0
ds_read_b128 a[40:43], v238 offset:128
v_cvt_pk_bf16_f32 v136, v16, v17
v_cvt_pk_bf16_f32 v138, v20, v21
v_cvt_pk_bf16_f32 v137, v18, v19
v_mfma_f32_16x16x32_bf16 v[92:95], a[124:127], a[224:227], v[92:95]
s_waitcnt vmcnt(8)
buffer_load_dwordx4 v246, s[32:35], s45 offen offset:2112 nt lds
ds_read_b128 a[44:47], v239 offset:128
v_cvt_pk_bf16_f32 v139, v22, v23
v_mfma_f32_16x16x32_bf16 v[112:115], a[96:99], a[212:215], v[112:115]
ds_write_b128 v234, v[212:215] offset:1024
v_permlane32_swap_b32 v136, v138
v_permlane32_swap_b32 v137, v139
v_mfma_f32_16x16x32_bf16 v[112:115], a[100:103], a[228:231], v[112:115]
v_mul_f32 v24, s46, v24
v_mul_f32 v25, s46, v25
v_mul_f32 v26, s46, v26
v_mul_f32 v27, s46, v27
v_mfma_f32_16x16x32_bf16 v[116:119], a[104:107], a[212:215], v[116:119]
ds_read_b128 a[48:51], v238 offset:512
ds_read_b128 a[52:55], v239 offset:512
v_mul_f32 v28, s46, v28
v_mul_f32 v29, s46, v29
v_mul_f32 v30, s46, v30
v_mfma_f32_16x16x32_bf16 v[116:119], a[108:111], a[228:231], v[116:119]
ds_read_b128 a[56:59], v238 offset:640
ds_read_b128 a[60:63], v239 offset:640
v_mul_f32 v31, s46, v31
v_cvt_pk_bf16_f32 v140, v24, v25
v_mfma_f32_16x16x32_bf16 v[120:123], a[112:115], a[212:215], v[120:123]
v_cvt_pk_bf16_f32 v142, v28, v29
v_cvt_pk_bf16_f32 v141, v26, v27
v_cvt_pk_bf16_f32 v143, v30, v31
v_permlane32_swap_b32 v140, v142
v_mfma_f32_16x16x32_bf16 v[120:123], a[116:119], a[228:231], v[120:123]
v_permlane32_swap_b32 v141, v143
v_mul_f32 v48, s46, v48
v_mul_f32 v49, s46, v49
v_mfma_f32_16x16x32_bf16 v[124:127], a[120:123], a[212:215], v[124:127]
v_mul_f32 v50, s46, v50
v_mul_f32 v51, s46, v51
v_mul_f32 v52, s46, v52
v_mul_f32 v53, s46, v53
v_mul_f32 v54, s46, v54
v_mfma_f32_16x16x32_bf16 v[124:127], a[124:127], a[228:231], v[124:127]
s_waitcnt lgkmcnt(4)
v_mul_f32 v55, s46, v55
v_cvt_pk_bf16_f32 v152, v48, v49
v_cvt_pk_bf16_f32 v154, v52, v53
v_cvt_pk_bf16_f32 v153, v50, v51
v_mfma_f32_16x16x32_bf16 v[216:219], a[0:3], v[128:131], 0
v_cvt_pk_bf16_f32 v155, v54, v55
v_permlane32_swap_b32 v152, v154
s_nop 0
v_permlane32_swap_b32 v153, v155
v_mfma_f32_16x16x32_bf16 v[216:219], a[4:7], v[132:135], v[216:219]
s_waitcnt vmcnt(15) lgkmcnt(0)
s_barrier
ds_read_b64_tr_b16 a[64:65], v240 offset:0
ds_read_b64_tr_b16 a[66:67], v240 offset:512
v_mul_f32 v56, s46, v56
v_mfma_f32_16x16x32_bf16 v[216:219], a[8:11], v[136:139], v[216:219]
ds_read_b64_tr_b16 a[68:69], v240 offset:32
ds_read_b64_tr_b16 a[70:71], v240 offset:544
v_mul_f32 v57, s46, v57
v_mul_f32 v58, s46, v58
v_mul_f32 v59, s46, v59
v_mfma_f32_16x16x32_bf16 v[216:219], a[12:15], v[140:143], v[216:219]
ds_read_b64_tr_b16 a[72:73], v240 offset:64
ds_read_b64_tr_b16 a[74:75], v240 offset:576
v_mul_f32 v60, s46, v60
v_mul_f32 v61, s46, v61
v_mul_f32 v62, s46, v62
v_mfma_f32_16x16x32_bf16 v[220:223], a[0:3], v[144:147], 0
ds_read_b64_tr_b16 a[76:77], v240 offset:96
ds_read_b64_tr_b16 a[78:79], v240 offset:608
v_mul_f32 v63, s46, v63
v_cvt_pk_bf16_f32 v156, v56, v57
v_cvt_pk_bf16_f32 v158, v60, v61
v_mfma_f32_16x16x32_bf16 v[220:223], a[4:7], v[148:151], v[220:223]
ds_read_b64_tr_b16 a[80:81], v241 offset:0
ds_read_b64_tr_b16 a[82:83], v241 offset:512
v_cvt_pk_bf16_f32 v157, v58, v59
v_cvt_pk_bf16_f32 v159, v62, v63
v_permlane32_swap_b32 v156, v158
s_nop 0
v_permlane32_swap_b32 v157, v159
v_mfma_f32_16x16x32_bf16 v[220:223], a[8:11], v[152:155], v[220:223]
ds_read_b64_tr_b16 a[84:85], v241 offset:32
ds_read_b64_tr_b16 a[86:87], v241 offset:544
v_accvgpr_read_b32 v255, a248
v_max3_f32 v216, v216, v217, v255
v_max3_f32 v216, v216, v218, v219
v_mov_b32 v217, v216
v_mfma_f32_16x16x32_bf16 v[220:223], a[12:15], v[156:159], v[220:223]
ds_read_b64_tr_b16 a[88:89], v241 offset:64
ds_read_b64_tr_b16 a[90:91], v241 offset:576
v_permlane32_swap_b32 v216, v217
v_max_f32 v216, v216, v217
v_mov_b32 v217, v216
s_nop 1
v_permlane16_swap_b32 v216, v217
v_min_f32_e64 v216, -v216, -v217
v_mov_b32 v217, v216
v_mov_b64 v[218:219], v[216:217]
s_nop 1
v_mfma_f32_16x16x32_bf16 v[192:195], a[0:3], v[128:131], v[216:219]
s_waitcnt vmcnt(8)
buffer_load_dwordx4 v247, s[32:35], s45 offen offset:3168 nt lds
v_mul_f32 v80, s46, v80
v_mul_f32 v81, s46, v81
v_mfma_f32_16x16x32_bf16 v[192:195], a[4:7], v[132:135], v[192:195]
ds_read_b64_tr_b16 a[92:93], v241 offset:96
v_mul_f32 v82, s46, v82
v_mul_f32 v83, s46, v83
v_mul_f32 v84, s46, v84
v_mfma_f32_16x16x32_bf16 v[192:195], a[8:11], v[136:139], v[192:195]
ds_read_b64_tr_b16 a[94:95], v241 offset:608
v_mul_f32 v85, s46, v85
v_mul_f32 v86, s46, v86
v_mfma_f32_16x16x32_bf16 v[192:195], a[12:15], v[140:143], v[192:195]
ds_read_b64_tr_b16 a[96:97], v242 offset:0
v_mul_f32 v87, s46, v87
v_cvt_pk_bf16_f32 v168, v80, v81
v_cvt_pk_bf16_f32 v170, v84, v85
v_mfma_f32_16x16x32_bf16 v[196:199], a[16:19], v[128:131], v[216:219]
ds_read_b64_tr_b16 a[98:99], v242 offset:512
v_cvt_pk_bf16_f32 v169, v82, v83
v_cvt_pk_bf16_f32 v171, v86, v87
v_accvgpr_read_b32 v255, a249
v_mfma_f32_16x16x32_bf16 v[196:199], a[20:23], v[132:135], v[196:199]
ds_read_b64_tr_b16 a[100:101], v242 offset:32
v_permlane32_swap_b32 v168, v170
v_max3_f32 v220, v220, v221, v255
v_mfma_f32_16x16x32_bf16 v[196:199], a[24:27], v[136:139], v[196:199]
ds_read_b64_tr_b16 a[102:103], v242 offset:544
v_permlane32_swap_b32 v169, v171
v_mfma_f32_16x16x32_bf16 v[196:199], a[28:31], v[140:143], v[196:199]
ds_read_b64_tr_b16 a[104:105], v242 offset:64
v_mul_f32 v88, s46, v88
v_mul_f32 v89, s46, v89
v_mul_f32 v90, s46, v90
v_mfma_f32_16x16x32_bf16 v[200:203], a[32:35], v[128:131], v[216:219]
ds_read_b64_tr_b16 a[106:107], v242 offset:576
v_mul_f32 v91, s46, v91
v_mul_f32 v92, s46, v92
v_mul_f32 v93, s46, v93
v_mfma_f32_16x16x32_bf16 v[200:203], a[36:39], v[132:135], v[200:203]
ds_read_b64_tr_b16 a[108:109], v242 offset:96
v_mul_f32 v94, s46, v94
v_mul_f32 v95, s46, v95
v_cvt_pk_bf16_f32 v172, v88, v89
v_mfma_f32_16x16x32_bf16 v[200:203], a[40:43], v[136:139], v[200:203]
ds_read_b64_tr_b16 a[110:111], v242 offset:608
v_cvt_pk_bf16_f32 v174, v92, v93
v_cvt_pk_bf16_f32 v173, v90, v91
v_mfma_f32_16x16x32_bf16 v[200:203], a[44:47], v[140:143], v[200:203]
ds_read_b64_tr_b16 a[112:113], v243 offset:0
v_cvt_pk_bf16_f32 v175, v94, v95
v_permlane32_swap_b32 v172, v174
v_mfma_f32_16x16x32_bf16 v[204:207], a[48:51], v[128:131], v[216:219]
ds_read_b64_tr_b16 a[114:115], v243 offset:512
v_permlane32_swap_b32 v173, v175
v_max3_f32 v220, v220, v222, v223
v_mfma_f32_16x16x32_bf16 v[204:207], a[52:55], v[132:135], v[204:207]
ds_read_b64_tr_b16 a[116:117], v243 offset:32
v_exp_f32 v192, v192
v_mov_b32 v221, v220
v_mfma_f32_16x16x32_bf16 v[204:207], a[56:59], v[136:139], v[204:207]
ds_read_b64_tr_b16 a[118:119], v243 offset:544
v_exp_f32 v193, v193
v_mfma_f32_16x16x32_bf16 v[204:207], a[60:63], v[140:143], v[204:207]
ds_read_b64_tr_b16 a[120:121], v243 offset:64
v_exp_f32 v194, v194
v_cvt_pk_bf16_f32 v208, v192, v193
v_mfma_f32_16x16x32_bf16 v[224:227], a[0:3], v[160:163], 0
ds_read_b64_tr_b16 a[122:123], v243 offset:576
v_exp_f32 v195, v195
s_nop 0
v_cvt_pk_bf16_f32 v209, v194, v195
v_mfma_f32_16x16x32_bf16 v[224:227], a[4:7], v[164:167], v[224:227]
ds_read_b64_tr_b16 a[124:125], v243 offset:96
v_permlane32_swap_b32 v220, v221
v_mfma_f32_16x16x32_bf16 v[224:227], a[8:11], v[168:171], v[224:227]
ds_read_b64_tr_b16 a[126:127], v243 offset:608
v_max_f32 v220, v220, v221
v_mov_b32 v221, v220
v_mul_f32 v112, s46, v112
v_mfma_f32_16x16x32_bf16 v[224:227], a[12:15], v[172:175], v[224:227]
ds_read_b128 a[180:183], v234 offset:0
v_permlane16_swap_b32 v220, v221
v_min_f32_e64 v220, -v220, -v221
v_mov_b32 v221, v220
v_mov_b64 v[222:223], v[220:221]
s_nop 1
v_mfma_f32_16x16x32_bf16 v[192:195], a[0:3], v[144:147], v[220:223]
ds_read_b128 a[184:187], v235 offset:0
v_exp_f32 v196, v196
v_mfma_f32_16x16x32_bf16 v[192:195], a[4:7], v[148:151], v[192:195]
ds_read_b128 a[188:191], v234 offset:1024
v_exp_f32 v197, v197
s_nop 0
v_cvt_pk_bf16_f32 v210, v196, v197
v_mfma_f32_16x16x32_bf16 v[192:195], a[8:11], v[152:155], v[192:195]
ds_read_b128 a[192:195], v235 offset:1024
v_exp_f32 v198, v198
v_exp_f32 v199, v199
v_mfma_f32_16x16x32_bf16 v[192:195], a[12:15], v[156:159], v[192:195]
s_waitcnt lgkmcnt(0)
s_barrier
v_cvt_pk_bf16_f32 v211, v198, v199
s_add_u32 m0, s44, 0
v_mfma_f32_16x16x32_bf16 v[196:199], a[16:19], v[144:147], v[220:223]
s_xor_b32 s45, s47, 32768
v_exp_f32 v200, v200
v_mfma_f32_16x16x32_bf16 v[196:199], a[20:23], v[148:151], v[196:199]
v_exp_f32 v201, v201
s_nop 0
v_cvt_pk_bf16_f32 v212, v200, v201
v_mfma_f32_16x16x32_bf16 v[196:199], a[24:27], v[152:155], v[196:199]
v_exp_f32 v202, v202
v_exp_f32 v203, v203
v_mfma_f32_16x16x32_bf16 v[196:199], a[28:31], v[156:159], v[196:199]
v_cvt_pk_bf16_f32 v213, v202, v203
v_exp_f32 v204, v204
v_mfma_f32_16x16x32_bf16 v[200:203], a[32:35], v[144:147], v[220:223]
v_exp_f32 v205, v205
v_mfma_f32_16x16x32_bf16 v[200:203], a[36:39], v[148:151], v[200:203]
v_exp_f32 v206, v206
v_cvt_pk_bf16_f32 v214, v204, v205
v_mfma_f32_16x16x32_bf16 v[200:203], a[40:43], v[152:155], v[200:203]
v_exp_f32 v207, v207
v_mfma_f32_16x16x32_bf16 v[200:203], a[44:47], v[156:159], v[200:203]
v_cvt_pk_bf16_f32 v215, v206, v207
v_mul_f32 v113, s46, v113
v_mfma_f32_16x16x32_bf16 v[204:207], a[48:51], v[144:147], v[220:223]
s_waitcnt vmcnt(5)
buffer_load_dwordx4 v244, s[28:31], s45 offen offset:0 nt lds
v_mul_f32 v114, s46, v114
v_mfma_f32_16x16x32_bf16 v[204:207], a[52:55], v[148:151], v[204:207]
v_mul_f32 v115, s46, v115
v_mul_f32 v116, s46, v116
v_mfma_f32_16x16x32_bf16 v[204:207], a[56:59], v[152:155], v[204:207]
s_waitcnt vmcnt(5)
buffer_load_dwordx4 v245, s[28:31], s45 offen offset:1056 nt lds
v_mul_f32 v117, s46, v117
v_mfma_f32_16x16x32_bf16 v[204:207], a[60:63], v[156:159], v[204:207]
v_mul_f32 v118, s46, v118
v_mul_f32 v119, s46, v119
v_mfma_f32_16x16x32_bf16 a[160:163], a[196:199], v[208:211], 0
v_cvt_pk_bf16_f32 v184, v112, v113
v_cvt_pk_bf16_f32 v186, v116, v117
v_mfma_f32_16x16x32_bf16 a[160:163], a[196:199], v[212:215], a[160:163]
v_cvt_pk_bf16_f32 v185, v114, v115
v_cvt_pk_bf16_f32 v187, v118, v119
v_accvgpr_read_b32 v255, a250
v_mfma_f32_16x16x32_bf16 v[0:3], a[64:67], v[208:211], 0
v_permlane32_swap_b32 v184, v186
v_mfma_f32_16x16x32_bf16 v[0:3], a[96:99], v[212:215], v[0:3]
v_permlane32_swap_b32 v185, v187
v_mul_f32 v120, s46, v120
v_mfma_f32_16x16x32_bf16 v[4:7], a[68:71], v[208:211], 0
v_mul_f32 v121, s46, v121
v_mul_f32 v122, s46, v122
v_mfma_f32_16x16x32_bf16 v[4:7], a[100:103], v[212:215], v[4:7]
v_mul_f32 v123, s46, v123
v_mul_f32 v124, s46, v124
v_mfma_f32_16x16x32_bf16 v[8:11], a[72:75], v[208:211], 0
v_mul_f32 v125, s46, v125
v_mul_f32 v126, s46, v126
v_mul_f32 v127, s46, v127
v_mfma_f32_16x16x32_bf16 v[8:11], a[104:107], v[212:215], v[8:11]
v_cvt_pk_bf16_f32 v188, v120, v121
v_cvt_pk_bf16_f32 v190, v124, v125
v_mfma_f32_16x16x32_bf16 v[12:15], a[76:79], v[208:211], 0
v_cvt_pk_bf16_f32 v189, v122, v123
v_cvt_pk_bf16_f32 v191, v126, v127
v_mfma_f32_16x16x32_bf16 v[12:15], a[108:111], v[212:215], v[12:15]
v_permlane32_swap_b32 v188, v190
v_max3_f32 v224, v224, v225, v255
v_mfma_f32_16x16x32_bf16 v[16:19], a[80:83], v[208:211], 0
v_permlane32_swap_b32 v189, v191
v_mfma_f32_16x16x32_bf16 v[16:19], a[112:115], v[212:215], v[16:19]
s_waitcnt vmcnt(5)
buffer_load_dwordx4 v246, s[28:31], s45 offen offset:2112 nt lds
v_max3_f32 v224, v224, v226, v227
v_mfma_f32_16x16x32_bf16 v[20:23], a[84:87], v[208:211], 0
v_exp_f32 v192, v192
v_mfma_f32_16x16x32_bf16 v[20:23], a[116:119], v[212:215], v[20:23]
v_exp_f32 v193, v193
v_mfma_f32_16x16x32_bf16 v[24:27], a[88:91], v[208:211], 0
v_exp_f32 v194, v194
v_mov_b32 v225, v224
v_mfma_f32_16x16x32_bf16 v[24:27], a[120:123], v[212:215], v[24:27]
v_exp_f32 v195, v195
v_mfma_f32_16x16x32_bf16 v[28:31], a[92:95], v[208:211], 0
v_permlane32_swap_b32 v224, v225
v_max_f32 v224, v224, v225
v_mfma_f32_16x16x32_bf16 v[28:31], a[124:127], v[212:215], v[28:31]
v_mov_b32 v225, v224
v_cvt_pk_bf16_f32 v248, v192, v193
v_mfma_f32_16x16x32_bf16 v[228:231], a[0:3], v[176:179], 0
v_permlane16_swap_b32 v224, v225
v_mfma_f32_16x16x32_bf16 v[228:231], a[4:7], v[180:183], v[228:231]
v_min_f32_e64 v224, -v224, -v225
v_mov_b32 v225, v224
v_mov_b64 v[226:227], v[224:225]
v_mfma_f32_16x16x32_bf16 v[228:231], a[8:11], v[184:187], v[228:231]
v_cvt_pk_bf16_f32 v249, v194, v195
v_exp_f32 v196, v196
v_mfma_f32_16x16x32_bf16 v[228:231], a[12:15], v[188:191], v[228:231]
v_exp_f32 v197, v197
s_nop 0
v_cvt_pk_bf16_f32 v250, v196, v197
v_mfma_f32_16x16x32_bf16 v[192:195], a[0:3], v[160:163], v[224:227]
v_exp_f32 v198, v198
v_mfma_f32_16x16x32_bf16 v[192:195], a[4:7], v[164:167], v[192:195]
v_exp_f32 v199, v199
v_mfma_f32_16x16x32_bf16 v[192:195], a[8:11], v[168:171], v[192:195]
v_cvt_pk_bf16_f32 v251, v198, v199
v_exp_f32 v200, v200
v_mfma_f32_16x16x32_bf16 v[192:195], a[12:15], v[172:175], v[192:195]
v_exp_f32 v201, v201
v_mfma_f32_16x16x32_bf16 v[196:199], a[16:19], v[160:163], v[224:227]
v_exp_f32 v202, v202
v_mfma_f32_16x16x32_bf16 v[196:199], a[20:23], v[164:167], v[196:199]
v_exp_f32 v203, v203
v_mfma_f32_16x16x32_bf16 v[196:199], a[24:27], v[168:171], v[196:199]
v_cvt_pk_bf16_f32 v208, v200, v201
v_cvt_pk_bf16_f32 v209, v202, v203
v_accvgpr_read_b32 v255, a251
v_mfma_f32_16x16x32_bf16 v[196:199], a[28:31], v[172:175], v[196:199]
s_waitcnt vmcnt(5)
buffer_load_dwordx4 v247, s[28:31], s45 offen offset:3168 nt lds
v_mfma_f32_16x16x32_bf16 v[200:203], a[32:35], v[160:163], v[224:227]
s_add_u32 m0, s44, 17024
v_exp_f32 v204, v204
s_xor_b32 s45, s47, 40960
v_mfma_f32_16x16x32_bf16 v[200:203], a[36:39], v[164:167], v[200:203]
s_cmp_lg_u32 0, 0
Lisl3_0:
s_cbranch_scc1 Lisl3_1
v_exp_f32 v205, v205
s_nop 0
v_cvt_pk_bf16_f32 v210, v204, v205
v_mfma_f32_16x16x32_bf16 v[200:203], a[40:43], v[168:171], v[200:203]
v_exp_f32 v206, v206
v_exp_f32 v207, v207
v_mfma_f32_16x16x32_bf16 v[200:203], a[44:47], v[172:175], v[200:203]
v_cvt_pk_bf16_f32 v211, v206, v207
v_max3_f32 v228, v228, v229, v255
v_mfma_f32_16x16x32_bf16 v[204:207], a[48:51], v[160:163], v[224:227]
s_waitcnt vmcnt(5)
buffer_load_dwordx4 v244, s[28:31], s45 offen offset:0 nt lds
v_mfma_f32_16x16x32_bf16 v[204:207], a[52:55], v[164:167], v[204:207]
v_exp_f32 v192, v192
v_mfma_f32_16x16x32_bf16 v[204:207], a[56:59], v[168:171], v[204:207]
v_exp_f32 v193, v193
v_mfma_f32_16x16x32_bf16 v[204:207], a[60:63], v[172:175], v[204:207]
s_cmp_lg_u32 0, 0
Lisl3_1:
s_cbranch_scc1 Lret0
v_exp_f32 v194, v194
v_mfma_f32_16x16x32_bf16 a[164:167], a[196:199], v[248:251], 0
v_exp_f32 v195, v195
v_mfma_f32_16x16x32_bf16 a[164:167], a[196:199], v[208:211], a[164:167]
v_max3_f32 v228, v228, v230, v231
v_mov_b32 v229, v228
v_mfma_f32_16x16x32_bf16 v[32:35], a[64:67], v[248:251], 0
s_nop 0
v_permlane32_swap_b32 v228, v229
v_mfma_f32_16x16x32_bf16 v[32:35], a[96:99], v[208:211], v[32:35]
v_max_f32 v228, v228, v229
v_mov_b32 v229, v228
v_mfma_f32_16x16x32_bf16 v[36:39], a[68:71], v[248:251], 0
s_nop 0
v_permlane16_swap_b32 v228, v229
v_mfma_f32_16x16x32_bf16 v[36:39], a[100:103], v[208:211], v[36:39]
s_waitcnt vmcnt(5)
buffer_load_dwordx4 v245, s[28:31], s45 offen offset:1056 nt lds
v_mfma_f32_16x16x32_bf16 v[40:43], a[72:75], v[248:251], 0
v_min_f32_e64 v228, -v228, -v229
v_mov_b32 v229, v228
v_mfma_f32_16x16x32_bf16 v[40:43], a[104:107], v[208:211], v[40:43]
v_mov_b64 v[230:231], v[228:229]
v_cvt_pk_bf16_f32 v212, v192, v193
v_mfma_f32_16x16x32_bf16 v[44:47], a[76:79], v[248:251], 0
v_cvt_pk_bf16_f32 v213, v194, v195
v_mfma_f32_16x16x32_bf16 v[44:47], a[108:111], v[208:211], v[44:47]
v_exp_f32 v196, v196
v_mfma_f32_16x16x32_bf16 v[48:51], a[80:83], v[248:251], 0
v_exp_f32 v197, v197
v_mfma_f32_16x16x32_bf16 v[48:51], a[112:115], v[208:211], v[48:51]
v_exp_f32 v198, v198
v_mfma_f32_16x16x32_bf16 v[52:55], a[84:87], v[248:251], 0
v_exp_f32 v199, v199
v_mfma_f32_16x16x32_bf16 v[52:55], a[116:119], v[208:211], v[52:55]
v_cvt_pk_bf16_f32 v214, v196, v197
v_cvt_pk_bf16_f32 v215, v198, v199
v_mfma_f32_16x16x32_bf16 v[56:59], a[88:91], v[248:251], 0
v_exp_f32 v200, v200
v_mfma_f32_16x16x32_bf16 v[56:59], a[120:123], v[208:211], v[56:59]
v_exp_f32 v201, v201
v_mfma_f32_16x16x32_bf16 v[60:63], a[92:95], v[248:251], 0
s_waitcnt vmcnt(5)
buffer_load_dwordx4 v246, s[28:31], s45 offen offset:2112 nt lds
v_mfma_f32_16x16x32_bf16 v[60:63], a[124:127], v[208:211], v[60:63]
v_exp_f32 v202, v202
v_mfma_f32_16x16x32_bf16 v[232:235], a[0:3], a[180:183], 0
v_exp_f32 v203, v203
v_mfma_f32_16x16x32_bf16 v[232:235], a[4:7], a[184:187], v[232:235]
v_cvt_pk_bf16_f32 v248, v200, v201
v_cvt_pk_bf16_f32 v249, v202, v203
v_mfma_f32_16x16x32_bf16 v[232:235], a[8:11], a[188:191], v[232:235]
v_exp_f32 v204, v204
v_mfma_f32_16x16x32_bf16 v[232:235], a[12:15], a[192:195], v[232:235]
v_exp_f32 v205, v205
v_mfma_f32_16x16x32_bf16 v[192:195], a[0:3], v[176:179], v[228:231]
v_exp_f32 v206, v206
v_mfma_f32_16x16x32_bf16 v[192:195], a[4:7], v[180:183], v[192:195]
v_exp_f32 v207, v207
v_mfma_f32_16x16x32_bf16 v[192:195], a[8:11], v[184:187], v[192:195]
v_cvt_pk_bf16_f32 v250, v204, v205
v_cvt_pk_bf16_f32 v251, v206, v207
v_mfma_f32_16x16x32_bf16 v[192:195], a[12:15], v[188:191], v[192:195]
v_accvgpr_read_b32 v255, a252
v_max3_f32 v232, v232, v233, v255
v_mfma_f32_16x16x32_bf16 v[196:199], a[16:19], v[176:179], v[228:231]
v_max3_f32 v232, v232, v234, v235
v_mov_b32 v233, v232
v_mfma_f32_16x16x32_bf16 v[196:199], a[20:23], v[180:183], v[196:199]
s_nop 0
v_permlane32_swap_b32 v232, v233
v_mfma_f32_16x16x32_bf16 v[196:199], a[24:27], v[184:187], v[196:199]
s_waitcnt vmcnt(5)
buffer_load_dwordx4 v247, s[28:31], s45 offen offset:3168 nt lds
v_mfma_f32_16x16x32_bf16 v[196:199], a[28:31], v[188:191], v[196:199]
v_exp_f32 v192, v192
v_mfma_f32_16x16x32_bf16 v[200:203], a[32:35], v[176:179], v[228:231]
v_exp_f32 v193, v193
v_mfma_f32_16x16x32_bf16 v[200:203], a[36:39], v[180:183], v[200:203]
v_exp_f32 v194, v194
v_mfma_f32_16x16x32_bf16 v[200:203], a[40:43], v[184:187], v[200:203]
v_exp_f32 v195, v195
v_mfma_f32_16x16x32_bf16 v[200:203], a[44:47], v[188:191], v[200:203]
v_max_f32 v232, v232, v233
v_mov_b32 v233, v232
v_mfma_f32_16x16x32_bf16 v[204:207], a[48:51], v[176:179], v[228:231]
s_nop 0
v_permlane16_swap_b32 v232, v233
v_mfma_f32_16x16x32_bf16 v[204:207], a[52:55], v[180:183], v[204:207]
v_min_f32_e64 v232, -v232, -v233
v_mov_b32 v233, v232
v_mfma_f32_16x16x32_bf16 v[204:207], a[56:59], v[184:187], v[204:207]
s_add_u32 m0, s44, 68096
s_xor_b32 s45, s47, 32768
v_mov_b64 v[234:235], v[232:233]
v_mfma_f32_16x16x32_bf16 v[204:207], a[60:63], v[188:191], v[204:207]
v_cvt_pk_bf16_f32 v208, v192, v193
v_cvt_pk_bf16_f32 v209, v194, v195
v_mfma_f32_16x16x32_bf16 a[168:171], a[196:199], v[212:215], 0
v_exp_f32 v196, v196
v_mfma_f32_16x16x32_bf16 a[168:171], a[196:199], v[248:251], a[168:171]
s_waitcnt vmcnt(5)
buffer_load_dwordx4 v244, s[32:35], s45 offen offset:0 nt lds
v_mfma_f32_16x16x32_bf16 v[64:67], a[64:67], v[212:215], 0
v_exp_f32 v197, v197
v_mfma_f32_16x16x32_bf16 v[64:67], a[96:99], v[248:251], v[64:67]
v_exp_f32 v198, v198
v_mfma_f32_16x16x32_bf16 v[68:71], a[68:71], v[212:215], 0
v_exp_f32 v199, v199
v_mfma_f32_16x16x32_bf16 v[68:71], a[100:103], v[248:251], v[68:71]
v_cvt_pk_bf16_f32 v210, v196, v197
v_cvt_pk_bf16_f32 v211, v198, v199
v_mfma_f32_16x16x32_bf16 v[72:75], a[72:75], v[212:215], 0
v_exp_f32 v200, v200
v_mfma_f32_16x16x32_bf16 v[72:75], a[104:107], v[248:251], v[72:75]
v_exp_f32 v201, v201
v_mfma_f32_16x16x32_bf16 v[76:79], a[76:79], v[212:215], 0
v_exp_f32 v202, v202
v_mfma_f32_16x16x32_bf16 v[76:79], a[108:111], v[248:251], v[76:79]
v_exp_f32 v203, v203
v_mfma_f32_16x16x32_bf16 v[80:83], a[80:83], v[212:215], 0
v_exp_f32 v204, v204
v_mfma_f32_16x16x32_bf16 v[80:83], a[112:115], v[248:251], v[80:83]
v_exp_f32 v205, v205
v_mfma_f32_16x16x32_bf16 v[84:87], a[84:87], v[212:215], 0
s_waitcnt vmcnt(5)
buffer_load_dwordx4 v245, s[32:35], s45 offen offset:1056 nt lds
v_mfma_f32_16x16x32_bf16 v[84:87], a[116:119], v[248:251], v[84:87]
v_exp_f32 v206, v206
v_mfma_f32_16x16x32_bf16 v[88:91], a[88:91], v[212:215], 0
v_exp_f32 v207, v207
v_mfma_f32_16x16x32_bf16 v[88:91], a[120:123], v[248:251], v[88:91]
v_mfma_f32_16x16x32_bf16 v[92:95], a[92:95], v[212:215], 0
v_mfma_f32_16x16x32_bf16 v[92:95], a[124:127], v[248:251], v[92:95]
s_waitcnt vmcnt(10)
s_barrier
v_cvt_pk_bf16_f32 v212, v200, v201
v_mfma_f32_16x16x32_bf16 v[192:195], a[0:3], a[180:183], v[232:235]
ds_read_b128 a[0:3], v236 offset:34048
v_cvt_pk_bf16_f32 v213, v202, v203
v_mfma_f32_16x16x32_bf16 v[192:195], a[4:7], a[184:187], v[192:195]
ds_read_b128 a[4:7], v237 offset:34048
v_cvt_pk_bf16_f32 v214, v204, v205
v_mfma_f32_16x16x32_bf16 v[192:195], a[8:11], a[188:191], v[192:195]
ds_read_b128 a[8:11], v236 offset:34176
v_cvt_pk_bf16_f32 v215, v206, v207
v_mfma_f32_16x16x32_bf16 v[192:195], a[12:15], a[192:195], v[192:195]
ds_read_b128 a[12:15], v237 offset:34176
v_mfma_f32_16x16x32_bf16 v[196:199], a[16:19], a[180:183], v[232:235]
ds_read_b128 a[16:19], v236 offset:34560
v_mfma_f32_16x16x32_bf16 v[196:199], a[20:23], a[184:187], v[196:199]
s_waitcnt vmcnt(5)
buffer_load_dwordx4 v246, s[32:35], s45 offen offset:2112 nt lds
v_mfma_f32_16x16x32_bf16 v[196:199], a[24:27], a[188:191], v[196:199]
ds_read_b128 a[20:23], v237 offset:34560
v_mfma_f32_16x16x32_bf16 v[196:199], a[28:31], a[192:195], v[196:199]
ds_read_b128 a[24:27], v236 offset:34688
v_mfma_f32_16x16x32_bf16 a[172:175], a[196:199], v[208:211], 0
ds_read_b128 a[28:31], v237 offset:34688
v_mfma_f32_16x16x32_bf16 a[172:175], a[196:199], v[212:215], a[172:175]
ds_read_b128 a[32:35], v238 offset:34048
v_mfma_f32_16x16x32_bf16 v[96:99], a[64:67], v[208:211], 0
ds_read_b128 a[36:39], v239 offset:34048
v_mfma_f32_16x16x32_bf16 v[96:99], a[96:99], v[212:215], v[96:99]
ds_read_b128 a[40:43], v238 offset:34176
v_mfma_f32_16x16x32_bf16 v[100:103], a[68:71], v[208:211], 0
ds_read_b128 a[44:47], v239 offset:34176
v_mfma_f32_16x16x32_bf16 v[100:103], a[100:103], v[212:215], v[100:103]
ds_read_b128 a[48:51], v238 offset:34560
v_mfma_f32_16x16x32_bf16 v[104:107], a[72:75], v[208:211], 0
v_exp_f32 v192, v192
v_mfma_f32_16x16x32_bf16 v[104:107], a[104:107], v[212:215], v[104:107]
v_exp_f32 v193, v193
v_mfma_f32_16x16x32_bf16 v[108:111], a[76:79], v[208:211], 0
v_exp_f32 v194, v194
v_mfma_f32_16x16x32_bf16 v[108:111], a[108:111], v[212:215], v[108:111]
s_waitcnt vmcnt(5)
buffer_load_dwordx4 v247, s[32:35], s45 offen offset:3168 nt lds
v_mfma_f32_16x16x32_bf16 v[112:115], a[80:83], v[208:211], 0
v_exp_f32 v195, v195
v_mfma_f32_16x16x32_bf16 v[112:115], a[112:115], v[212:215], v[112:115]
ds_read_b128 a[52:55], v239 offset:34560
v_cvt_pk_bf16_f32 v248, v192, v193
v_mfma_f32_16x16x32_bf16 v[116:119], a[84:87], v[208:211], 0
ds_read_b128 a[56:59], v238 offset:34688
v_cvt_pk_bf16_f32 v249, v194, v195
v_mfma_f32_16x16x32_bf16 v[116:119], a[116:119], v[212:215], v[116:119]
ds_read_b128 a[60:63], v239 offset:34688
v_mfma_f32_16x16x32_bf16 v[120:123], a[88:91], v[208:211], 0
v_exp_f32 v196, v196
v_mfma_f32_16x16x32_bf16 v[120:123], a[120:123], v[212:215], v[120:123]
v_exp_f32 v197, v197
v_mfma_f32_16x16x32_bf16 v[124:127], a[92:95], v[208:211], 0
v_exp_f32 v198, v198
v_mfma_f32_16x16x32_bf16 v[124:127], a[124:127], v[212:215], v[124:127]
s_waitcnt lgkmcnt(3)
v_exp_f32 v199, v199
v_mfma_f32_16x16x32_bf16 v[200:203], a[0:3], v[128:131], v[216:219]
s_add_u32 m0, s44, 85120
ds_read_b64_tr_b16 a[200:201], v240 offset:34048
v_cvt_pk_bf16_f32 v250, v196, v197
v_mfma_f32_16x16x32_bf16 v[200:203], a[4:7], v[132:135], v[200:203]
s_xor_b32 s45, s47, 40960
ds_read_b64_tr_b16 a[202:203], v240 offset:34560
v_cvt_pk_bf16_f32 v251, v198, v199
v_mfma_f32_16x16x32_bf16 v[200:203], a[8:11], v[136:139], v[200:203]
s_waitcnt vmcnt(5)
buffer_load_dwordx4 v244, s[32:35], s45 offen offset:0 nt lds
v_mfma_f32_16x16x32_bf16 v[200:203], a[12:15], v[140:143], v[200:203]
ds_read_b64_tr_b16 a[96:97], v242 offset:34048
v_mfma_f32_16x16x32_bf16 v[204:207], a[16:19], v[128:131], v[216:219]
ds_read_b64_tr_b16 a[98:99], v242 offset:34560
v_mfma_f32_16x16x32_bf16 v[204:207], a[20:23], v[132:135], v[204:207]
ds_read_b64_tr_b16 a[204:205], v240 offset:34080
v_mfma_f32_16x16x32_bf16 v[204:207], a[24:27], v[136:139], v[204:207]
s_nop 1
v_exp_f32 v200, v200
v_mfma_f32_16x16x32_bf16 v[204:207], a[28:31], v[140:143], v[204:207]
v_exp_f32 v201, v201
v_mfma_f32_16x16x32_bf16 v[192:195], a[32:35], v[128:131], v[216:219]
v_exp_f32 v202, v202
v_mfma_f32_16x16x32_bf16 v[192:195], a[36:39], v[132:135], v[192:195]
v_exp_f32 v203, v203
v_mfma_f32_16x16x32_bf16 v[192:195], a[40:43], v[136:139], v[192:195]
ds_read_b64_tr_b16 a[206:207], v240 offset:34592
v_cvt_pk_bf16_f32 v208, v200, v201
v_mfma_f32_16x16x32_bf16 v[192:195], a[44:47], v[140:143], v[192:195]
ds_read_b64_tr_b16 a[100:101], v242 offset:34080
v_cvt_pk_bf16_f32 v209, v202, v203
v_mfma_f32_16x16x32_bf16 v[196:199], a[48:51], v[128:131], v[216:219]
s_waitcnt lgkmcnt(2)
v_exp_f32 v204, v204
v_mfma_f32_16x16x32_bf16 v[196:199], a[52:55], v[132:135], v[196:199]
s_waitcnt vmcnt(5)
buffer_load_dwordx4 v245, s[32:35], s45 offen offset:1056 nt lds
v_mfma_f32_16x16x32_bf16 v[196:199], a[56:59], v[136:139], v[196:199]
v_exp_f32 v205, v205
v_mfma_f32_16x16x32_bf16 v[196:199], a[60:63], v[140:143], v[196:199]
v_exp_f32 v206, v206
v_mfma_f32_16x16x32_bf16 a[176:179], a[196:199], v[248:251], 0
v_exp_f32 v207, v207
v_mfma_f32_16x16x32_bf16 a[128:131], a[64:67], v[248:251], 0
ds_read_b64_tr_b16 a[102:103], v242 offset:34592
v_cvt_pk_bf16_f32 v210, v204, v205
v_mfma_f32_16x16x32_bf16 a[132:135], a[68:71], v[248:251], 0
ds_read_b64_tr_b16 a[208:209], v240 offset:34112
v_cvt_pk_bf16_f32 v211, v206, v207
v_mfma_f32_16x16x32_bf16 a[136:139], a[72:75], v[248:251], 0
v_exp_f32 v192, v192
v_mfma_f32_16x16x32_bf16 a[140:143], a[76:79], v[248:251], 0
v_exp_f32 v193, v193
v_mfma_f32_16x16x32_bf16 a[144:147], a[80:83], v[248:251], 0
v_exp_f32 v194, v194
v_mfma_f32_16x16x32_bf16 a[148:151], a[84:87], v[248:251], 0
v_exp_f32 v195, v195
v_mfma_f32_16x16x32_bf16 a[152:155], a[88:91], v[248:251], 0
ds_read_b64_tr_b16 a[210:211], v240 offset:34624
v_cvt_pk_bf16_f32 v212, v192, v193
v_mfma_f32_16x16x32_bf16 a[156:159], a[92:95], v[248:251], 0
ds_read_b64_tr_b16 a[104:105], v242 offset:34112
v_cvt_pk_bf16_f32 v213, v194, v195
v_mfma_f32_16x16x32_bf16 v[200:203], a[0:3], v[144:147], v[220:223]
v_exp_f32 v196, v196
v_mfma_f32_16x16x32_bf16 v[200:203], a[4:7], v[148:151], v[200:203]
v_exp_f32 v197, v197
v_mfma_f32_16x16x32_bf16 v[200:203], a[8:11], v[152:155], v[200:203]
v_exp_f32 v198, v198
v_mfma_f32_16x16x32_bf16 v[200:203], a[12:15], v[156:159], v[200:203]
v_exp_f32 v199, v199
v_mfma_f32_16x16x32_bf16 v[204:207], a[16:19], v[144:147], v[220:223]
s_waitcnt vmcnt(5)
buffer_load_dwordx4 v246, s[32:35], s45 offen offset:2112 nt lds
v_mfma_f32_16x16x32_bf16 v[204:207], a[20:23], v[148:151], v[204:207]
ds_read_b64_tr_b16 a[106:107], v242 offset:34624
v_cvt_pk_bf16_f32 v214, v196, v197
v_mfma_f32_16x16x32_bf16 v[204:207], a[24:27], v[152:155], v[204:207]
ds_read_b64_tr_b16 a[212:213], v240 offset:34144
v_cvt_pk_bf16_f32 v215, v198, v199
v_mfma_f32_16x16x32_bf16 v[204:207], a[28:31], v[156:159], v[204:207]
ds_read_b64_tr_b16 a[214:215], v240 offset:34656
ds_read_b64_tr_b16 a[216:217], v241 offset:34048
v_mfma_f32_16x16x32_bf16 v[192:195], a[32:35], v[144:147], v[220:223]
ds_read_b64_tr_b16 a[218:219], v241 offset:34560
ds_read_b64_tr_b16 a[220:221], v241 offset:34080
v_mfma_f32_16x16x32_bf16 v[192:195], a[36:39], v[148:151], v[192:195]
ds_read_b64_tr_b16 a[222:223], v241 offset:34592
ds_read_b64_tr_b16 a[224:225], v241 offset:34112
v_mfma_f32_16x16x32_bf16 v[192:195], a[40:43], v[152:155], v[192:195]
ds_read_b64_tr_b16 a[226:227], v241 offset:34624
ds_read_b64_tr_b16 a[228:229], v241 offset:34144
v_mfma_f32_16x16x32_bf16 v[192:195], a[44:47], v[156:159], v[192:195]
ds_read_b64_tr_b16 a[230:231], v241 offset:34656
ds_read_b64_tr_b16 a[108:109], v242 offset:34144
v_mfma_f32_16x16x32_bf16 v[196:199], a[48:51], v[144:147], v[220:223]
ds_read_b64_tr_b16 a[110:111], v242 offset:34656
ds_read_b64_tr_b16 a[112:113], v243 offset:34048
v_mfma_f32_16x16x32_bf16 v[196:199], a[52:55], v[148:151], v[196:199]
ds_read_b64_tr_b16 a[114:115], v243 offset:34560
v_exp_f32 v200, v200
v_mfma_f32_16x16x32_bf16 v[196:199], a[56:59], v[152:155], v[196:199]
ds_read_b64_tr_b16 a[116:117], v243 offset:34080
v_exp_f32 v201, v201
v_mfma_f32_16x16x32_bf16 v[196:199], a[60:63], v[156:159], v[196:199]
ds_read_b64_tr_b16 a[118:119], v243 offset:34592
v_cvt_pk_bf16_f32 v248, v200, v201
v_mfma_f32_16x16x32_bf16 a[160:163], a[196:199], v[208:211], a[160:163]
ds_read_b64_tr_b16 a[120:121], v243 offset:34112
v_exp_f32 v202, v202
v_mfma_f32_16x16x32_bf16 a[160:163], a[196:199], v[212:215], a[160:163]
ds_read_b64_tr_b16 a[122:123], v243 offset:34624
v_exp_f32 v203, v203
v_mfma_f32_16x16x32_bf16 v[0:3], a[200:203], v[208:211], v[0:3]
ds_read_b64_tr_b16 a[124:125], v243 offset:34144
v_cvt_pk_bf16_f32 v249, v202, v203
v_mfma_f32_16x16x32_bf16 v[0:3], a[96:99], v[212:215], v[0:3]
s_waitcnt lgkmcnt(6)
ds_read_b64_tr_b16 a[126:127], v243 offset:34656
v_exp_f32 v204, v204
v_mfma_f32_16x16x32_bf16 v[4:7], a[204:207], v[208:211], v[4:7]
s_waitcnt vmcnt(5)
buffer_load_dwordx4 v247, s[32:35], s45 offen offset:3168 nt lds
v_mfma_f32_16x16x32_bf16 v[4:7], a[100:103], v[212:215], v[4:7]
v_lshlrev_b32 v254, 3, v252
s_and_b32 s52, s50, 7
v_mfma_f32_16x16x32_bf16 v[8:11], a[208:211], v[208:211], v[8:11]
s_lshl_b32 s53, s3, 6
s_add_u32 s52, s52, s53
s_lshl_b32 s52, s52, 7
v_mfma_f32_16x16x32_bf16 v[8:11], a[104:107], v[212:215], v[8:11]
v_and_b32 v254, 0x1c00, v254
v_add_u32 v254, s52, v254
v_mfma_f32_16x16x32_bf16 v[12:15], a[212:215], v[208:211], v[12:15]
s_getpc_b64 s[52:53]
Lpc2:
s_waitcnt lgkmcnt(0)
s_barrier
v_mfma_f32_16x16x32_bf16 v[12:15], a[108:111], v[212:215], v[12:15]
v_min_u32 v254, Lcode_end-Lpc2-4, v254
v_mov_b32 v255, 0
v_mfma_f32_16x16x32_bf16 v[16:19], a[216:219], v[208:211], v[16:19]
v_lshl_add_u64 v[254:255], v[254:255], 0, s[52:53]
v_exp_f32 v205, v205
v_mfma_f32_16x16x32_bf16 v[16:19], a[112:115], v[212:215], v[16:19]
global_load_dword v253, v[254:255], off
s_add_u32 m0, s44, 34048
v_mfma_f32_16x16x32_bf16 v[20:23], a[220:223], v[208:211], v[20:23]
s_xor_b32 s45, s47, 49152
v_exp_f32 v206, v206
v_mfma_f32_16x16x32_bf16 v[20:23], a[116:119], v[212:215], v[20:23]
s_cbranch_vccz Lw1
s_waitcnt vmcnt(4)
Lw1:
s_waitcnt vmcnt(6)
buffer_load_dwordx4 v244, s[28:31], s45 offen offset:0 nt lds
v_mfma_f32_16x16x32_bf16 v[24:27], a[224:227], v[208:211], v[24:27]
v_exp_f32 v207, v207
v_mfma_f32_16x16x32_bf16 v[24:27], a[120:123], v[212:215], v[24:27]
v_cvt_pk_bf16_f32 v250, v204, v205
v_cvt_pk_bf16_f32 v251, v206, v207
v_mfma_f32_16x16x32_bf16 v[28:31], a[228:231], v[208:211], v[28:31]
v_exp_f32 v192, v192
v_mfma_f32_16x16x32_bf16 v[28:31], a[124:127], v[212:215], v[28:31]
v_exp_f32 v193, v193
v_mfma_f32_16x16x32_bf16 v[200:203], a[0:3], v[160:163], v[224:227]
v_exp_f32 v194, v194
v_mfma_f32_16x16x32_bf16 v[200:203], a[4:7], v[164:167], v[200:203]
v_exp_f32 v195, v195
v_mfma_f32_16x16x32_bf16 v[200:203], a[8:11], v[168:171], v[200:203]
v_cvt_pk_bf16_f32 v208, v192, v193
v_cvt_pk_bf16_f32 v209, v194, v195
v_mfma_f32_16x16x32_bf16 v[200:203], a[12:15], v[172:175], v[200:203]
v_exp_f32 v196, v196
v_mfma_f32_16x16x32_bf16 v[204:207], a[16:19], v[160:163], v[224:227]
v_exp_f32 v197, v197
v_mfma_f32_16x16x32_bf16 v[204:207], a[20:23], v[164:167], v[204:207]
v_exp_f32 v198, v198
v_mfma_f32_16x16x32_bf16 v[204:207], a[24:27], v[168:171], v[204:207]
v_exp_f32 v199, v199
v_mfma_f32_16x16x32_bf16 v[204:207], a[28:31], v[172:175], v[204:207]
s_cbranch_vccz Lw2
s_waitcnt vmcnt(4)
Lw2:
s_waitcnt vmcnt(6)
buffer_load_dwordx4 v245, s[28:31], s45 offen offset:1056 nt lds
v_mfma_f32_16x16x32_bf16 v[192:195], a[32:35], v[160:163], v[224:227]
v_cvt_pk_bf16_f32 v210, v196, v197
v_cvt_pk_bf16_f32 v211, v198, v199
v_mfma_f32_16x16x32_bf16 v[192:195], a[36:39], v[164:167], v[192:195]
v_exp_f32 v200, v200
v_mfma_f32_16x16x32_bf16 v[192:195], a[40:43], v[168:171], v[192:195]
v_exp_f32 v201, v201
v_mfma_f32_16x16x32_bf16 v[192:195], a[44:47], v[172:175], v[192:195]
s_cbranch_vccz Lw3
s_waitcnt vmcnt(4)
Lw3:
s_waitcnt vmcnt(6)
buffer_load_dwordx4 v246, s[28:31], s45 offen offset:2112 nt lds
v_mfma_f32_16x16x32_bf16 v[196:199], a[48:51], v[160:163], v[224:227]
v_exp_f32 v202, v202
v_mfma_f32_16x16x32_bf16 v[196:199], a[52:55], v[164:167], v[196:199]
v_exp_f32 v203, v203
v_mfma_f32_16x16x32_bf16 v[196:199], a[56:59], v[168:171], v[196:199]
v_cvt_pk_bf16_f32 v212, v200, v201
v_cvt_pk_bf16_f32 v213, v202, v203
v_mfma_f32_16x16x32_bf16 v[196:199], a[60:63], v[172:175], v[196:199]
v_exp_f32 v204, v204
v_mfma_f32_16x16x32_bf16 a[164:167], a[196:199], v[248:251], a[164:167]
v_exp_f32 v205, v205
v_mfma_f32_16x16x32_bf16 a[164:167], a[196:199], v[208:211], a[164:167]
v_exp_f32 v206, v206
v_mfma_f32_16x16x32_bf16 v[32:35], a[200:203], v[248:251], v[32:35]
v_exp_f32 v207, v207
v_mfma_f32_16x16x32_bf16 v[32:35], a[96:99], v[208:211], v[32:35]
v_cvt_pk_bf16_f32 v214, v204, v205
v_cvt_pk_bf16_f32 v215, v206, v207
v_mfma_f32_16x16x32_bf16 v[36:39], a[204:207], v[248:251], v[36:39]
v_exp_f32 v192, v192
v_mfma_f32_16x16x32_bf16 v[36:39], a[100:103], v[208:211], v[36:39]
s_cbranch_vccz Lw4
s_waitcnt vmcnt(4)
Lw4:
s_waitcnt vmcnt(6)
buffer_load_dwordx4 v247, s[28:31], s45 offen offset:3168 nt lds
v_mfma_f32_16x16x32_bf16 v[40:43], a[208:211], v[248:251], v[40:43]
v_exp_f32 v193, v193
v_mfma_f32_16x16x32_bf16 v[40:43], a[104:107], v[208:211], v[40:43]
v_exp_f32 v194, v194
v_mfma_f32_16x16x32_bf16 v[44:47], a[212:215], v[248:251], v[44:47]
v_exp_f32 v195, v195
v_mfma_f32_16x16x32_bf16 v[44:47], a[108:111], v[208:211], v[44:47]
v_exp_f32 v196, v196
v_mfma_f32_16x16x32_bf16 v[48:51], a[216:219], v[248:251], v[48:51]
v_exp_f32 v197, v197
v_mfma_f32_16x16x32_bf16 v[48:51], a[112:115], v[208:211], v[48:51]
v_exp_f32 v198, v198
v_mfma_f32_16x16x32_bf16 v[52:55], a[220:223], v[248:251], v[52:55]
v_exp_f32 v199, v199
v_mfma_f32_16x16x32_bf16 v[52:55], a[116:119], v[208:211], v[52:55]
s_add_u32 m0, s44, 51072
s_xor_b32 s45, s47, 57344
v_mfma_f32_16x16x32_bf16 v[56:59], a[224:227], v[248:251], v[56:59]
v_mfma_f32_16x16x32_bf16 v[56:59], a[120:123], v[208:211], v[56:59]
v_mfma_f32_16x16x32_bf16 v[60:63], a[228:231], v[248:251], v[60:63]
s_cbranch_vccz Lw5
s_waitcnt vmcnt(4)
Lw5:
s_waitcnt vmcnt(6)
buffer_load_dwordx4 v244, s[28:31], s45 offen offset:0 nt lds
v_mfma_f32_16x16x32_bf16 v[60:63], a[124:127], v[208:211], v[60:63]
v_cvt_pk_bf16_f32 v248, v192, v193
v_cvt_pk_bf16_f32 v249, v194, v195
v_mfma_f32_16x16x32_bf16 v[200:203], a[0:3], v[176:179], v[228:231]
v_cvt_pk_bf16_f32 v250, v196, v197
v_cvt_pk_bf16_f32 v251, v198, v199
v_mfma_f32_16x16x32_bf16 v[200:203], a[4:7], v[180:183], v[200:203]
v_mfma_f32_16x16x32_bf16 v[200:203], a[8:11], v[184:187], v[200:203]
v_mfma_f32_16x16x32_bf16 v[200:203], a[12:15], v[188:191], v[200:203]
v_mfma_f32_16x16x32_bf16 v[204:207], a[16:19], v[176:179], v[228:231]
v_mfma_f32_16x16x32_bf16 v[204:207], a[20:23], v[180:183], v[204:207]
v_mfma_f32_16x16x32_bf16 v[204:207], a[24:27], v[184:187], v[204:207]
s_nop 4
v_exp_f32 v200, v200
v_mfma_f32_16x16x32_bf16 v[204:207], a[28:31], v[188:191], v[204:207]
v_exp_f32 v201, v201
v_mfma_f32_16x16x32_bf16 v[192:195], a[32:35], v[176:179], v[228:231]
v_exp_f32 v202, v202
v_mfma_f32_16x16x32_bf16 v[192:195], a[36:39], v[180:183], v[192:195]
s_cbranch_vccz Lw6
s_waitcnt vmcnt(4)
Lw6:
s_waitcnt vmcnt(6)
buffer_load_dwordx4 v245, s[28:31], s45 offen offset:1056 nt lds
v_mfma_f32_16x16x32_bf16 v[192:195], a[40:43], v[184:187], v[192:195]
v_exp_f32 v203, v203
v_mfma_f32_16x16x32_bf16 v[192:195], a[44:47], v[188:191], v[192:195]
v_cvt_pk_bf16_f32 v208, v200, v201
v_cvt_pk_bf16_f32 v209, v202, v203
v_mfma_f32_16x16x32_bf16 v[196:199], a[48:51], v[176:179], v[228:231]
v_exp_f32 v204, v204
v_mfma_f32_16x16x32_bf16 v[196:199], a[52:55], v[180:183], v[196:199]
v_exp_f32 v205, v205
v_mfma_f32_16x16x32_bf16 v[196:199], a[56:59], v[184:187], v[196:199]
v_exp_f32 v206, v206
v_mfma_f32_16x16x32_bf16 v[196:199], a[60:63], v[188:191], v[196:199]
v_exp_f32 v207, v207
v_mfma_f32_16x16x32_bf16 a[168:171], a[196:199], v[212:215], a[168:171]
v_cvt_pk_bf16_f32 v210, v204, v205
v_cvt_pk_bf16_f32 v211, v206, v207
v_mfma_f32_16x16x32_bf16 a[168:171], a[196:199], v[248:251], a[168:171]
v_exp_f32 v192, v192
v_mfma_f32_16x16x32_bf16 v[64:67], a[200:203], v[212:215], v[64:67]
v_exp_f32 v193, v193
v_mfma_f32_16x16x32_bf16 v[64:67], a[96:99], v[248:251], v[64:67]
s_cbranch_vccz Lw7
s_waitcnt vmcnt(4)
Lw7:
s_waitcnt vmcnt(6)
buffer_load_dwordx4 v246, s[28:31], s45 offen offset:2112 nt lds
v_mfma_f32_16x16x32_bf16 v[68:71], a[204:207], v[212:215], v[68:71]
v_exp_f32 v194, v194
v_mfma_f32_16x16x32_bf16 v[68:71], a[100:103], v[248:251], v[68:71]
v_exp_f32 v195, v195
v_mfma_f32_16x16x32_bf16 v[72:75], a[208:211], v[212:215], v[72:75]
v_exp_f32 v196, v196
v_mfma_f32_16x16x32_bf16 v[72:75], a[104:107], v[248:251], v[72:75]
v_exp_f32 v197, v197
v_mfma_f32_16x16x32_bf16 v[76:79], a[212:215], v[212:215], v[76:79]
v_exp_f32 v198, v198
v_mfma_f32_16x16x32_bf16 v[76:79], a[108:111], v[248:251], v[76:79]
v_exp_f32 v199, v199
v_mfma_f32_16x16x32_bf16 v[80:83], a[216:219], v[212:215], v[80:83]
v_mfma_f32_16x16x32_bf16 v[80:83], a[112:115], v[248:251], v[80:83]
v_mfma_f32_16x16x32_bf16 v[84:87], a[220:223], v[212:215], v[84:87]
v_mfma_f32_16x16x32_bf16 v[84:87], a[116:119], v[248:251], v[84:87]
v_mfma_f32_16x16x32_bf16 v[88:91], a[224:227], v[212:215], v[88:91]
s_cbranch_vccz Lw8
s_waitcnt vmcnt(4)
Lw8:
s_waitcnt vmcnt(6)
buffer_load_dwordx4 v247, s[28:31], s45 offen offset:3168 nt lds
v_mfma_f32_16x16x32_bf16 v[88:91], a[120:123], v[248:251], v[88:91]
v_mfma_f32_16x16x32_bf16 v[92:95], a[228:231], v[212:215], v[92:95]
v_mfma_f32_16x16x32_bf16 v[92:95], a[124:127], v[248:251], v[92:95]
s_waitcnt vmcnt(9)
s_barrier
v_cvt_pk_bf16_f32 v212, v192, v193
v_mfma_f32_16x16x32_bf16 v[200:203], a[0:3], a[180:183], v[232:235]
ds_read_b128 a[0:3], v236 offset:0
v_cvt_pk_bf16_f32 v213, v194, v195
v_mfma_f32_16x16x32_bf16 v[200:203], a[4:7], a[184:187], v[200:203]
ds_read_b128 a[4:7], v237 offset:0
v_cvt_pk_bf16_f32 v214, v196, v197
v_mfma_f32_16x16x32_bf16 v[200:203], a[8:11], a[188:191], v[200:203]
ds_read_b128 a[8:11], v236 offset:128
v_cvt_pk_bf16_f32 v215, v198, v199
v_mfma_f32_16x16x32_bf16 v[200:203], a[12:15], a[192:195], v[200:203]
ds_read_b128 a[12:15], v237 offset:128
v_mfma_f32_16x16x32_bf16 v[204:207], a[16:19], a[180:183], v[232:235]
s_add_u32 m0, s44, 102144
ds_read_b128 a[16:19], v236 offset:512
s_xor_b32 s45, s47, 49152
v_mfma_f32_16x16x32_bf16 v[204:207], a[20:23], a[184:187], v[204:207]
ds_read_b128 a[20:23], v237 offset:512
v_mfma_f32_16x16x32_bf16 v[204:207], a[24:27], a[188:191], v[204:207]
ds_read_b128 a[24:27], v236 offset:640
v_mfma_f32_16x16x32_bf16 v[204:207], a[28:31], a[192:195], v[204:207]
s_cbranch_vccz Lw9
s_waitcnt vmcnt(4)
Lw9:
s_waitcnt vmcnt(6)
buffer_load_dwordx4 v244, s[32:35], s45 offen offset:0 nt lds
v_mfma_f32_16x16x32_bf16 a[172:175], a[196:199], v[208:211], a[172:175]
ds_read_b128 a[28:31], v237 offset:640
v_mfma_f32_16x16x32_bf16 a[172:175], a[196:199], v[212:215], a[172:175]
ds_read_b128 a[32:35], v238 offset:0
v_mfma_f32_16x16x32_bf16 v[96:99], a[200:203], v[208:211], v[96:99]
ds_read_b128 a[36:39], v239 offset:0
v_mfma_f32_16x16x32_bf16 v[96:99], a[96:99], v[212:215], v[96:99]
ds_read_b128 a[40:43], v238 offset:128
v_mfma_f32_16x16x32_bf16 v[100:103], a[204:207], v[208:211], v[100:103]
ds_read_b128 a[44:47], v239 offset:128
v_mfma_f32_16x16x32_bf16 v[100:103], a[100:103], v[212:215], v[100:103]
ds_read_b128 a[48:51], v238 offset:512
v_mfma_f32_16x16x32_bf16 v[104:107], a[208:211], v[208:211], v[104:107]
v_exp_f32 v200, v200
v_mfma_f32_16x16x32_bf16 v[104:107], a[104:107], v[212:215], v[104:107]
v_exp_f32 v201, v201
v_mfma_f32_16x16x32_bf16 v[108:111], a[212:215], v[208:211], v[108:111]
v_exp_f32 v202, v202
v_mfma_f32_16x16x32_bf16 v[108:111], a[108:111], v[212:215], v[108:111]
s_cbranch_vccz Lw10
s_waitcnt vmcnt(4)
Lw10:
s_waitcnt vmcnt(6)
buffer_load_dwordx4 v245, s[32:35], s45 offen offset:1056 nt lds
v_mfma_f32_16x16x32_bf16 v[112:115], a[216:219], v[208:211], v[112:115]
v_exp_f32 v203, v203
v_mfma_f32_16x16x32_bf16 v[112:115], a[112:115], v[212:215], v[112:115]
ds_read_b128 a[52:55], v239 offset:512
v_cvt_pk_bf16_f32 v248, v200, v201
v_mfma_f32_16x16x32_bf16 v[116:119], a[220:223], v[208:211], v[116:119]
ds_read_b128 a[56:59], v238 offset:640
v_cvt_pk_bf16_f32 v249, v202, v203
v_mfma_f32_16x16x32_bf16 v[116:119], a[116:119], v[212:215], v[116:119]
ds_read_b128 a[60:63], v239 offset:640
v_mfma_f32_16x16x32_bf16 v[120:123], a[224:227], v[208:211], v[120:123]
v_exp_f32 v204, v204
v_mfma_f32_16x16x32_bf16 v[120:123], a[120:123], v[212:215], v[120:123]
v_exp_f32 v205, v205
v_mfma_f32_16x16x32_bf16 v[124:127], a[228:231], v[208:211], v[124:127]
v_exp_f32 v206, v206
v_mfma_f32_16x16x32_bf16 v[124:127], a[124:127], v[212:215], v[124:127]
s_waitcnt lgkmcnt(3)
v_exp_f32 v207, v207
v_mfma_f32_16x16x32_bf16 v[192:195], a[0:3], v[128:131], v[216:219]
ds_read_b64_tr_b16 a[64:65], v240 offset:0
v_cvt_pk_bf16_f32 v250, v204, v205
v_mfma_f32_16x16x32_bf16 v[192:195], a[4:7], v[132:135], v[192:195]
ds_read_b64_tr_b16 a[66:67], v240 offset:512
v_cvt_pk_bf16_f32 v251, v206, v207
v_mfma_f32_16x16x32_bf16 v[192:195], a[8:11], v[136:139], v[192:195]
s_cbranch_vccz Lw11
s_waitcnt vmcnt(4)
Lw11:
s_waitcnt vmcnt(6)
buffer_load_dwordx4 v246, s[32:35], s45 offen offset:2112 nt lds
v_mfma_f32_16x16x32_bf16 v[192:195], a[12:15], v[140:143], v[192:195]
ds_read_b64_tr_b16 a[96:97], v242 offset:0
v_mfma_f32_16x16x32_bf16 v[196:199], a[16:19], v[128:131], v[216:219]
ds_read_b64_tr_b16 a[98:99], v242 offset:512
v_mfma_f32_16x16x32_bf16 v[196:199], a[20:23], v[132:135], v[196:199]
ds_read_b64_tr_b16 a[68:69], v240 offset:32
v_mfma_f32_16x16x32_bf16 v[196:199], a[24:27], v[136:139], v[196:199]
s_nop 1
v_exp_f32 v192, v192
v_mfma_f32_16x16x32_bf16 v[196:199], a[28:31], v[140:143], v[196:199]
v_exp_f32 v193, v193
v_mfma_f32_16x16x32_bf16 v[200:203], a[32:35], v[128:131], v[216:219]
v_exp_f32 v194, v194
v_mfma_f32_16x16x32_bf16 v[200:203], a[36:39], v[132:135], v[200:203]
v_exp_f32 v195, v195
v_mfma_f32_16x16x32_bf16 v[200:203], a[40:43], v[136:139], v[200:203]
ds_read_b64_tr_b16 a[70:71], v240 offset:544
v_cvt_pk_bf16_f32 v208, v192, v193
v_mfma_f32_16x16x32_bf16 v[200:203], a[44:47], v[140:143], v[200:203]
ds_read_b64_tr_b16 a[100:101], v242 offset:32
v_cvt_pk_bf16_f32 v209, v194, v195
v_mfma_f32_16x16x32_bf16 v[204:207], a[48:51], v[128:131], v[216:219]
s_waitcnt lgkmcnt(2)
v_exp_f32 v196, v196
v_mfma_f32_16x16x32_bf16 v[204:207], a[52:55], v[132:135], v[204:207]
s_cbranch_vccz Lw12
s_waitcnt vmcnt(4)
Lw12:
s_waitcnt vmcnt(6)
buffer_load_dwordx4 v247, s[32:35], s45 offen offset:3168 nt lds
v_mfma_f32_16x16x32_bf16 v[204:207], a[56:59], v[136:139], v[204:207]
v_exp_f32 v197, v197
v_mfma_f32_16x16x32_bf16 v[204:207], a[60:63], v[140:143], v[204:207]
v_exp_f32 v198, v198
v_mfma_f32_16x16x32_bf16 a[176:179], a[196:199], v[248:251], a[176:179]
v_exp_f32 v199, v199
v_mfma_f32_16x16x32_bf16 a[128:131], a[200:203], v[248:251], a[128:131]
ds_read_b64_tr_b16 a[102:103], v242 offset:544
v_cvt_pk_bf16_f32 v210, v196, v197
v_mfma_f32_16x16x32_bf16 a[132:135], a[204:207], v[248:251], a[132:135]
ds_read_b64_tr_b16 a[72:73], v240 offset:64
v_cvt_pk_bf16_f32 v211, v198, v199
v_mfma_f32_16x16x32_bf16 a[136:139], a[208:211], v[248:251], a[136:139]
v_exp_f32 v200, v200
v_mfma_f32_16x16x32_bf16 a[140:143], a[212:215], v[248:251], a[140:143]
s_add_u32 m0, s44, 119168
v_exp_f32 v201, v201
v_mfma_f32_16x16x32_bf16 a[144:147], a[216:219], v[248:251], a[144:147]
s_xor_b32 s45, s47, 57344
v_exp_f32 v202, v202
v_mfma_f32_16x16x32_bf16 a[148:151], a[220:223], v[248:251], a[148:151]
v_exp_f32 v203, v203
v_mfma_f32_16x16x32_bf16 a[152:155], a[224:227], v[248:251], a[152:155]
ds_read_b64_tr_b16 a[74:75], v240 offset:576
v_cvt_pk_bf16_f32 v212, v200, v201
v_mfma_f32_16x16x32_bf16 a[156:159], a[228:231], v[248:251], a[156:159]
ds_read_b64_tr_b16 a[104:105], v242 offset:64
v_cvt_pk_bf16_f32 v213, v202, v203
v_mfma_f32_16x16x32_bf16 v[192:195], a[0:3], v[144:147], v[220:223]
s_cbranch_vccz Lw13
s_waitcnt vmcnt(4)
Lw13:
s_waitcnt vmcnt(6)
buffer_load_dwordx4 v244, s[32:35], s45 offen offset:0 nt lds
v_mfma_f32_16x16x32_bf16 v[192:195], a[4:7], v[148:151], v[192:195]
v_exp_f32 v204, v204
v_mfma_f32_16x16x32_bf16 v[192:195], a[8:11], v[152:155], v[192:195]
v_exp_f32 v205, v205
v_mfma_f32_16x16x32_bf16 v[192:195], a[12:15], v[156:159], v[192:195]
v_exp_f32 v206, v206
v_mfma_f32_16x16x32_bf16 v[196:199], a[16:19], v[144:147], v[220:223]
v_exp_f32 v207, v207
v_mfma_f32_16x16x32_bf16 v[196:199], a[20:23], v[148:151], v[196:199]
ds_read_b64_tr_b16 a[106:107], v242 offset:576
v_cvt_pk_bf16_f32 v214, v204, v205
v_mfma_f32_16x16x32_bf16 v[196:199], a[24:27], v[152:155], v[196:199]
ds_read_b64_tr_b16 a[76:77], v240 offset:96
v_cvt_pk_bf16_f32 v215, v206, v207
v_mfma_f32_16x16x32_bf16 v[196:199], a[28:31], v[156:159], v[196:199]
ds_read_b64_tr_b16 a[78:79], v240 offset:608
ds_read_b64_tr_b16 a[80:81], v241 offset:0
v_mfma_f32_16x16x32_bf16 v[200:203], a[32:35], v[144:147], v[220:223]
ds_read_b64_tr_b16 a[82:83], v241 offset:512
ds_read_b64_tr_b16 a[84:85], v241 offset:32
v_mfma_f32_16x16x32_bf16 v[200:203], a[36:39], v[148:151], v[200:203]
ds_read_b64_tr_b16 a[86:87], v241 offset:544
ds_read_b64_tr_b16 a[88:89], v241 offset:64
v_mfma_f32_16x16x32_bf16 v[200:203], a[40:43], v[152:155], v[200:203]
ds_read_b64_tr_b16 a[90:91], v241 offset:576
ds_read_b64_tr_b16 a[92:93], v241 offset:96
v_mfma_f32_16x16x32_bf16 v[200:203], a[44:47], v[156:159], v[200:203]
ds_read_b64_tr_b16 a[94:95], v241 offset:608
ds_read_b64_tr_b16 a[108:109], v242 offset:96
v_mfma_f32_16x16x32_bf16 v[204:207], a[48:51], v[144:147], v[220:223]
ds_read_b64_tr_b16 a[110:111], v242 offset:608
ds_read_b64_tr_b16 a[112:113], v243 offset:0
v_mfma_f32_16x16x32_bf16 v[204:207], a[52:55], v[148:151], v[204:207]
ds_read_b64_tr_b16 a[114:115], v243 offset:512
v_exp_f32 v192, v192
v_mfma_f32_16x16x32_bf16 v[204:207], a[56:59], v[152:155], v[204:207]
ds_read_b64_tr_b16 a[116:117], v243 offset:32
v_exp_f32 v193, v193
v_mfma_f32_16x16x32_bf16 v[204:207], a[60:63], v[156:159], v[204:207]
ds_read_b64_tr_b16 a[118:119], v243 offset:544
v_cvt_pk_bf16_f32 v248, v192, v193
v_mfma_f32_16x16x32_bf16 a[160:163], a[196:199], v[208:211], a[160:163]
ds_read_b64_tr_b16 a[120:121], v243 offset:64
v_mfma_f32_16x16x32_bf16 a[160:163], a[196:199], v[212:215], a[160:163]
ds_read_b64_tr_b16 a[122:123], v243 offset:576
v_mfma_f32_16x16x32_bf16 v[0:3], a[64:67], v[208:211], v[0:3]
ds_read_b64_tr_b16 a[124:125], v243 offset:96
v_exp_f32 v194, v194
v_mfma_f32_16x16x32_bf16 v[0:3], a[96:99], v[212:215], v[0:3]
s_waitcnt lgkmcnt(6)
ds_read_b64_tr_b16 a[126:127], v243 offset:608
v_mfma_f32_16x16x32_bf16 v[4:7], a[68:71], v[208:211], v[4:7]
s_cbranch_vccz Lw14
s_waitcnt vmcnt(4)
Lw14:
s_waitcnt vmcnt(6)
buffer_load_dwordx4 v245, s[32:35], s45 offen offset:1056 nt lds
v_mfma_f32_16x16x32_bf16 v[4:7], a[100:103], v[212:215], v[4:7]
v_exp_f32 v195, v195
v_mfma_f32_16x16x32_bf16 v[8:11], a[72:75], v[208:211], v[8:11]
s_cbranch_vccz Lw15
s_waitcnt vmcnt(4)
Lw15:
s_waitcnt vmcnt(6)
buffer_load_dwordx4 v246, s[32:35], s45 offen offset:2112 nt lds
v_mfma_f32_16x16x32_bf16 v[8:11], a[104:107], v[212:215], v[8:11]
v_cvt_pk_bf16_f32 v249, v194, v195
v_mfma_f32_16x16x32_bf16 v[12:15], a[76:79], v[208:211], v[12:15]
s_waitcnt lgkmcnt(0)
s_barrier
v_exp_f32 v196, v196
v_mfma_f32_16x16x32_bf16 v[12:15], a[108:111], v[212:215], v[12:15]
v_exp_f32 v197, v197
v_mfma_f32_16x16x32_bf16 v[16:19], a[80:83], v[208:211], v[16:19]
v_exp_f32 v198, v198
v_mfma_f32_16x16x32_bf16 v[16:19], a[112:115], v[212:215], v[16:19]
v_exp_f32 v199, v199
v_mfma_f32_16x16x32_bf16 v[20:23], a[84:87], v[208:211], v[20:23]
v_cvt_pk_bf16_f32 v250, v196, v197
v_cvt_pk_bf16_f32 v251, v198, v199
v_mfma_f32_16x16x32_bf16 v[20:23], a[116:119], v[212:215], v[20:23]
v_exp_f32 v200, v200
v_mfma_f32_16x16x32_bf16 v[24:27], a[88:91], v[208:211], v[24:27]
v_exp_f32 v201, v201
v_mfma_f32_16x16x32_bf16 v[24:27], a[120:123], v[212:215], v[24:27]
v_exp_f32 v202, v202
v_mfma_f32_16x16x32_bf16 v[28:31], a[92:95], v[208:211], v[28:31]
v_exp_f32 v203, v203
v_mfma_f32_16x16x32_bf16 v[28:31], a[124:127], v[212:215], v[28:31]
s_cbranch_vccz Lw16
s_waitcnt vmcnt(4)
Lw16:
s_waitcnt vmcnt(6)
buffer_load_dwordx4 v247, s[32:35], s45 offen offset:3168 nt lds
v_mfma_f32_16x16x32_bf16 v[192:195], a[0:3], v[160:163], v[224:227]
v_cvt_pk_bf16_f32 v208, v200, v201
v_cvt_pk_bf16_f32 v209, v202, v203
v_mfma_f32_16x16x32_bf16 v[192:195], a[4:7], v[164:167], v[192:195]
v_exp_f32 v204, v204
v_mfma_f32_16x16x32_bf16 v[192:195], a[8:11], v[168:171], v[192:195]
v_exp_f32 v205, v205
v_mfma_f32_16x16x32_bf16 v[192:195], a[12:15], v[172:175], v[192:195]
v_exp_f32 v206, v206
v_mfma_f32_16x16x32_bf16 v[196:199], a[16:19], v[160:163], v[224:227]
s_add_u32 m0, s44, 0
v_exp_f32 v207, v207
v_mfma_f32_16x16x32_bf16 v[196:199], a[20:23], v[164:167], v[196:199]
s_xor_b32 s45, s47, 65536
v_cvt_pk_bf16_f32 v210, v204, v205
v_cvt_pk_bf16_f32 v211, v206, v207
v_mfma_f32_16x16x32_bf16 v[196:199], a[24:27], v[168:171], v[196:199]
v_exp_f32 v192, v192
v_mfma_f32_16x16x32_bf16 v[196:199], a[28:31], v[172:175], v[196:199]
s_cbranch_vccz Lw17
s_waitcnt vmcnt(4)
Lw17:
s_waitcnt vmcnt(6)
buffer_load_dwordx4 v244, s[28:31], s45 offen offset:0 nt lds
v_mfma_f32_16x16x32_bf16 v[200:203], a[32:35], v[160:163], v[224:227]
v_exp_f32 v193, v193
v_mfma_f32_16x16x32_bf16 v[200:203], a[36:39], v[164:167], v[200:203]
v_exp_f32 v194, v194
v_mfma_f32_16x16x32_bf16 v[200:203], a[40:43], v[168:171], v[200:203]
v_exp_f32 v195, v195
v_mfma_f32_16x16x32_bf16 v[200:203], a[44:47], v[172:175], v[200:203]
v_cvt_pk_bf16_f32 v212, v192, v193
v_cvt_pk_bf16_f32 v213, v194, v195
v_mfma_f32_16x16x32_bf16 v[204:207], a[48:51], v[160:163], v[224:227]
v_exp_f32 v196, v196
v_mfma_f32_16x16x32_bf16 v[204:207], a[52:55], v[164:167], v[204:207]
v_exp_f32 v197, v197
v_mfma_f32_16x16x32_bf16 v[204:207], a[56:59], v[168:171], v[204:207]
v_exp_f32 v198, v198
v_mfma_f32_16x16x32_bf16 v[204:207], a[60:63], v[172:175], v[204:207]
v_exp_f32 v199, v199
v_mfma_f32_16x16x32_bf16 a[164:167], a[196:199], v[248:251], a[164:167]
v_cvt_pk_bf16_f32 v214, v196, v197
v_cvt_pk_bf16_f32 v215, v198, v199
v_mfma_f32_16x16x32_bf16 a[164:167], a[196:199], v[208:211], a[164:167]
v_exp_f32 v200, v200
v_mfma_f32_16x16x32_bf16 v[32:35], a[64:67], v[248:251], v[32:35]
s_cbranch_vccz Lw18
s_waitcnt vmcnt(4)
Lw18:
s_waitcnt vmcnt(6)
buffer_load_dwordx4 v245, s[28:31], s45 offen offset:1056 nt lds
v_mfma_f32_16x16x32_bf16 v[32:35], a[96:99], v[208:211], v[32:35]
v_exp_f32 v201, v201
v_mfma_f32_16x16x32_bf16 v[36:39], a[68:71], v[248:251], v[36:39]
v_exp_f32 v202, v202
v_mfma_f32_16x16x32_bf16 v[36:39], a[100:103], v[208:211], v[36:39]
v_exp_f32 v203, v203
v_mfma_f32_16x16x32_bf16 v[40:43], a[72:75], v[248:251], v[40:43]
v_exp_f32 v204, v204
v_mfma_f32_16x16x32_bf16 v[40:43], a[104:107], v[208:211], v[40:43]
v_exp_f32 v205, v205
v_mfma_f32_16x16x32_bf16 v[44:47], a[76:79], v[248:251], v[44:47]
v_exp_f32 v206, v206
v_mfma_f32_16x16x32_bf16 v[44:47], a[108:111], v[208:211], v[44:47]
v_exp_f32 v207, v207
v_mfma_f32_16x16x32_bf16 v[48:51], a[80:83], v[248:251], v[48:51]
v_mfma_f32_16x16x32_bf16 v[48:51], a[112:115], v[208:211], v[48:51]
v_mfma_f32_16x16x32_bf16 v[52:55], a[84:87], v[248:251], v[52:55]
s_cbranch_vccz Lw19
s_waitcnt vmcnt(4)
Lw19:
s_waitcnt vmcnt(6)
buffer_load_dwordx4 v246, s[28:31], s45 offen offset:2112 nt lds
v_mfma_f32_16x16x32_bf16 v[52:55], a[116:119], v[208:211], v[52:55]
v_mfma_f32_16x16x32_bf16 v[56:59], a[88:91], v[248:251], v[56:59]
v_mfma_f32_16x16x32_bf16 v[56:59], a[120:123], v[208:211], v[56:59]
v_mfma_f32_16x16x32_bf16 v[60:63], a[92:95], v[248:251], v[60:63]
v_mfma_f32_16x16x32_bf16 v[60:63], a[124:127], v[208:211], v[60:63]
v_cvt_pk_bf16_f32 v248, v200, v201
v_cvt_pk_bf16_f32 v249, v202, v203
v_mfma_f32_16x16x32_bf16 v[192:195], a[0:3], v[176:179], v[228:231]
v_cvt_pk_bf16_f32 v250, v204, v205
v_cvt_pk_bf16_f32 v251, v206, v207
v_mfma_f32_16x16x32_bf16 v[192:195], a[4:7], v[180:183], v[192:195]
v_mfma_f32_16x16x32_bf16 v[192:195], a[8:11], v[184:187], v[192:195]
v_mfma_f32_16x16x32_bf16 v[192:195], a[12:15], v[188:191], v[192:195]
v_mfma_f32_16x16x32_bf16 v[196:199], a[16:19], v[176:179], v[228:231]
v_mfma_f32_16x16x32_bf16 v[196:199], a[20:23], v[180:183], v[196:199]
s_cbranch_vccz Lw20
s_waitcnt vmcnt(4)
Lw20:
s_waitcnt vmcnt(6)
buffer_load_dwordx4 v247, s[28:31], s45 offen offset:3168 nt lds
v_mfma_f32_16x16x32_bf16 v[196:199], a[24:27], v[184:187], v[196:199]
s_nop 3
v_exp_f32 v192, v192
v_mfma_f32_16x16x32_bf16 v[196:199], a[28:31], v[188:191], v[196:199]
v_exp_f32 v193, v193
v_mfma_f32_16x16x32_bf16 v[200:203], a[32:35], v[176:179], v[228:231]
v_exp_f32 v194, v194
v_mfma_f32_16x16x32_bf16 v[200:203], a[36:39], v[180:183], v[200:203]
v_exp_f32 v195, v195
v_mfma_f32_16x16x32_bf16 v[200:203], a[40:43], v[184:187], v[200:203]
v_cvt_pk_bf16_f32 v208, v192, v193
v_cvt_pk_bf16_f32 v209, v194, v195
v_mfma_f32_16x16x32_bf16 v[200:203], a[44:47], v[188:191], v[200:203]
v_exp_f32 v196, v196
v_mfma_f32_16x16x32_bf16 v[204:207], a[48:51], v[176:179], v[228:231]
s_add_u32 m0, s44, 17024
s_xor_b32 s45, s47, 73728
v_mfma_f32_16x16x32_bf16 v[204:207], a[52:55], v[180:183], v[204:207]
v_exp_f32 v197, v197
v_mfma_f32_16x16x32_bf16 v[204:207], a[56:59], v[184:187], v[204:207]
v_exp_f32 v198, v198
v_mfma_f32_16x16x32_bf16 v[204:207], a[60:63], v[188:191], v[204:207]
s_cbranch_vccz Lw21
s_waitcnt vmcnt(4)
Lw21:
s_waitcnt vmcnt(6)
buffer_load_dwordx4 v244, s[28:31], s45 offen offset:0 nt lds
v_mfma_f32_16x16x32_bf16 a[168:171], a[196:199], v[212:215], a[168:171]
v_exp_f32 v199, v199
v_mfma_f32_16x16x32_bf16 a[168:171], a[196:199], v[248:251], a[168:171]
v_cvt_pk_bf16_f32 v210, v196, v197
v_cvt_pk_bf16_f32 v211, v198, v199
v_mfma_f32_16x16x32_bf16 v[64:67], a[64:67], v[212:215], v[64:67]
v_exp_f32 v200, v200
v_mfma_f32_16x16x32_bf16 v[64:67], a[96:99], v[248:251], v[64:67]
v_exp_f32 v201, v201
v_mfma_f32_16x16x32_bf16 v[68:71], a[68:71], v[212:215], v[68:71]
v_exp_f32 v202, v202
v_mfma_f32_16x16x32_bf16 v[68:71], a[100:103], v[248:251], v[68:71]
v_exp_f32 v203, v203
v_mfma_f32_16x16x32_bf16 v[72:75], a[72:75], v[212:215], v[72:75]
v_exp_f32 v204, v204
v_mfma_f32_16x16x32_bf16 v[72:75], a[104:107], v[248:251], v[72:75]
v_exp_f32 v205, v205
v_mfma_f32_16x16x32_bf16 v[76:79], a[76:79], v[212:215], v[76:79]
v_exp_f32 v206, v206
v_mfma_f32_16x16x32_bf16 v[76:79], a[108:111], v[248:251], v[76:79]
v_exp_f32 v207, v207
v_mfma_f32_16x16x32_bf16 v[80:83], a[80:83], v[212:215], v[80:83]
s_cbranch_vccz Lw22
s_waitcnt vmcnt(4)
Lw22:
s_waitcnt vmcnt(6)
buffer_load_dwordx4 v245, s[28:31], s45 offen offset:1056 nt lds
v_mfma_f32_16x16x32_bf16 v[80:83], a[112:115], v[248:251], v[80:83]
v_mfma_f32_16x16x32_bf16 v[84:87], a[84:87], v[212:215], v[84:87]
v_mfma_f32_16x16x32_bf16 v[84:87], a[116:119], v[248:251], v[84:87]
v_mfma_f32_16x16x32_bf16 v[88:91], a[88:91], v[212:215], v[88:91]
v_mfma_f32_16x16x32_bf16 v[88:91], a[120:123], v[248:251], v[88:91]
v_mfma_f32_16x16x32_bf16 v[92:95], a[92:95], v[212:215], v[92:95]
v_mfma_f32_16x16x32_bf16 v[92:95], a[124:127], v[248:251], v[92:95]
s_waitcnt vmcnt(14)
s_barrier
v_cvt_pk_bf16_f32 v212, v200, v201
v_mfma_f32_16x16x32_bf16 v[192:195], a[0:3], a[180:183], v[232:235]
ds_read_b128 a[0:3], v236 offset:34048
v_cvt_pk_bf16_f32 v213, v202, v203
v_mfma_f32_16x16x32_bf16 v[192:195], a[4:7], a[184:187], v[192:195]
ds_read_b128 a[4:7], v237 offset:34048
v_cvt_pk_bf16_f32 v214, v204, v205
v_mfma_f32_16x16x32_bf16 v[192:195], a[8:11], a[188:191], v[192:195]
ds_read_b128 a[8:11], v236 offset:34176
v_cvt_pk_bf16_f32 v215, v206, v207
v_mfma_f32_16x16x32_bf16 v[192:195], a[12:15], a[192:195], v[192:195]
s_cbranch_vccz Lw23
s_waitcnt vmcnt(4)
Lw23:
s_waitcnt vmcnt(6)
buffer_load_dwordx4 v246, s[28:31], s45 offen offset:2112 nt lds
v_mfma_f32_16x16x32_bf16 v[196:199], a[16:19], a[180:183], v[232:235]
ds_read_b128 a[12:15], v237 offset:34176
v_mfma_f32_16x16x32_bf16 v[196:199], a[20:23], a[184:187], v[196:199]
ds_read_b128 a[16:19], v236 offset:34560
v_mfma_f32_16x16x32_bf16 v[196:199], a[24:27], a[188:191], v[196:199]
ds_read_b128 a[20:23], v237 offset:34560
v_mfma_f32_16x16x32_bf16 v[196:199], a[28:31], a[192:195], v[196:199]
ds_read_b128 a[24:27], v236 offset:34688
v_mfma_f32_16x16x32_bf16 a[172:175], a[196:199], v[208:211], a[172:175]
ds_read_b128 a[28:31], v237 offset:34688
v_mfma_f32_16x16x32_bf16 a[172:175], a[196:199], v[212:215], a[172:175]
ds_read_b128 a[32:35], v238 offset:34048
v_mfma_f32_16x16x32_bf16 v[96:99], a[64:67], v[208:211], v[96:99]
ds_read_b128 a[36:39], v239 offset:34048
v_mfma_f32_16x16x32_bf16 v[96:99], a[96:99], v[212:215], v[96:99]
ds_read_b128 a[40:43], v238 offset:34176
v_mfma_f32_16x16x32_bf16 v[100:103], a[68:71], v[208:211], v[100:103]
ds_read_b128 a[44:47], v239 offset:34176
v_mfma_f32_16x16x32_bf16 v[100:103], a[100:103], v[212:215], v[100:103]
s_cbranch_vccz Lw24
s_waitcnt vmcnt(4)
Lw24:
s_waitcnt vmcnt(6)
buffer_load_dwordx4 v247, s[28:31], s45 offen offset:3168 nt lds
v_mfma_f32_16x16x32_bf16 v[104:107], a[72:75], v[208:211], v[104:107]
ds_read_b128 a[48:51], v238 offset:34560
v_mfma_f32_16x16x32_bf16 v[104:107], a[104:107], v[212:215], v[104:107]
v_exp_f32 v192, v192
v_mfma_f32_16x16x32_bf16 v[108:111], a[76:79], v[208:211], v[108:111]
v_exp_f32 v193, v193
v_mfma_f32_16x16x32_bf16 v[108:111], a[108:111], v[212:215], v[108:111]
v_exp_f32 v194, v194
v_mfma_f32_16x16x32_bf16 v[112:115], a[80:83], v[208:211], v[112:115]
v_exp_f32 v195, v195
v_mfma_f32_16x16x32_bf16 v[112:115], a[112:115], v[212:215], v[112:115]
ds_read_b128 a[52:55], v239 offset:34560
v_cvt_pk_bf16_f32 v248, v192, v193
v_mfma_f32_16x16x32_bf16 v[116:119], a[84:87], v[208:211], v[116:119]
ds_read_b128 a[56:59], v238 offset:34688
v_cvt_pk_bf16_f32 v249, v194, v195
v_mfma_f32_16x16x32_bf16 v[116:119], a[116:119], v[212:215], v[116:119]
s_add_u32 m0, s44, 68096
ds_read_b128 a[60:63], v239 offset:34688
s_xor_b32 s45, s47, 65536
v_mfma_f32_16x16x32_bf16 v[120:123], a[88:91], v[208:211], v[120:123]
v_exp_f32 v196, v196
v_mfma_f32_16x16x32_bf16 v[120:123], a[120:123], v[212:215], v[120:123]
v_exp_f32 v197, v197
v_mfma_f32_16x16x32_bf16 v[124:127], a[92:95], v[208:211], v[124:127]
s_waitcnt vmcnt(5)
buffer_load_dwordx4 v244, s[32:35], s45 offen offset:0 nt lds
v_mfma_f32_16x16x32_bf16 v[124:127], a[124:127], v[212:215], v[124:127]
s_waitcnt lgkmcnt(3)
v_exp_f32 v198, v198
v_mfma_f32_16x16x32_bf16 v[200:203], a[0:3], v[128:131], v[216:219]
v_exp_f32 v199, v199
v_mfma_f32_16x16x32_bf16 v[200:203], a[4:7], v[132:135], v[200:203]
v_cvt_pk_bf16_f32 v250, v196, v197
v_cvt_pk_bf16_f32 v251, v198, v199
v_mfma_f32_16x16x32_bf16 v[200:203], a[8:11], v[136:139], v[200:203]
v_mfma_f32_16x16x32_bf16 v[200:203], a[12:15], v[140:143], v[200:203]
v_mfma_f32_16x16x32_bf16 v[204:207], a[16:19], v[128:131], v[216:219]
v_mfma_f32_16x16x32_bf16 v[204:207], a[20:23], v[132:135], v[204:207]
v_mfma_f32_16x16x32_bf16 v[204:207], a[24:27], v[136:139], v[204:207]
s_nop 4
v_exp_f32 v200, v200
v_mfma_f32_16x16x32_bf16 v[204:207], a[28:31], v[140:143], v[204:207]
v_exp_f32 v201, v201
v_mfma_f32_16x16x32_bf16 v[192:195], a[32:35], v[128:131], v[216:219]
v_exp_f32 v202, v202
v_mfma_f32_16x16x32_bf16 v[192:195], a[36:39], v[132:135], v[192:195]
s_waitcnt vmcnt(5)
buffer_load_dwordx4 v245, s[32:35], s45 offen offset:1056 nt lds
v_mfma_f32_16x16x32_bf16 v[192:195], a[40:43], v[136:139], v[192:195]
v_exp_f32 v203, v203
v_mfma_f32_16x16x32_bf16 v[192:195], a[44:47], v[140:143], v[192:195]
v_cvt_pk_bf16_f32 v208, v200, v201
v_cvt_pk_bf16_f32 v209, v202, v203
v_mfma_f32_16x16x32_bf16 v[196:199], a[48:51], v[128:131], v[216:219]
s_waitcnt lgkmcnt(0)
v_exp_f32 v204, v204
v_mfma_f32_16x16x32_bf16 v[196:199], a[52:55], v[132:135], v[196:199]
v_exp_f32 v205, v205
v_mfma_f32_16x16x32_bf16 v[196:199], a[56:59], v[136:139], v[196:199]
s_waitcnt vmcnt(10)
s_barrier
v_cvt_pk_bf16_f32 v210, v204, v205
v_mfma_f32_16x16x32_bf16 v[196:199], a[60:63], v[140:143], v[196:199]
v_exp_f32 v206, v206
v_mfma_f32_16x16x32_bf16 a[176:179], a[196:199], v[248:251], a[176:179]
v_exp_f32 v207, v207
v_mfma_f32_16x16x32_bf16 a[128:131], a[64:67], v[248:251], a[128:131]
ds_read_b64_tr_b16 a[200:201], v240 offset:34048
v_cvt_pk_bf16_f32 v211, v206, v207
v_mfma_f32_16x16x32_bf16 a[132:135], a[68:71], v[248:251], a[132:135]
v_exp_f32 v192, v192
v_mfma_f32_16x16x32_bf16 a[136:139], a[72:75], v[248:251], a[136:139]
s_waitcnt vmcnt(5)
buffer_load_dwordx4 v246, s[32:35], s45 offen offset:2112 nt lds
v_mfma_f32_16x16x32_bf16 a[140:143], a[76:79], v[248:251], a[140:143]
v_exp_f32 v193, v193
v_mfma_f32_16x16x32_bf16 a[144:147], a[80:83], v[248:251], a[144:147]
v_exp_f32 v194, v194
v_mfma_f32_16x16x32_bf16 a[148:151], a[84:87], v[248:251], a[148:151]
v_exp_f32 v195, v195
v_mfma_f32_16x16x32_bf16 a[152:155], a[88:91], v[248:251], a[152:155]
ds_read_b64_tr_b16 a[202:203], v240 offset:34560
v_cvt_pk_bf16_f32 v212, v192, v193
v_mfma_f32_16x16x32_bf16 a[156:159], a[92:95], v[248:251], a[156:159]
ds_read_b64_tr_b16 a[96:97], v242 offset:34048
v_cvt_pk_bf16_f32 v213, v194, v195
v_mfma_f32_16x16x32_bf16 v[200:203], a[0:3], v[144:147], v[220:223]
v_exp_f32 v196, v196
v_mfma_f32_16x16x32_bf16 v[200:203], a[4:7], v[148:151], v[200:203]
v_exp_f32 v197, v197
v_mfma_f32_16x16x32_bf16 v[200:203], a[8:11], v[152:155], v[200:203]
v_exp_f32 v198, v198
v_mfma_f32_16x16x32_bf16 v[200:203], a[12:15], v[156:159], v[200:203]
v_exp_f32 v199, v199
v_mfma_f32_16x16x32_bf16 v[204:207], a[16:19], v[144:147], v[220:223]
ds_read_b64_tr_b16 a[98:99], v242 offset:34560
v_cvt_pk_bf16_f32 v214, v196, v197
v_mfma_f32_16x16x32_bf16 v[204:207], a[20:23], v[148:151], v[204:207]
ds_read_b64_tr_b16 a[204:205], v240 offset:34080
v_cvt_pk_bf16_f32 v215, v198, v199
v_mfma_f32_16x16x32_bf16 v[204:207], a[24:27], v[152:155], v[204:207]
ds_read_b64_tr_b16 a[206:207], v240 offset:34592
ds_read_b64_tr_b16 a[100:101], v242 offset:34080
v_mfma_f32_16x16x32_bf16 v[204:207], a[28:31], v[156:159], v[204:207]
ds_read_b64_tr_b16 a[102:103], v242 offset:34592
ds_read_b64_tr_b16 a[208:209], v240 offset:34112
v_mfma_f32_16x16x32_bf16 v[192:195], a[32:35], v[144:147], v[220:223]
s_waitcnt vmcnt(5)
buffer_load_dwordx4 v247, s[32:35], s45 offen offset:3168 nt lds
v_mfma_f32_16x16x32_bf16 v[192:195], a[36:39], v[148:151], v[192:195]
ds_read_b64_tr_b16 a[210:211], v240 offset:34624
ds_read_b64_tr_b16 a[104:105], v242 offset:34112
v_mfma_f32_16x16x32_bf16 v[192:195], a[40:43], v[152:155], v[192:195]
ds_read_b64_tr_b16 a[106:107], v242 offset:34624
ds_read_b64_tr_b16 a[212:213], v240 offset:34144
v_mfma_f32_16x16x32_bf16 v[192:195], a[44:47], v[156:159], v[192:195]
ds_read_b64_tr_b16 a[214:215], v240 offset:34656
ds_read_b64_tr_b16 a[108:109], v242 offset:34144
v_mfma_f32_16x16x32_bf16 v[196:199], a[48:51], v[144:147], v[220:223]
ds_read_b64_tr_b16 a[110:111], v242 offset:34656
ds_read_b64_tr_b16 a[216:217], v241 offset:34048
v_mfma_f32_16x16x32_bf16 v[196:199], a[52:55], v[148:151], v[196:199]
s_add_u32 m0, s44, 85120
ds_read_b64_tr_b16 a[218:219], v241 offset:34560
ds_read_b64_tr_b16 a[112:113], v243 offset:34048
v_mfma_f32_16x16x32_bf16 v[196:199], a[56:59], v[152:155], v[196:199]
s_xor_b32 s45, s47, 73728
ds_read_b64_tr_b16 a[114:115], v243 offset:34560
v_exp_f32 v200, v200
v_mfma_f32_16x16x32_bf16 v[196:199], a[60:63], v[156:159], v[196:199]
ds_read_b64_tr_b16 a[220:221], v241 offset:34080
v_exp_f32 v201, v201
v_mfma_f32_16x16x32_bf16 a[160:163], a[196:199], v[208:211], a[160:163]
ds_read_b64_tr_b16 a[222:223], v241 offset:34592
v_cvt_pk_bf16_f32 v248, v200, v201
v_mfma_f32_16x16x32_bf16 a[160:163], a[196:199], v[212:215], a[160:163]
s_waitcnt lgkmcnt(9)
ds_read_b64_tr_b16 a[116:117], v243 offset:34080
v_exp_f32 v202, v202
v_mfma_f32_16x16x32_bf16 v[0:3], a[200:203], v[208:211], v[0:3]
ds_read_b64_tr_b16 a[118:119], v243 offset:34592
v_exp_f32 v203, v203
v_mfma_f32_16x16x32_bf16 v[0:3], a[96:99], v[212:215], v[0:3]
ds_read_b64_tr_b16 a[224:225], v241 offset:34112
v_cvt_pk_bf16_f32 v249, v202, v203
v_mfma_f32_16x16x32_bf16 v[4:7], a[204:207], v[208:211], v[4:7]
ds_read_b64_tr_b16 a[226:227], v241 offset:34624
v_exp_f32 v204, v204
v_mfma_f32_16x16x32_bf16 v[4:7], a[100:103], v[212:215], v[4:7]
ds_read_b64_tr_b16 a[120:121], v243 offset:34112
v_mfma_f32_16x16x32_bf16 v[8:11], a[208:211], v[208:211], v[8:11]
ds_read_b64_tr_b16 a[122:123], v243 offset:34624
v_exp_f32 v205, v205
v_mfma_f32_16x16x32_bf16 v[8:11], a[104:107], v[212:215], v[8:11]
s_waitcnt lgkmcnt(6)
s_waitcnt vmcnt(5)
buffer_load_dwordx4 v244, s[32:35], s45 offen offset:0 nt lds
v_mfma_f32_16x16x32_bf16 v[12:15], a[212:215], v[208:211], v[12:15]
ds_read_b64_tr_b16 a[228:229], v241 offset:34144
v_cvt_pk_bf16_f32 v250, v204, v205
v_mfma_f32_16x16x32_bf16 v[12:15], a[108:111], v[212:215], v[12:15]
ds_read_b64_tr_b16 a[230:231], v241 offset:34656
v_mfma_f32_16x16x32_bf16 v[16:19], a[216:219], v[208:211], v[16:19]
ds_read_b64_tr_b16 a[124:125], v243 offset:34144
v_mfma_f32_16x16x32_bf16 v[16:19], a[112:115], v[212:215], v[16:19]
ds_read_b64_tr_b16 a[126:127], v243 offset:34656
v_mfma_f32_16x16x32_bf16 v[20:23], a[220:223], v[208:211], v[20:23]
s_waitcnt lgkmcnt(5)
v_exp_f32 v206, v206
v_mfma_f32_16x16x32_bf16 v[20:23], a[116:119], v[212:215], v[20:23]
v_exp_f32 v207, v207
v_mfma_f32_16x16x32_bf16 v[24:27], a[224:227], v[208:211], v[24:27]
s_waitcnt lgkmcnt(4)
s_waitcnt vmcnt(5)
buffer_load_dwordx4 v245, s[32:35], s45 offen offset:1056 nt lds
v_mfma_f32_16x16x32_bf16 v[24:27], a[120:123], v[212:215], v[24:27]
s_waitcnt lgkmcnt(2)
v_cvt_pk_bf16_f32 v251, v206, v207
v_mfma_f32_16x16x32_bf16 v[28:31], a[228:231], v[208:211], v[28:31]
s_waitcnt lgkmcnt(0)
v_exp_f32 v192, v192
v_mfma_f32_16x16x32_bf16 v[28:31], a[124:127], v[212:215], v[28:31]
v_exp_f32 v193, v193
v_mfma_f32_16x16x32_bf16 v[200:203], a[0:3], v[160:163], v[224:227]
v_exp_f32 v194, v194
v_mfma_f32_16x16x32_bf16 v[200:203], a[4:7], v[164:167], v[200:203]
v_exp_f32 v195, v195
v_mfma_f32_16x16x32_bf16 v[200:203], a[8:11], v[168:171], v[200:203]
s_barrier
v_cvt_pk_bf16_f32 v208, v192, v193
v_cvt_pk_bf16_f32 v209, v194, v195
v_mfma_f32_16x16x32_bf16 v[200:203], a[12:15], v[172:175], v[200:203]
v_exp_f32 v196, v196
v_mfma_f32_16x16x32_bf16 v[204:207], a[16:19], v[160:163], v[224:227]
v_exp_f32 v197, v197
v_mfma_f32_16x16x32_bf16 v[204:207], a[20:23], v[164:167], v[204:207]
v_exp_f32 v198, v198
v_mfma_f32_16x16x32_bf16 v[204:207], a[24:27], v[168:171], v[204:207]
v_exp_f32 v199, v199
v_mfma_f32_16x16x32_bf16 v[204:207], a[28:31], v[172:175], v[204:207]
v_cvt_pk_bf16_f32 v210, v196, v197
v_cvt_pk_bf16_f32 v211, v198, v199
v_mfma_f32_16x16x32_bf16 v[192:195], a[32:35], v[160:163], v[224:227]
s_waitcnt vmcnt(5)
buffer_load_dwordx4 v246, s[32:35], s45 offen offset:2112 nt lds
v_mfma_f32_16x16x32_bf16 v[192:195], a[36:39], v[164:167], v[192:195]
v_exp_f32 v200, v200
v_mfma_f32_16x16x32_bf16 v[192:195], a[40:43], v[168:171], v[192:195]
v_exp_f32 v201, v201
v_mfma_f32_16x16x32_bf16 v[192:195], a[44:47], v[172:175], v[192:195]
v_exp_f32 v202, v202
v_mfma_f32_16x16x32_bf16 v[196:199], a[48:51], v[160:163], v[224:227]
v_exp_f32 v203, v203
v_mfma_f32_16x16x32_bf16 v[196:199], a[52:55], v[164:167], v[196:199]
v_cvt_pk_bf16_f32 v212, v200, v201
v_cvt_pk_bf16_f32 v213, v202, v203
v_mfma_f32_16x16x32_bf16 v[196:199], a[56:59], v[168:171], v[196:199]
s_waitcnt vmcnt(5)
buffer_load_dwordx4 v247, s[32:35], s45 offen offset:3168 nt lds
v_mfma_f32_16x16x32_bf16 v[196:199], a[60:63], v[172:175], v[196:199]
v_exp_f32 v204, v204
v_mfma_f32_16x16x32_bf16 a[164:167], a[196:199], v[248:251], a[164:167]
v_exp_f32 v205, v205
v_mfma_f32_16x16x32_bf16 a[164:167], a[196:199], v[208:211], a[164:167]
v_exp_f32 v206, v206
v_mfma_f32_16x16x32_bf16 v[32:35], a[200:203], v[248:251], v[32:35]
v_exp_f32 v207, v207
v_mfma_f32_16x16x32_bf16 v[32:35], a[96:99], v[208:211], v[32:35]
v_cvt_pk_bf16_f32 v214, v204, v205
v_cvt_pk_bf16_f32 v215, v206, v207
v_mfma_f32_16x16x32_bf16 v[36:39], a[204:207], v[248:251], v[36:39]
v_exp_f32 v192, v192
v_mfma_f32_16x16x32_bf16 v[36:39], a[100:103], v[208:211], v[36:39]
s_add_u32 m0, s44, 34048
s_xor_b32 s45, s47, 81920
v_mfma_f32_16x16x32_bf16 v[40:43], a[208:211], v[248:251], v[40:43]
v_exp_f32 v193, v193
v_mfma_f32_16x16x32_bf16 v[40:43], a[104:107], v[208:211], v[40:43]
v_exp_f32 v194, v194
v_mfma_f32_16x16x32_bf16 v[44:47], a[212:215], v[248:251], v[44:47]
s_waitcnt vmcnt(5)
buffer_load_dwordx4 v244, s[28:31], s45 offen offset:0 nt lds
v_mfma_f32_16x16x32_bf16 v[44:47], a[108:111], v[208:211], v[44:47]
v_exp_f32 v195, v195
v_mfma_f32_16x16x32_bf16 v[48:51], a[216:219], v[248:251], v[48:51]
v_exp_f32 v196, v196
v_mfma_f32_16x16x32_bf16 v[48:51], a[112:115], v[208:211], v[48:51]
v_exp_f32 v197, v197
v_mfma_f32_16x16x32_bf16 v[52:55], a[220:223], v[248:251], v[52:55]
v_exp_f32 v198, v198
v_mfma_f32_16x16x32_bf16 v[52:55], a[116:119], v[208:211], v[52:55]
v_exp_f32 v199, v199
v_mfma_f32_16x16x32_bf16 v[56:59], a[224:227], v[248:251], v[56:59]
v_mfma_f32_16x16x32_bf16 v[56:59], a[120:123], v[208:211], v[56:59]
v_mfma_f32_16x16x32_bf16 v[60:63], a[228:231], v[248:251], v[60:63]
v_mfma_f32_16x16x32_bf16 v[60:63], a[124:127], v[208:211], v[60:63]
v_cvt_pk_bf16_f32 v248, v192, v193
v_cvt_pk_bf16_f32 v249, v194, v195
v_mfma_f32_16x16x32_bf16 v[200:203], a[0:3], v[176:179], v[228:231]
v_cvt_pk_bf16_f32 v250, v196, v197
v_cvt_pk_bf16_f32 v251, v198, v199
v_mfma_f32_16x16x32_bf16 v[200:203], a[4:7], v[180:183], v[200:203]
s_waitcnt vmcnt(5)
buffer_load_dwordx4 v245, s[28:31], s45 offen offset:1056 nt lds
v_mfma_f32_16x16x32_bf16 v[200:203], a[8:11], v[184:187], v[200:203]
v_mfma_f32_16x16x32_bf16 v[200:203], a[12:15], v[188:191], v[200:203]
v_mfma_f32_16x16x32_bf16 v[204:207], a[16:19], v[176:179], v[228:231]
v_mfma_f32_16x16x32_bf16 v[204:207], a[20:23], v[180:183], v[204:207]
v_mfma_f32_16x16x32_bf16 v[204:207], a[24:27], v[184:187], v[204:207]
s_nop 4
v_exp_f32 v200, v200
v_mfma_f32_16x16x32_bf16 v[204:207], a[28:31], v[188:191], v[204:207]
v_exp_f32 v201, v201
v_mfma_f32_16x16x32_bf16 v[192:195], a[32:35], v[176:179], v[228:231]
v_exp_f32 v202, v202
v_mfma_f32_16x16x32_bf16 v[192:195], a[36:39], v[180:183], v[192:195]
v_exp_f32 v203, v203
v_mfma_f32_16x16x32_bf16 v[192:195], a[40:43], v[184:187], v[192:195]
v_cvt_pk_bf16_f32 v208, v200, v201
v_cvt_pk_bf16_f32 v209, v202, v203
v_mfma_f32_16x16x32_bf16 v[192:195], a[44:47], v[188:191], v[192:195]
v_exp_f32 v204, v204
v_mfma_f32_16x16x32_bf16 v[196:199], a[48:51], v[176:179], v[228:231]
s_waitcnt vmcnt(5)
buffer_load_dwordx4 v246, s[28:31], s45 offen offset:2112 nt lds
v_mfma_f32_16x16x32_bf16 v[196:199], a[52:55], v[180:183], v[196:199]
v_exp_f32 v205, v205
v_mfma_f32_16x16x32_bf16 v[196:199], a[56:59], v[184:187], v[196:199]
v_exp_f32 v206, v206
v_mfma_f32_16x16x32_bf16 v[196:199], a[60:63], v[188:191], v[196:199]
v_exp_f32 v207, v207
v_mfma_f32_16x16x32_bf16 a[168:171], a[196:199], v[212:215], a[168:171]
v_cvt_pk_bf16_f32 v210, v204, v205
v_cvt_pk_bf16_f32 v211, v206, v207
v_mfma_f32_16x16x32_bf16 a[168:171], a[196:199], v[248:251], a[168:171]
v_exp_f32 v192, v192
v_mfma_f32_16x16x32_bf16 v[64:67], a[200:203], v[212:215], v[64:67]
v_exp_f32 v193, v193
v_mfma_f32_16x16x32_bf16 v[64:67], a[96:99], v[248:251], v[64:67]
v_exp_f32 v194, v194
v_mfma_f32_16x16x32_bf16 v[68:71], a[204:207], v[212:215], v[68:71]
v_exp_f32 v195, v195
v_mfma_f32_16x16x32_bf16 v[68:71], a[100:103], v[248:251], v[68:71]
v_exp_f32 v196, v196
v_mfma_f32_16x16x32_bf16 v[72:75], a[208:211], v[212:215], v[72:75]
s_waitcnt vmcnt(5)
buffer_load_dwordx4 v247, s[28:31], s45 offen offset:3168 nt lds
v_mfma_f32_16x16x32_bf16 v[72:75], a[104:107], v[248:251], v[72:75]
v_exp_f32 v197, v197
v_mfma_f32_16x16x32_bf16 v[76:79], a[212:215], v[212:215], v[76:79]
v_exp_f32 v198, v198
v_mfma_f32_16x16x32_bf16 v[76:79], a[108:111], v[248:251], v[76:79]
v_exp_f32 v199, v199
v_mfma_f32_16x16x32_bf16 v[80:83], a[216:219], v[212:215], v[80:83]
v_mfma_f32_16x16x32_bf16 v[80:83], a[112:115], v[248:251], v[80:83]
v_mfma_f32_16x16x32_bf16 v[84:87], a[220:223], v[212:215], v[84:87]
v_mfma_f32_16x16x32_bf16 v[84:87], a[116:119], v[248:251], v[84:87]
v_mfma_f32_16x16x32_bf16 v[88:91], a[224:227], v[212:215], v[88:91]
s_add_u32 m0, s44, 51072
s_xor_b32 s45, s47, 90112
v_mfma_f32_16x16x32_bf16 v[88:91], a[120:123], v[248:251], v[88:91]
v_mfma_f32_16x16x32_bf16 v[92:95], a[228:231], v[212:215], v[92:95]
v_mfma_f32_16x16x32_bf16 v[92:95], a[124:127], v[248:251], v[92:95]
s_waitcnt vmcnt(12)
s_barrier
v_cvt_pk_bf16_f32 v212, v192, v193
v_mfma_f32_16x16x32_bf16 v[200:203], a[0:3], a[180:183], v[232:235]
ds_read_b128 a[0:3], v236 offset:0
v_cvt_pk_bf16_f32 v213, v194, v195
v_mfma_f32_16x16x32_bf16 v[200:203], a[4:7], a[184:187], v[200:203]
ds_read_b128 a[4:7], v237 offset:0
v_cvt_pk_bf16_f32 v214, v196, v197
v_mfma_f32_16x16x32_bf16 v[200:203], a[8:11], a[188:191], v[200:203]
ds_read_b128 a[8:11], v236 offset:128
v_cvt_pk_bf16_f32 v215, v198, v199
v_mfma_f32_16x16x32_bf16 v[200:203], a[12:15], a[192:195], v[200:203]
s_waitcnt vmcnt(5)
buffer_load_dwordx4 v244, s[28:31], s45 offen offset:0 nt lds
v_mfma_f32_16x16x32_bf16 v[204:207], a[16:19], a[180:183], v[232:235]
ds_read_b128 a[12:15], v237 offset:128
v_mfma_f32_16x16x32_bf16 v[204:207], a[20:23], a[184:187], v[204:207]
ds_read_b128 a[16:19], v236 offset:512
v_mfma_f32_16x16x32_bf16 v[204:207], a[24:27], a[188:191], v[204:207]
ds_read_b128 a[20:23], v237 offset:512
v_mfma_f32_16x16x32_bf16 v[204:207], a[28:31], a[192:195], v[204:207]
ds_read_b128 a[24:27], v236 offset:640
v_mfma_f32_16x16x32_bf16 a[172:175], a[196:199], v[208:211], a[172:175]
ds_read_b128 a[28:31], v237 offset:640
v_mfma_f32_16x16x32_bf16 a[172:175], a[196:199], v[212:215], a[172:175]
ds_read_b128 a[32:35], v238 offset:0
v_mfma_f32_16x16x32_bf16 v[96:99], a[200:203], v[208:211], v[96:99]
s_waitcnt vmcnt(5)
buffer_load_dwordx4 v245, s[28:31], s45 offen offset:1056 nt lds
v_mfma_f32_16x16x32_bf16 v[96:99], a[96:99], v[212:215], v[96:99]
ds_read_b128 a[36:39], v239 offset:0
v_mfma_f32_16x16x32_bf16 v[100:103], a[204:207], v[208:211], v[100:103]
ds_read_b128 a[40:43], v238 offset:128
v_mfma_f32_16x16x32_bf16 v[100:103], a[100:103], v[212:215], v[100:103]
ds_read_b128 a[44:47], v239 offset:128
v_mfma_f32_16x16x32_bf16 v[104:107], a[208:211], v[208:211], v[104:107]
ds_read_b128 a[48:51], v238 offset:512
v_mfma_f32_16x16x32_bf16 v[104:107], a[104:107], v[212:215], v[104:107]
v_exp_f32 v200, v200
v_mfma_f32_16x16x32_bf16 v[108:111], a[212:215], v[208:211], v[108:111]
v_exp_f32 v201, v201
v_mfma_f32_16x16x32_bf16 v[108:111], a[108:111], v[212:215], v[108:111]
v_exp_f32 v202, v202
v_mfma_f32_16x16x32_bf16 v[112:115], a[216:219], v[208:211], v[112:115]
v_exp_f32 v203, v203
v_mfma_f32_16x16x32_bf16 v[112:115], a[112:115], v[212:215], v[112:115]
ds_read_b128 a[52:55], v239 offset:512
v_cvt_pk_bf16_f32 v248, v200, v201
v_mfma_f32_16x16x32_bf16 v[116:119], a[220:223], v[208:211], v[116:119]
s_waitcnt vmcnt(5)
buffer_load_dwordx4 v246, s[28:31], s45 offen offset:2112 nt lds
v_mfma_f32_16x16x32_bf16 v[116:119], a[116:119], v[212:215], v[116:119]
ds_read_b128 a[56:59], v238 offset:640
v_cvt_pk_bf16_f32 v249, v202, v203
v_mfma_f32_16x16x32_bf16 v[120:123], a[224:227], v[208:211], v[120:123]
ds_read_b128 a[60:63], v239 offset:640
v_mfma_f32_16x16x32_bf16 v[120:123], a[120:123], v[212:215], v[120:123]
v_exp_f32 v204, v204
v_mfma_f32_16x16x32_bf16 v[124:127], a[228:231], v[208:211], v[124:127]
v_exp_f32 v205, v205
v_mfma_f32_16x16x32_bf16 v[124:127], a[124:127], v[212:215], v[124:127]
s_waitcnt lgkmcnt(3)
v_exp_f32 v206, v206
v_mfma_f32_16x16x32_bf16 v[192:195], a[0:3], v[128:131], v[216:219]
v_exp_f32 v207, v207
v_mfma_f32_16x16x32_bf16 v[192:195], a[4:7], v[132:135], v[192:195]
v_cvt_pk_bf16_f32 v250, v204, v205
v_cvt_pk_bf16_f32 v251, v206, v207
v_mfma_f32_16x16x32_bf16 v[192:195], a[8:11], v[136:139], v[192:195]
v_mfma_f32_16x16x32_bf16 v[192:195], a[12:15], v[140:143], v[192:195]
v_mfma_f32_16x16x32_bf16 v[196:199], a[16:19], v[128:131], v[216:219]
v_mfma_f32_16x16x32_bf16 v[196:199], a[20:23], v[132:135], v[196:199]
s_waitcnt vmcnt(5)
buffer_load_dwordx4 v247, s[28:31], s45 offen offset:3168 nt lds
v_mfma_f32_16x16x32_bf16 v[196:199], a[24:27], v[136:139], v[196:199]
s_nop 3
v_exp_f32 v192, v192
v_mfma_f32_16x16x32_bf16 v[196:199], a[28:31], v[140:143], v[196:199]
v_exp_f32 v193, v193
v_mfma_f32_16x16x32_bf16 v[200:203], a[32:35], v[128:131], v[216:219]
v_exp_f32 v194, v194
v_mfma_f32_16x16x32_bf16 v[200:203], a[36:39], v[132:135], v[200:203]
v_exp_f32 v195, v195
v_mfma_f32_16x16x32_bf16 v[200:203], a[40:43], v[136:139], v[200:203]
v_cvt_pk_bf16_f32 v208, v192, v193
v_cvt_pk_bf16_f32 v209, v194, v195
v_mfma_f32_16x16x32_bf16 v[200:203], a[44:47], v[140:143], v[200:203]
v_exp_f32 v196, v196
v_mfma_f32_16x16x32_bf16 v[204:207], a[48:51], v[128:131], v[216:219]
s_waitcnt lgkmcnt(0)
v_exp_f32 v197, v197
v_mfma_f32_16x16x32_bf16 v[204:207], a[52:55], v[132:135], v[204:207]
s_add_u32 m0, s44, 102144
s_xor_b32 s45, s47, 81920
v_cvt_pk_bf16_f32 v210, v196, v197
v_mfma_f32_16x16x32_bf16 v[204:207], a[56:59], v[136:139], v[204:207]
s_waitcnt vmcnt(8)
s_barrier
ds_read_b64_tr_b16 a[64:65], v240 offset:0
v_mfma_f32_16x16x32_bf16 v[204:207], a[60:63], v[140:143], v[204:207]
v_exp_f32 v198, v198
v_mfma_f32_16x16x32_bf16 a[176:179], a[196:199], v[248:251], a[176:179]
s_waitcnt vmcnt(5)
buffer_load_dwordx4 v244, s[32:35], s45 offen offset:0 nt lds
v_mfma_f32_16x16x32_bf16 a[128:131], a[200:203], v[248:251], a[128:131]
v_exp_f32 v199, v199
v_mfma_f32_16x16x32_bf16 a[132:135], a[204:207], v[248:251], a[132:135]
ds_read_b64_tr_b16 a[66:67], v240 offset:512
v_cvt_pk_bf16_f32 v211, v198, v199
v_mfma_f32_16x16x32_bf16 a[136:139], a[208:211], v[248:251], a[136:139]
v_exp_f32 v200, v200
v_mfma_f32_16x16x32_bf16 a[140:143], a[212:215], v[248:251], a[140:143]
v_exp_f32 v201, v201
v_mfma_f32_16x16x32_bf16 a[144:147], a[216:219], v[248:251], a[144:147]
v_exp_f32 v202, v202
v_mfma_f32_16x16x32_bf16 a[148:151], a[220:223], v[248:251], a[148:151]
v_exp_f32 v203, v203
v_mfma_f32_16x16x32_bf16 a[152:155], a[224:227], v[248:251], a[152:155]
ds_read_b64_tr_b16 a[96:97], v242 offset:0
v_cvt_pk_bf16_f32 v212, v200, v201
v_mfma_f32_16x16x32_bf16 a[156:159], a[228:231], v[248:251], a[156:159]
ds_read_b64_tr_b16 a[98:99], v242 offset:512
v_cvt_pk_bf16_f32 v213, v202, v203
v_mfma_f32_16x16x32_bf16 v[192:195], a[0:3], v[144:147], v[220:223]
v_exp_f32 v204, v204
v_mfma_f32_16x16x32_bf16 v[192:195], a[4:7], v[148:151], v[192:195]
v_exp_f32 v205, v205
v_mfma_f32_16x16x32_bf16 v[192:195], a[8:11], v[152:155], v[192:195]
v_exp_f32 v206, v206
v_mfma_f32_16x16x32_bf16 v[192:195], a[12:15], v[156:159], v[192:195]
v_exp_f32 v207, v207
v_mfma_f32_16x16x32_bf16 v[196:199], a[16:19], v[144:147], v[220:223]
ds_read_b64_tr_b16 a[68:69], v240 offset:32
v_cvt_pk_bf16_f32 v214, v204, v205
v_mfma_f32_16x16x32_bf16 v[196:199], a[20:23], v[148:151], v[196:199]
ds_read_b64_tr_b16 a[70:71], v240 offset:544
v_cvt_pk_bf16_f32 v215, v206, v207
v_mfma_f32_16x16x32_bf16 v[196:199], a[24:27], v[152:155], v[196:199]
s_waitcnt vmcnt(5)
buffer_load_dwordx4 v245, s[32:35], s45 offen offset:1056 nt lds
v_mfma_f32_16x16x32_bf16 v[196:199], a[28:31], v[156:159], v[196:199]
ds_read_b64_tr_b16 a[100:101], v242 offset:32
ds_read_b64_tr_b16 a[102:103], v242 offset:544
v_mfma_f32_16x16x32_bf16 v[200:203], a[32:35], v[144:147], v[220:223]
ds_read_b64_tr_b16 a[72:73], v240 offset:64
ds_read_b64_tr_b16 a[74:75], v240 offset:576
v_mfma_f32_16x16x32_bf16 v[200:203], a[36:39], v[148:151], v[200:203]
ds_read_b64_tr_b16 a[104:105], v242 offset:64
ds_read_b64_tr_b16 a[106:107], v242 offset:576
v_mfma_f32_16x16x32_bf16 v[200:203], a[40:43], v[152:155], v[200:203]
ds_read_b64_tr_b16 a[76:77], v240 offset:96
ds_read_b64_tr_b16 a[78:79], v240 offset:608
v_mfma_f32_16x16x32_bf16 v[200:203], a[44:47], v[156:159], v[200:203]
ds_read_b64_tr_b16 a[108:109], v242 offset:96
ds_read_b64_tr_b16 a[110:111], v242 offset:608
v_mfma_f32_16x16x32_bf16 v[204:207], a[48:51], v[144:147], v[220:223]
ds_read_b64_tr_b16 a[80:81], v241 offset:0
ds_read_b64_tr_b16 a[82:83], v241 offset:512
v_mfma_f32_16x16x32_bf16 v[204:207], a[52:55], v[148:151], v[204:207]
ds_read_b64_tr_b16 a[112:113], v243 offset:0
v_exp_f32 v192, v192
v_mfma_f32_16x16x32_bf16 v[204:207], a[56:59], v[152:155], v[204:207]
ds_read_b64_tr_b16 a[114:115], v243 offset:512
v_exp_f32 v193, v193
v_mfma_f32_16x16x32_bf16 v[204:207], a[60:63], v[156:159], v[204:207]
s_waitcnt vmcnt(5)
buffer_load_dwordx4 v246, s[32:35], s45 offen offset:2112 nt lds
v_mfma_f32_16x16x32_bf16 a[160:163], a[196:199], v[208:211], a[160:163]
ds_read_b64_tr_b16 a[84:85], v241 offset:32
v_cvt_pk_bf16_f32 v248, v192, v193
v_mfma_f32_16x16x32_bf16 a[160:163], a[196:199], v[212:215], a[160:163]
s_waitcnt lgkmcnt(7)
ds_read_b64_tr_b16 a[86:87], v241 offset:544
v_exp_f32 v194, v194
v_mfma_f32_16x16x32_bf16 v[0:3], a[64:67], v[208:211], v[0:3]
ds_read_b64_tr_b16 a[116:117], v243 offset:32
v_exp_f32 v195, v195
v_mfma_f32_16x16x32_bf16 v[0:3], a[96:99], v[212:215], v[0:3]
ds_read_b64_tr_b16 a[118:119], v243 offset:544
v_cvt_pk_bf16_f32 v249, v194, v195
v_mfma_f32_16x16x32_bf16 v[4:7], a[68:71], v[208:211], v[4:7]
ds_read_b64_tr_b16 a[88:89], v241 offset:64
v_exp_f32 v196, v196
v_mfma_f32_16x16x32_bf16 v[4:7], a[100:103], v[212:215], v[4:7]
ds_read_b64_tr_b16 a[90:91], v241 offset:576
v_exp_f32 v197, v197
v_mfma_f32_16x16x32_bf16 v[8:11], a[72:75], v[208:211], v[8:11]
ds_read_b64_tr_b16 a[120:121], v243 offset:64
v_cvt_pk_bf16_f32 v250, v196, v197
v_mfma_f32_16x16x32_bf16 v[8:11], a[104:107], v[212:215], v[8:11]
ds_read_b64_tr_b16 a[122:123], v243 offset:576
v_mfma_f32_16x16x32_bf16 v[12:15], a[76:79], v[208:211], v[12:15]
s_waitcnt lgkmcnt(6)
ds_read_b64_tr_b16 a[92:93], v241 offset:96
v_mfma_f32_16x16x32_bf16 v[12:15], a[108:111], v[212:215], v[12:15]
ds_read_b64_tr_b16 a[94:95], v241 offset:608
v_exp_f32 v198, v198
v_mfma_f32_16x16x32_bf16 v[16:19], a[80:83], v[208:211], v[16:19]
ds_read_b64_tr_b16 a[124:125], v243 offset:96
v_mfma_f32_16x16x32_bf16 v[16:19], a[112:115], v[212:215], v[16:19]
ds_read_b64_tr_b16 a[126:127], v243 offset:608
v_mfma_f32_16x16x32_bf16 v[20:23], a[84:87], v[208:211], v[20:23]
s_waitcnt lgkmcnt(6)
s_waitcnt vmcnt(5)
buffer_load_dwordx4 v247, s[32:35], s45 offen offset:3168 nt lds
v_mfma_f32_16x16x32_bf16 v[20:23], a[116:119], v[212:215], v[20:23]
v_exp_f32 v199, v199
v_mfma_f32_16x16x32_bf16 v[24:27], a[88:91], v[208:211], v[24:27]
s_waitcnt lgkmcnt(4)
v_cvt_pk_bf16_f32 v251, v198, v199
s_add_u32 m0, s44, 119168
v_mfma_f32_16x16x32_bf16 v[24:27], a[120:123], v[212:215], v[24:27]
s_waitcnt lgkmcnt(2)
v_exp_f32 v200, v200
v_mfma_f32_16x16x32_bf16 v[28:31], a[92:95], v[208:211], v[28:31]
s_waitcnt lgkmcnt(0)
v_exp_f32 v201, v201
v_mfma_f32_16x16x32_bf16 v[28:31], a[124:127], v[212:215], v[28:31]
s_xor_b32 s45, s47, 90112
v_exp_f32 v202, v202
v_mfma_f32_16x16x32_bf16 v[192:195], a[0:3], v[160:163], v[224:227]
v_exp_f32 v203, v203
v_mfma_f32_16x16x32_bf16 v[192:195], a[4:7], v[164:167], v[192:195]
v_cvt_pk_bf16_f32 v208, v200, v201
v_cvt_pk_bf16_f32 v209, v202, v203
v_mfma_f32_16x16x32_bf16 v[192:195], a[8:11], v[168:171], v[192:195]
s_barrier
s_waitcnt vmcnt(5)
buffer_load_dwordx4 v244, s[32:35], s45 offen offset:0 nt lds
v_mfma_f32_16x16x32_bf16 v[192:195], a[12:15], v[172:175], v[192:195]
v_exp_f32 v204, v204
v_mfma_f32_16x16x32_bf16 v[196:199], a[16:19], v[160:163], v[224:227]
v_exp_f32 v205, v205
v_mfma_f32_16x16x32_bf16 v[196:199], a[20:23], v[164:167], v[196:199]
v_exp_f32 v206, v206
v_mfma_f32_16x16x32_bf16 v[196:199], a[24:27], v[168:171], v[196:199]
v_exp_f32 v207, v207
v_mfma_f32_16x16x32_bf16 v[196:199], a[28:31], v[172:175], v[196:199]
v_cvt_pk_bf16_f32 v210, v204, v205
v_cvt_pk_bf16_f32 v211, v206, v207
v_mfma_f32_16x16x32_bf16 v[200:203], a[32:35], v[160:163], v[224:227]
s_cmp_eq_u32 s3, 0
s_cbranch_scc1 Lisl7_0
s_cmp_eq_u32 s3, 1
s_cbranch_scc1 Lisl8_0
s_cmp_eq_u32 s3, 2
s_cbranch_scc1 Lisl9_0
s_cmp_eq_u32 s3, 3
s_cbranch_scc1 Lisl10_0
Lret1:
v_mfma_f32_16x16x32_bf16 v[200:203], a[36:39], v[164:167], v[200:203]
v_exp_f32 v192, v192
v_mfma_f32_16x16x32_bf16 v[200:203], a[40:43], v[168:171], v[200:203]
s_waitcnt vmcnt(5)
buffer_load_dwordx4 v245, s[32:35], s45 offen offset:1056 nt lds
v_mfma_f32_16x16x32_bf16 v[200:203], a[44:47], v[172:175], v[200:203]
v_exp_f32 v193, v193
v_mfma_f32_16x16x32_bf16 v[204:207], a[48:51], v[160:163], v[224:227]
v_exp_f32 v194, v194
v_mfma_f32_16x16x32_bf16 v[204:207], a[52:55], v[164:167], v[204:207]
v_exp_f32 v195, v195
v_mfma_f32_16x16x32_bf16 v[204:207], a[56:59], v[168:171], v[204:207]
v_cvt_pk_bf16_f32 v212, v192, v193
v_cvt_pk_bf16_f32 v213, v194, v195
v_mfma_f32_16x16x32_bf16 v[204:207], a[60:63], v[172:175], v[204:207]
v_exp_f32 v196, v196
v_mfma_f32_16x16x32_bf16 a[164:167], a[196:199], v[248:251], a[164:167]
v_exp_f32 v197, v197
v_mfma_f32_16x16x32_bf16 a[164:167], a[196:199], v[208:211], a[164:167]
v_exp_f32 v198, v198
v_mfma_f32_16x16x32_bf16 v[32:35], a[64:67], v[248:251], v[32:35]
v_exp_f32 v199, v199
v_mfma_f32_16x16x32_bf16 v[32:35], a[96:99], v[208:211], v[32:35]
v_cvt_pk_bf16_f32 v214, v196, v197
v_cvt_pk_bf16_f32 v215, v198, v199
v_mfma_f32_16x16x32_bf16 v[36:39], a[68:71], v[248:251], v[36:39]
s_waitcnt vmcnt(5)
buffer_load_dwordx4 v246, s[32:35], s45 offen offset:2112 nt lds
v_mfma_f32_16x16x32_bf16 v[36:39], a[100:103], v[208:211], v[36:39]
v_exp_f32 v200, v200
v_mfma_f32_16x16x32_bf16 v[40:43], a[72:75], v[248:251], v[40:43]
v_exp_f32 v201, v201
v_mfma_f32_16x16x32_bf16 v[40:43], a[104:107], v[208:211], v[40:43]
v_exp_f32 v202, v202
v_mfma_f32_16x16x32_bf16 v[44:47], a[76:79], v[248:251], v[44:47]
v_exp_f32 v203, v203
v_mfma_f32_16x16x32_bf16 v[44:47], a[108:111], v[208:211], v[44:47]
v_exp_f32 v204, v204
v_mfma_f32_16x16x32_bf16 v[48:51], a[80:83], v[248:251], v[48:51]
v_exp_f32 v205, v205
v_mfma_f32_16x16x32_bf16 v[48:51], a[112:115], v[208:211], v[48:51]
v_exp_f32 v206, v206
v_mfma_f32_16x16x32_bf16 v[52:55], a[84:87], v[248:251], v[52:55]
v_exp_f32 v207, v207
v_mfma_f32_16x16x32_bf16 v[52:55], a[116:119], v[208:211], v[52:55]
v_mfma_f32_16x16x32_bf16 v[56:59], a[88:91], v[248:251], v[56:59]
v_mfma_f32_16x16x32_bf16 v[56:59], a[120:123], v[208:211], v[56:59]
s_waitcnt vmcnt(5)
buffer_load_dwordx4 v247, s[32:35], s45 offen offset:3168 nt lds
v_mfma_f32_16x16x32_bf16 v[60:63], a[92:95], v[248:251], v[60:63]
v_mfma_f32_16x16x32_bf16 v[60:63], a[124:127], v[208:211], v[60:63]
v_cvt_pk_bf16_f32 v248, v200, v201
v_cvt_pk_bf16_f32 v249, v202, v203
v_mfma_f32_16x16x32_bf16 v[192:195], a[0:3], v[176:179], v[228:231]
v_cvt_pk_bf16_f32 v250, v204, v205
v_cvt_pk_bf16_f32 v251, v206, v207
v_mfma_f32_16x16x32_bf16 v[192:195], a[4:7], v[180:183], v[192:195]
v_mfma_f32_16x16x32_bf16 v[192:195], a[8:11], v[184:187], v[192:195]
v_mfma_f32_16x16x32_bf16 v[192:195], a[12:15], v[188:191], v[192:195]
v_mfma_f32_16x16x32_bf16 v[196:199], a[16:19], v[176:179], v[228:231]
v_mfma_f32_16x16x32_bf16 v[196:199], a[20:23], v[180:183], v[196:199]
v_lshlrev_b32 v254, 3, v252
s_and_b32 s52, s50, 7
v_mfma_f32_16x16x32_bf16 v[196:199], a[24:27], v[184:187], v[196:199]
s_lshl_b32 s53, s3, 6
s_add_u32 s52, s52, s53
s_lshl_b32 s52, s52, 7
v_mfma_f32_16x16x32_bf16 v[196:199], a[28:31], v[188:191], v[196:199]
v_and_b32 v254, 0x1c00, v254
v_add_u32 v254, s52, v254
v_mfma_f32_16x16x32_bf16 v[200:203], a[32:35], v[176:179], v[228:231]
s_getpc_b64 s[52:53]
Lpc3:
v_min_u32 v254, Lcode_end-Lpc3-4, v254
v_mov_b32 v255, 0
v_mfma_f32_16x16x32_bf16 v[200:203], a[36:39], v[180:183], v[200:203]
v_lshl_add_u64 v[254:255], v[254:255], 0, s[52:53]
v_mfma_f32_16x16x32_bf16 v[200:203], a[40:43], v[184:187], v[200:203]
global_load_dword v253, v[254:255], off
s_add_u32 m0, s44, 0
v_mfma_f32_16x16x32_bf16 v[200:203], a[44:47], v[188:191], v[200:203]
s_xor_b32 s45, s47, 98304
v_exp_f32 v192, v192
v_mfma_f32_16x16x32_bf16 v[204:207], a[48:51], v[176:179], v[228:231]
s_waitcnt vmcnt(5)
buffer_load_dwordx4 v244, s[28:31], s45 offen offset:0 nt lds
v_mfma_f32_16x16x32_bf16 v[204:207], a[52:55], v[180:183], v[204:207]
v_exp_f32 v193, v193
v_mfma_f32_16x16x32_bf16 v[204:207], a[56:59], v[184:187], v[204:207]
v_exp_f32 v194, v194
v_mfma_f32_16x16x32_bf16 v[204:207], a[60:63], v[188:191], v[204:207]
v_exp_f32 v195, v195
v_mfma_f32_16x16x32_bf16 a[168:171], a[196:199], v[212:215], a[168:171]
v_cvt_pk_bf16_f32 v208, v192, v193
v_cvt_pk_bf16_f32 v209, v194, v195
v_mfma_f32_16x16x32_bf16 a[168:171], a[196:199], v[248:251], a[168:171]
v_exp_f32 v196, v196
v_mfma_f32_16x16x32_bf16 v[64:67], a[64:67], v[212:215], v[64:67]
s_waitcnt vmcnt(5)
buffer_load_dwordx4 v245, s[28:31], s45 offen offset:1056 nt lds
v_mfma_f32_16x16x32_bf16 v[64:67], a[96:99], v[248:251], v[64:67]
v_exp_f32 v197, v197
v_mfma_f32_16x16x32_bf16 v[68:71], a[68:71], v[212:215], v[68:71]
v_exp_f32 v198, v198
v_mfma_f32_16x16x32_bf16 v[68:71], a[100:103], v[248:251], v[68:71]
v_exp_f32 v199, v199
v_mfma_f32_16x16x32_bf16 v[72:75], a[72:75], v[212:215], v[72:75]
v_cvt_pk_bf16_f32 v210, v196, v197
v_cvt_pk_bf16_f32 v211, v198, v199
v_mfma_f32_16x16x32_bf16 v[72:75], a[104:107], v[248:251], v[72:75]
v_exp_f32 v200, v200
v_mfma_f32_16x16x32_bf16 v[76:79], a[76:79], v[212:215], v[76:79]
v_exp_f32 v201, v201
v_mfma_f32_16x16x32_bf16 v[76:79], a[108:111], v[248:251], v[76:79]
v_exp_f32 v202, v202
v_mfma_f32_16x16x32_bf16 v[80:83], a[80:83], v[212:215], v[80:83]
v_exp_f32 v203, v203
v_mfma_f32_16x16x32_bf16 v[80:83], a[112:115], v[248:251], v[80:83]
v_exp_f32 v204, v204
v_mfma_f32_16x16x32_bf16 v[84:87], a[84:87], v[212:215], v[84:87]
v_exp_f32 v205, v205
v_mfma_f32_16x16x32_bf16 v[84:87], a[116:119], v[248:251], v[84:87]
s_waitcnt vmcnt(5)
buffer_load_dwordx4 v246, s[28:31], s45 offen offset:2112 nt lds
v_mfma_f32_16x16x32_bf16 v[88:91], a[88:91], v[212:215], v[88:91]
v_exp_f32 v206, v206
v_mfma_f32_16x16x32_bf16 v[88:91], a[120:123], v[248:251], v[88:91]
v_exp_f32 v207, v207
v_mfma_f32_16x16x32_bf16 v[92:95], a[92:95], v[212:215], v[92:95]
v_mfma_f32_16x16x32_bf16 v[92:95], a[124:127], v[248:251], v[92:95]
s_waitcnt vmcnt(12)
s_barrier
v_cvt_pk_bf16_f32 v212, v200, v201
v_mfma_f32_16x16x32_bf16 v[192:195], a[0:3], a[180:183], v[232:235]
ds_read_b128 a[0:3], v236 offset:34048
v_cvt_pk_bf16_f32 v213, v202, v203
v_mfma_f32_16x16x32_bf16 v[192:195], a[4:7], a[184:187], v[192:195]
ds_read_b128 a[4:7], v237 offset:34048
v_cvt_pk_bf16_f32 v214, v204, v205
v_mfma_f32_16x16x32_bf16 v[192:195], a[8:11], a[188:191], v[192:195]
ds_read_b128 a[8:11], v236 offset:34176
v_cvt_pk_bf16_f32 v215, v206, v207
v_mfma_f32_16x16x32_bf16 v[192:195], a[12:15], a[192:195], v[192:195]
ds_read_b128 a[12:15], v237 offset:34176
v_mfma_f32_16x16x32_bf16 v[196:199], a[16:19], a[180:183], v[232:235]
ds_read_b128 a[16:19], v236 offset:34560
v_mfma_f32_16x16x32_bf16 v[196:199], a[20:23], a[184:187], v[196:199]
ds_read_b128 a[20:23], v237 offset:34560
v_mfma_f32_16x16x32_bf16 v[196:199], a[24:27], a[188:191], v[196:199]
s_waitcnt vmcnt(5)
buffer_load_dwordx4 v247, s[28:31], s45 offen offset:3168 nt lds
v_mfma_f32_16x16x32_bf16 v[196:199], a[28:31], a[192:195], v[196:199]
ds_read_b128 a[24:27], v236 offset:34688
v_mfma_f32_16x16x32_bf16 a[172:175], a[196:199], v[208:211], a[172:175]
ds_read_b128 a[28:31], v237 offset:34688
v_mfma_f32_16x16x32_bf16 a[172:175], a[196:199], v[212:215], a[172:175]
ds_read_b128 a[32:35], v238 offset:34048
v_mfma_f32_16x16x32_bf16 v[96:99], a[64:67], v[208:211], v[96:99]
ds_read_b128 a[36:39], v239 offset:34048
v_mfma_f32_16x16x32_bf16 v[96:99], a[96:99], v[212:215], v[96:99]
ds_read_b128 a[40:43], v238 offset:34176
v_mfma_f32_16x16x32_bf16 v[100:103], a[68:71], v[208:211], v[100:103]
ds_read_b128 a[44:47], v239 offset:34176
v_mfma_f32_16x16x32_bf16 v[100:103], a[100:103], v[212:215], v[100:103]
s_add_u32 m0, s44, 17024
ds_read_b128 a[48:51], v238 offset:34560
s_xor_b32 s45, s47, 106496
v_mfma_f32_16x16x32_bf16 v[104:107], a[72:75], v[208:211], v[104:107]
v_exp_f32 v192, v192
v_mfma_f32_16x16x32_bf16 v[104:107], a[104:107], v[212:215], v[104:107]
v_exp_f32 v193, v193
v_mfma_f32_16x16x32_bf16 v[108:111], a[76:79], v[208:211], v[108:111]
s_waitcnt vmcnt(5)
buffer_load_dwordx4 v244, s[28:31], s45 offen offset:0 nt lds
v_mfma_f32_16x16x32_bf16 v[108:111], a[108:111], v[212:215], v[108:111]
v_exp_f32 v194, v194
v_mfma_f32_16x16x32_bf16 v[112:115], a[80:83], v[208:211], v[112:115]
v_exp_f32 v195, v195
v_mfma_f32_16x16x32_bf16 v[112:115], a[112:115], v[212:215], v[112:115]
ds_read_b128 a[52:55], v239 offset:34560
v_cvt_pk_bf16_f32 v248, v192, v193
v_mfma_f32_16x16x32_bf16 v[116:119], a[84:87], v[208:211], v[116:119]
ds_read_b128 a[56:59], v238 offset:34688
v_cvt_pk_bf16_f32 v249, v194, v195
v_mfma_f32_16x16x32_bf16 v[116:119], a[116:119], v[212:215], v[116:119]
ds_read_b128 a[60:63], v239 offset:34688
v_mfma_f32_16x16x32_bf16 v[120:123], a[88:91], v[208:211], v[120:123]
v_exp_f32 v196, v196
v_mfma_f32_16x16x32_bf16 v[120:123], a[120:123], v[212:215], v[120:123]
v_exp_f32 v197, v197
v_mfma_f32_16x16x32_bf16 v[124:127], a[92:95], v[208:211], v[124:127]
v_exp_f32 v198, v198
v_mfma_f32_16x16x32_bf16 v[124:127], a[124:127], v[212:215], v[124:127]
s_waitcnt lgkmcnt(3)
v_exp_f32 v199, v199
v_mfma_f32_16x16x32_bf16 v[200:203], a[0:3], v[128:131], v[216:219]
v_cvt_pk_bf16_f32 v250, v196, v197
v_cvt_pk_bf16_f32 v251, v198, v199
v_mfma_f32_16x16x32_bf16 v[200:203], a[4:7], v[132:135], v[200:203]
s_waitcnt vmcnt(5)
buffer_load_dwordx4 v245, s[28:31], s45 offen offset:1056 nt lds
v_mfma_f32_16x16x32_bf16 v[200:203], a[8:11], v[136:139], v[200:203]
v_mfma_f32_16x16x32_bf16 v[200:203], a[12:15], v[140:143], v[200:203]
v_mfma_f32_16x16x32_bf16 v[204:207], a[16:19], v[128:131], v[216:219]
v_mfma_f32_16x16x32_bf16 v[204:207], a[20:23], v[132:135], v[204:207]
v_mfma_f32_16x16x32_bf16 v[204:207], a[24:27], v[136:139], v[204:207]
s_nop 4
v_exp_f32 v200, v200
v_mfma_f32_16x16x32_bf16 v[204:207], a[28:31], v[140:143], v[204:207]
v_exp_f32 v201, v201
v_mfma_f32_16x16x32_bf16 v[192:195], a[32:35], v[128:131], v[216:219]
v_exp_f32 v202, v202
v_mfma_f32_16x16x32_bf16 v[192:195], a[36:39], v[132:135], v[192:195]
v_exp_f32 v203, v203
v_mfma_f32_16x16x32_bf16 v[192:195], a[40:43], v[136:139], v[192:195]
v_cvt_pk_bf16_f32 v208, v200, v201
v_cvt_pk_bf16_f32 v209, v202, v203
v_mfma_f32_16x16x32_bf16 v[192:195], a[44:47], v[140:143], v[192:195]
v_exp_f32 v204, v204
v_mfma_f32_16x16x32_bf16 v[196:199], a[48:51], v[128:131], v[216:219]
s_waitcnt lgkmcnt(0)
s_waitcnt vmcnt(5)
buffer_load_dwordx4 v246, s[28:31], s45 offen offset:2112 nt lds
v_mfma_f32_16x16x32_bf16 v[196:199], a[52:55], v[132:135], v[196:199]
v_exp_f32 v205, v205
v_mfma_f32_16x16x32_bf16 v[196:199], a[56:59], v[136:139], v[196:199]
s_waitcnt vmcnt(8)
s_barrier
v_cvt_pk_bf16_f32 v210, v204, v205
v_mfma_f32_16x16x32_bf16 v[196:199], a[60:63], v[140:143], v[196:199]
v_exp_f32 v206, v206
v_mfma_f32_16x16x32_bf16 a[176:179], a[196:199], v[248:251], a[176:179]
v_exp_f32 v207, v207
v_mfma_f32_16x16x32_bf16 a[128:131], a[64:67], v[248:251], a[128:131]
ds_read_b64_tr_b16 a[200:201], v240 offset:34048
v_cvt_pk_bf16_f32 v211, v206, v207
v_mfma_f32_16x16x32_bf16 a[132:135], a[68:71], v[248:251], a[132:135]
v_exp_f32 v192, v192
v_mfma_f32_16x16x32_bf16 a[136:139], a[72:75], v[248:251], a[136:139]
v_exp_f32 v193, v193
v_mfma_f32_16x16x32_bf16 a[140:143], a[76:79], v[248:251], a[140:143]
v_exp_f32 v194, v194
v_mfma_f32_16x16x32_bf16 a[144:147], a[80:83], v[248:251], a[144:147]
v_exp_f32 v195, v195
v_mfma_f32_16x16x32_bf16 a[148:151], a[84:87], v[248:251], a[148:151]
ds_read_b64_tr_b16 a[202:203], v240 offset:34560
v_cvt_pk_bf16_f32 v212, v192, v193
v_mfma_f32_16x16x32_bf16 a[152:155], a[88:91], v[248:251], a[152:155]
ds_read_b64_tr_b16 a[96:97], v242 offset:34048
v_cvt_pk_bf16_f32 v213, v194, v195
v_mfma_f32_16x16x32_bf16 a[156:159], a[92:95], v[248:251], a[156:159]
s_waitcnt vmcnt(5)
buffer_load_dwordx4 v247, s[28:31], s45 offen offset:3168 nt lds
v_mfma_f32_16x16x32_bf16 v[200:203], a[0:3], v[144:147], v[220:223]
v_exp_f32 v196, v196
v_mfma_f32_16x16x32_bf16 v[200:203], a[4:7], v[148:151], v[200:203]
v_exp_f32 v197, v197
v_mfma_f32_16x16x32_bf16 v[200:203], a[8:11], v[152:155], v[200:203]
v_exp_f32 v198, v198
v_mfma_f32_16x16x32_bf16 v[200:203], a[12:15], v[156:159], v[200:203]
v_exp_f32 v199, v199
v_mfma_f32_16x16x32_bf16 v[204:207], a[16:19], v[144:147], v[220:223]
ds_read_b64_tr_b16 a[98:99], v242 offset:34560
v_cvt_pk_bf16_f32 v214, v196, v197
v_mfma_f32_16x16x32_bf16 v[204:207], a[20:23], v[148:151], v[204:207]
s_add_u32 m0, s44, 68096
ds_read_b64_tr_b16 a[204:205], v240 offset:34080
v_cvt_pk_bf16_f32 v215, v198, v199
v_mfma_f32_16x16x32_bf16 v[204:207], a[24:27], v[152:155], v[204:207]
s_xor_b32 s45, s47, 98304
ds_read_b64_tr_b16 a[206:207], v240 offset:34592
ds_read_b64_tr_b16 a[100:101], v242 offset:34080
v_mfma_f32_16x16x32_bf16 v[204:207], a[28:31], v[156:159], v[204:207]
ds_read_b64_tr_b16 a[102:103], v242 offset:34592
ds_read_b64_tr_b16 a[208:209], v240 offset:34112
v_mfma_f32_16x16x32_bf16 v[192:195], a[32:35], v[144:147], v[220:223]
ds_read_b64_tr_b16 a[210:211], v240 offset:34624
ds_read_b64_tr_b16 a[104:105], v242 offset:34112
v_mfma_f32_16x16x32_bf16 v[192:195], a[36:39], v[148:151], v[192:195]
ds_read_b64_tr_b16 a[106:107], v242 offset:34624
ds_read_b64_tr_b16 a[212:213], v240 offset:34144
v_mfma_f32_16x16x32_bf16 v[192:195], a[40:43], v[152:155], v[192:195]
ds_read_b64_tr_b16 a[214:215], v240 offset:34656
ds_read_b64_tr_b16 a[108:109], v242 offset:34144
v_mfma_f32_16x16x32_bf16 v[192:195], a[44:47], v[156:159], v[192:195]
s_waitcnt vmcnt(5)
buffer_load_dwordx4 v244, s[32:35], s45 offen offset:0 nt lds
v_mfma_f32_16x16x32_bf16 v[196:199], a[48:51], v[144:147], v[220:223]
ds_read_b64_tr_b16 a[110:111], v242 offset:34656
ds_read_b64_tr_b16 a[216:217], v241 offset:34048
v_mfma_f32_16x16x32_bf16 v[196:199], a[52:55], v[148:151], v[196:199]
ds_read_b64_tr_b16 a[218:219], v241 offset:34560
v_exp_f32 v200, v200
v_mfma_f32_16x16x32_bf16 v[196:199], a[56:59], v[152:155], v[196:199]
ds_read_b64_tr_b16 a[112:113], v243 offset:34048
v_exp_f32 v201, v201
v_mfma_f32_16x16x32_bf16 v[196:199], a[60:63], v[156:159], v[196:199]
ds_read_b64_tr_b16 a[114:115], v243 offset:34560
v_cvt_pk_bf16_f32 v248, v200, v201
v_mfma_f32_16x16x32_bf16 a[160:163], a[196:199], v[208:211], a[160:163]
ds_read_b64_tr_b16 a[220:221], v241 offset:34080
v_exp_f32 v202, v202
v_mfma_f32_16x16x32_bf16 a[160:163], a[196:199], v[212:215], a[160:163]
s_waitcnt lgkmcnt(6)
ds_read_b64_tr_b16 a[222:223], v241 offset:34592
v_exp_f32 v203, v203
v_mfma_f32_16x16x32_bf16 v[0:3], a[200:203], v[208:211], v[0:3]
ds_read_b64_tr_b16 a[116:117], v243 offset:34080
v_cvt_pk_bf16_f32 v249, v202, v203
v_mfma_f32_16x16x32_bf16 v[0:3], a[96:99], v[212:215], v[0:3]
ds_read_b64_tr_b16 a[118:119], v243 offset:34592
v_exp_f32 v204, v204
v_mfma_f32_16x16x32_bf16 v[4:7], a[204:207], v[208:211], v[4:7]
ds_read_b64_tr_b16 a[224:225], v241 offset:34112
v_exp_f32 v205, v205
v_mfma_f32_16x16x32_bf16 v[4:7], a[100:103], v[212:215], v[4:7]
ds_read_b64_tr_b16 a[226:227], v241 offset:34624
v_cvt_pk_bf16_f32 v250, v204, v205
v_mfma_f32_16x16x32_bf16 v[8:11], a[208:211], v[208:211], v[8:11]
ds_read_b64_tr_b16 a[120:121], v243 offset:34112
v_mfma_f32_16x16x32_bf16 v[8:11], a[104:107], v[212:215], v[8:11]
ds_read_b64_tr_b16 a[122:123], v243 offset:34624
v_mfma_f32_16x16x32_bf16 v[12:15], a[212:215], v[208:211], v[12:15]
s_waitcnt lgkmcnt(6)
ds_read_b64_tr_b16 a[228:229], v241 offset:34144
v_mfma_f32_16x16x32_bf16 v[12:15], a[108:111], v[212:215], v[12:15]
ds_read_b64_tr_b16 a[230:231], v241 offset:34656
v_exp_f32 v206, v206
v_mfma_f32_16x16x32_bf16 v[16:19], a[216:219], v[208:211], v[16:19]
ds_read_b64_tr_b16 a[124:125], v243 offset:34144
v_mfma_f32_16x16x32_bf16 v[16:19], a[112:115], v[212:215], v[16:19]
ds_read_b64_tr_b16 a[126:127], v243 offset:34656
v_mfma_f32_16x16x32_bf16 v[20:23], a[220:223], v[208:211], v[20:23]
s_waitcnt lgkmcnt(6)
s_waitcnt vmcnt(5)
buffer_load_dwordx4 v245, s[32:35], s45 offen offset:1056 nt lds
v_mfma_f32_16x16x32_bf16 v[20:23], a[116:119], v[212:215], v[20:23]
v_exp_f32 v207, v207
v_mfma_f32_16x16x32_bf16 v[24:27], a[224:227], v[208:211], v[24:27]
s_waitcnt lgkmcnt(4)
v_cvt_pk_bf16_f32 v251, v206, v207
v_mfma_f32_16x16x32_bf16 v[24:27], a[120:123], v[212:215], v[24:27]
s_waitcnt lgkmcnt(2)
s_waitcnt vmcnt(5)
buffer_load_dwordx4 v246, s[32:35], s45 offen offset:2112 nt lds
v_mfma_f32_16x16x32_bf16 v[28:31], a[228:231], v[208:211], v[28:31]
s_waitcnt lgkmcnt(0)
v_exp_f32 v192, v192
v_mfma_f32_16x16x32_bf16 v[28:31], a[124:127], v[212:215], v[28:31]
v_exp_f32 v193, v193
v_mfma_f32_16x16x32_bf16 v[200:203], a[0:3], v[160:163], v[224:227]
v_exp_f32 v194, v194
v_mfma_f32_16x16x32_bf16 v[200:203], a[4:7], v[164:167], v[200:203]
v_exp_f32 v195, v195
v_mfma_f32_16x16x32_bf16 v[200:203], a[8:11], v[168:171], v[200:203]
s_barrier
v_cvt_pk_bf16_f32 v208, v192, v193
v_cvt_pk_bf16_f32 v209, v194, v195
v_mfma_f32_16x16x32_bf16 v[200:203], a[12:15], v[172:175], v[200:203]
v_exp_f32 v196, v196
v_mfma_f32_16x16x32_bf16 v[204:207], a[16:19], v[160:163], v[224:227]
v_exp_f32 v197, v197
v_mfma_f32_16x16x32_bf16 v[204:207], a[20:23], v[164:167], v[204:207]
v_exp_f32 v198, v198
v_mfma_f32_16x16x32_bf16 v[204:207], a[24:27], v[168:171], v[204:207]
v_exp_f32 v199, v199
v_mfma_f32_16x16x32_bf16 v[204:207], a[28:31], v[172:175], v[204:207]
v_cvt_pk_bf16_f32 v210, v196, v197
v_cvt_pk_bf16_f32 v211, v198, v199
v_mfma_f32_16x16x32_bf16 v[192:195], a[32:35], v[160:163], v[224:227]
s_waitcnt vmcnt(5)
buffer_load_dwordx4 v247, s[32:35], s45 offen offset:3168 nt lds
v_mfma_f32_16x16x32_bf16 v[192:195], a[36:39], v[164:167], v[192:195]
v_exp_f32 v200, v200
v_mfma_f32_16x16x32_bf16 v[192:195], a[40:43], v[168:171], v[192:195]
v_exp_f32 v201, v201
v_mfma_f32_16x16x32_bf16 v[192:195], a[44:47], v[172:175], v[192:195]
v_exp_f32 v202, v202
v_mfma_f32_16x16x32_bf16 v[196:199], a[48:51], v[160:163], v[224:227]
v_exp_f32 v203, v203
v_mfma_f32_16x16x32_bf16 v[196:199], a[52:55], v[164:167], v[196:199]
v_cvt_pk_bf16_f32 v212, v200, v201
v_cvt_pk_bf16_f32 v213, v202, v203
v_mfma_f32_16x16x32_bf16 v[196:199], a[56:59], v[168:171], v[196:199]
s_add_u32 m0, s44, 85120
s_xor_b32 s45, s47, 106496
v_mfma_f32_16x16x32_bf16 v[196:199], a[60:63], v[172:175], v[196:199]
v_exp_f32 v204, v204
v_mfma_f32_16x16x32_bf16 a[164:167], a[196:199], v[248:251], a[164:167]
v_exp_f32 v205, v205
v_mfma_f32_16x16x32_bf16 a[164:167], a[196:199], v[208:211], a[164:167]
s_waitcnt vmcnt(5)
buffer_load_dwordx4 v244, s[32:35], s45 offen offset:0 nt lds
v_mfma_f32_16x16x32_bf16 v[32:35], a[200:203], v[248:251], v[32:35]
v_exp_f32 v206, v206
v_mfma_f32_16x16x32_bf16 v[32:35], a[96:99], v[208:211], v[32:35]
v_exp_f32 v207, v207
v_mfma_f32_16x16x32_bf16 v[36:39], a[204:207], v[248:251], v[36:39]
v_cvt_pk_bf16_f32 v214, v204, v205
v_cvt_pk_bf16_f32 v215, v206, v207
v_mfma_f32_16x16x32_bf16 v[36:39], a[100:103], v[208:211], v[36:39]
v_exp_f32 v192, v192
v_mfma_f32_16x16x32_bf16 v[40:43], a[208:211], v[248:251], v[40:43]
v_exp_f32 v193, v193
v_mfma_f32_16x16x32_bf16 v[40:43], a[104:107], v[208:211], v[40:43]
v_exp_f32 v194, v194
v_mfma_f32_16x16x32_bf16 v[44:47], a[212:215], v[248:251], v[44:47]
v_exp_f32 v195, v195
v_mfma_f32_16x16x32_bf16 v[44:47], a[108:111], v[208:211], v[44:47]
v_exp_f32 v196, v196
v_mfma_f32_16x16x32_bf16 v[48:51], a[216:219], v[248:251], v[48:51]
v_exp_f32 v197, v197
v_mfma_f32_16x16x32_bf16 v[48:51], a[112:115], v[208:211], v[48:51]
s_waitcnt vmcnt(5)
buffer_load_dwordx4 v245, s[32:35], s45 offen offset:1056 nt lds
v_mfma_f32_16x16x32_bf16 v[52:55], a[220:223], v[248:251], v[52:55]
v_exp_f32 v198, v198
v_mfma_f32_16x16x32_bf16 v[52:55], a[116:119], v[208:211], v[52:55]
v_exp_f32 v199, v199
v_mfma_f32_16x16x32_bf16 v[56:59], a[224:227], v[248:251], v[56:59]
v_mfma_f32_16x16x32_bf16 v[56:59], a[120:123], v[208:211], v[56:59]
v_mfma_f32_16x16x32_bf16 v[60:63], a[228:231], v[248:251], v[60:63]
v_mfma_f32_16x16x32_bf16 v[60:63], a[124:127], v[208:211], v[60:63]
v_cvt_pk_bf16_f32 v248, v192, v193
v_cvt_pk_bf16_f32 v249, v194, v195
v_mfma_f32_16x16x32_bf16 v[200:203], a[0:3], v[176:179], v[228:231]
v_cvt_pk_bf16_f32 v250, v196, v197
v_cvt_pk_bf16_f32 v251, v198, v199
v_mfma_f32_16x16x32_bf16 v[200:203], a[4:7], v[180:183], v[200:203]
v_mfma_f32_16x16x32_bf16 v[200:203], a[8:11], v[184:187], v[200:203]
v_mfma_f32_16x16x32_bf16 v[200:203], a[12:15], v[188:191], v[200:203]
v_mfma_f32_16x16x32_bf16 v[204:207], a[16:19], v[176:179], v[228:231]
s_waitcnt vmcnt(5)
buffer_load_dwordx4 v246, s[32:35], s45 offen offset:2112 nt lds
v_mfma_f32_16x16x32_bf16 v[204:207], a[20:23], v[180:183], v[204:207]
v_mfma_f32_16x16x32_bf16 v[204:207], a[24:27], v[184:187], v[204:207]
s_nop 3
v_exp_f32 v200, v200
v_mfma_f32_16x16x32_bf16 v[204:207], a[28:31], v[188:191], v[204:207]
v_exp_f32 v201, v201
v_mfma_f32_16x16x32_bf16 v[192:195], a[32:35], v[176:179], v[228:231]
v_exp_f32 v202, v202
v_mfma_f32_16x16x32_bf16 v[192:195], a[36:39], v[180:183], v[192:195]
v_exp_f32 v203, v203
v_mfma_f32_16x16x32_bf16 v[192:195], a[40:43], v[184:187], v[192:195]
v_cvt_pk_bf16_f32 v208, v200, v201
v_cvt_pk_bf16_f32 v209, v202, v203
v_mfma_f32_16x16x32_bf16 v[192:195], a[44:47], v[188:191], v[192:195]
v_exp_f32 v204, v204
v_mfma_f32_16x16x32_bf16 v[196:199], a[48:51], v[176:179], v[228:231]
v_exp_f32 v205, v205
v_mfma_f32_16x16x32_bf16 v[196:199], a[52:55], v[180:183], v[196:199]
v_exp_f32 v206, v206
v_mfma_f32_16x16x32_bf16 v[196:199], a[56:59], v[184:187], v[196:199]
s_waitcnt vmcnt(5)
buffer_load_dwordx4 v247, s[32:35], s45 offen offset:3168 nt lds
v_mfma_f32_16x16x32_bf16 v[196:199], a[60:63], v[188:191], v[196:199]
v_exp_f32 v207, v207
v_mfma_f32_16x16x32_bf16 a[168:171], a[196:199], v[212:215], a[168:171]
v_cvt_pk_bf16_f32 v210, v204, v205
v_cvt_pk_bf16_f32 v211, v206, v207
v_mfma_f32_16x16x32_bf16 a[168:171], a[196:199], v[248:251], a[168:171]
v_exp_f32 v192, v192
v_mfma_f32_16x16x32_bf16 v[64:67], a[200:203], v[212:215], v[64:67]
v_exp_f32 v193, v193
v_mfma_f32_16x16x32_bf16 v[64:67], a[96:99], v[248:251], v[64:67]
v_exp_f32 v194, v194
v_mfma_f32_16x16x32_bf16 v[68:71], a[204:207], v[212:215], v[68:71]
v_exp_f32 v195, v195
v_mfma_f32_16x16x32_bf16 v[68:71], a[100:103], v[248:251], v[68:71]
v_exp_f32 v196, v196
v_mfma_f32_16x16x32_bf16 v[72:75], a[208:211], v[212:215], v[72:75]
s_add_u32 m0, s44, 34048
s_xor_b32 s45, s47, 114688
v_mfma_f32_16x16x32_bf16 v[72:75], a[104:107], v[248:251], v[72:75]
v_exp_f32 v197, v197
v_mfma_f32_16x16x32_bf16 v[76:79], a[212:215], v[212:215], v[76:79]
v_exp_f32 v198, v198
v_mfma_f32_16x16x32_bf16 v[76:79], a[108:111], v[248:251], v[76:79]
s_waitcnt vmcnt(5)
buffer_load_dwordx4 v244, s[28:31], s45 offen offset:0 nt lds
v_mfma_f32_16x16x32_bf16 v[80:83], a[216:219], v[212:215], v[80:83]
v_exp_f32 v199, v199
v_mfma_f32_16x16x32_bf16 v[80:83], a[112:115], v[248:251], v[80:83]
v_mfma_f32_16x16x32_bf16 v[84:87], a[220:223], v[212:215], v[84:87]
v_mfma_f32_16x16x32_bf16 v[84:87], a[116:119], v[248:251], v[84:87]
v_mfma_f32_16x16x32_bf16 v[88:91], a[224:227], v[212:215], v[88:91]
v_mfma_f32_16x16x32_bf16 v[88:91], a[120:123], v[248:251], v[88:91]
v_mfma_f32_16x16x32_bf16 v[92:95], a[228:231], v[212:215], v[92:95]
v_mfma_f32_16x16x32_bf16 v[92:95], a[124:127], v[248:251], v[92:95]
s_waitcnt vmcnt(9)
s_barrier
v_cvt_pk_bf16_f32 v212, v192, v193
v_mfma_f32_16x16x32_bf16 v[200:203], a[0:3], a[180:183], v[232:235]
ds_read_b128 a[0:3], v236 offset:0
v_cvt_pk_bf16_f32 v213, v194, v195
v_mfma_f32_16x16x32_bf16 v[200:203], a[4:7], a[184:187], v[200:203]
ds_read_b128 a[4:7], v237 offset:0
v_cvt_pk_bf16_f32 v214, v196, v197
v_mfma_f32_16x16x32_bf16 v[200:203], a[8:11], a[188:191], v[200:203]
ds_read_b128 a[8:11], v236 offset:128
v_cvt_pk_bf16_f32 v215, v198, v199
v_mfma_f32_16x16x32_bf16 v[200:203], a[12:15], a[192:195], v[200:203]
s_waitcnt vmcnt(5)
buffer_load_dwordx4 v245, s[28:31], s45 offen offset:1056 nt lds
v_mfma_f32_16x16x32_bf16 v[204:207], a[16:19], a[180:183], v[232:235]
ds_read_b128 a[12:15], v237 offset:128
v_mfma_f32_16x16x32_bf16 v[204:207], a[20:23], a[184:187], v[204:207]
ds_read_b128 a[16:19], v236 offset:512
v_mfma_f32_16x16x32_bf16 v[204:207], a[24:27], a[188:191], v[204:207]
ds_read_b128 a[20:23], v237 offset:512
v_mfma_f32_16x16x32_bf16 v[204:207], a[28:31], a[192:195], v[204:207]
ds_read_b128 a[24:27], v236 offset:640
v_mfma_f32_16x16x32_bf16 a[172:175], a[196:199], v[208:211], a[172:175]
ds_read_b128 a[28:31], v237 offset:640
v_mfma_f32_16x16x32_bf16 a[172:175], a[196:199], v[212:215], a[172:175]
ds_read_b128 a[32:35], v238 offset:0
v_mfma_f32_16x16x32_bf16 v[96:99], a[200:203], v[208:211], v[96:99]
ds_read_b128 a[36:39], v239 offset:0
v_mfma_f32_16x16x32_bf16 v[96:99], a[96:99], v[212:215], v[96:99]
ds_read_b128 a[40:43], v238 offset:128
v_mfma_f32_16x16x32_bf16 v[100:103], a[204:207], v[208:211], v[100:103]
s_waitcnt vmcnt(5)
buffer_load_dwordx4 v246, s[28:31], s45 offen offset:2112 nt lds
v_mfma_f32_16x16x32_bf16 v[100:103], a[100:103], v[212:215], v[100:103]
ds_read_b128 a[44:47], v239 offset:128
v_mfma_f32_16x16x32_bf16 v[104:107], a[208:211], v[208:211], v[104:107]
ds_read_b128 a[48:51], v238 offset:512
v_mfma_f32_16x16x32_bf16 v[104:107], a[104:107], v[212:215], v[104:107]
v_exp_f32 v200, v200
v_mfma_f32_16x16x32_bf16 v[108:111], a[212:215], v[208:211], v[108:111]
v_exp_f32 v201, v201
v_mfma_f32_16x16x32_bf16 v[108:111], a[108:111], v[212:215], v[108:111]
v_exp_f32 v202, v202
v_mfma_f32_16x16x32_bf16 v[112:115], a[216:219], v[208:211], v[112:115]
v_exp_f32 v203, v203
v_mfma_f32_16x16x32_bf16 v[112:115], a[112:115], v[212:215], v[112:115]
ds_read_b128 a[52:55], v239 offset:512
v_cvt_pk_bf16_f32 v248, v200, v201
v_mfma_f32_16x16x32_bf16 v[116:119], a[220:223], v[208:211], v[116:119]
ds_read_b128 a[56:59], v238 offset:640
v_cvt_pk_bf16_f32 v249, v202, v203
v_mfma_f32_16x16x32_bf16 v[116:119], a[116:119], v[212:215], v[116:119]
ds_read_b128 a[60:63], v239 offset:640
v_mfma_f32_16x16x32_bf16 v[120:123], a[224:227], v[208:211], v[120:123]
v_exp_f32 v204, v204
v_mfma_f32_16x16x32_bf16 v[120:123], a[120:123], v[212:215], v[120:123]
s_waitcnt vmcnt(5)
buffer_load_dwordx4 v247, s[28:31], s45 offen offset:3168 nt lds
v_mfma_f32_16x16x32_bf16 v[124:127], a[228:231], v[208:211], v[124:127]
v_exp_f32 v205, v205
v_mfma_f32_16x16x32_bf16 v[124:127], a[124:127], v[212:215], v[124:127]
s_waitcnt lgkmcnt(3)
v_exp_f32 v206, v206
v_mfma_f32_16x16x32_bf16 v[192:195], a[0:3], v[128:131], v[216:219]
v_exp_f32 v207, v207
v_mfma_f32_16x16x32_bf16 v[192:195], a[4:7], v[132:135], v[192:195]
v_cvt_pk_bf16_f32 v250, v204, v205
v_cvt_pk_bf16_f32 v251, v206, v207
v_mfma_f32_16x16x32_bf16 v[192:195], a[8:11], v[136:139], v[192:195]
v_mfma_f32_16x16x32_bf16 v[192:195], a[12:15], v[140:143], v[192:195]
v_mfma_f32_16x16x32_bf16 v[196:199], a[16:19], v[128:131], v[216:219]
v_mfma_f32_16x16x32_bf16 v[196:199], a[20:23], v[132:135], v[196:199]
s_add_u32 m0, s44, 51072
s_xor_b32 s45, s47, 122880
v_mfma_f32_16x16x32_bf16 v[196:199], a[24:27], v[136:139], v[196:199]
s_nop 2
v_exp_f32 v192, v192
v_mfma_f32_16x16x32_bf16 v[196:199], a[28:31], v[140:143], v[196:199]
v_exp_f32 v193, v193
v_mfma_f32_16x16x32_bf16 v[200:203], a[32:35], v[128:131], v[216:219]
s_waitcnt vmcnt(5)
buffer_load_dwordx4 v244, s[28:31], s45 offen offset:0 nt lds
v_mfma_f32_16x16x32_bf16 v[200:203], a[36:39], v[132:135], v[200:203]
v_exp_f32 v194, v194
v_mfma_f32_16x16x32_bf16 v[200:203], a[40:43], v[136:139], v[200:203]
v_exp_f32 v195, v195
v_mfma_f32_16x16x32_bf16 v[200:203], a[44:47], v[140:143], v[200:203]
v_cvt_pk_bf16_f32 v208, v192, v193
v_cvt_pk_bf16_f32 v209, v194, v195
v_mfma_f32_16x16x32_bf16 v[204:207], a[48:51], v[128:131], v[216:219]
s_waitcnt lgkmcnt(0)
v_exp_f32 v196, v196
v_mfma_f32_16x16x32_bf16 v[204:207], a[52:55], v[132:135], v[204:207]
v_exp_f32 v197, v197
v_mfma_f32_16x16x32_bf16 v[204:207], a[56:59], v[136:139], v[204:207]
s_waitcnt vmcnt(5)
s_barrier
v_cvt_pk_bf16_f32 v210, v196, v197
v_mfma_f32_16x16x32_bf16 v[204:207], a[60:63], v[140:143], v[204:207]
v_exp_f32 v198, v198
v_mfma_f32_16x16x32_bf16 a[176:179], a[196:199], v[248:251], a[176:179]
v_exp_f32 v199, v199
v_mfma_f32_16x16x32_bf16 a[128:131], a[200:203], v[248:251], a[128:131]
ds_read_b64_tr_b16 a[64:65], v240 offset:0
v_cvt_pk_bf16_f32 v211, v198, v199
v_mfma_f32_16x16x32_bf16 a[132:135], a[204:207], v[248:251], a[132:135]
s_waitcnt vmcnt(5)
buffer_load_dwordx4 v245, s[28:31], s45 offen offset:1056 nt lds
v_mfma_f32_16x16x32_bf16 a[136:139], a[208:211], v[248:251], a[136:139]
v_exp_f32 v200, v200
v_mfma_f32_16x16x32_bf16 a[140:143], a[212:215], v[248:251], a[140:143]
v_exp_f32 v201, v201
v_mfma_f32_16x16x32_bf16 a[144:147], a[216:219], v[248:251], a[144:147]
v_exp_f32 v202, v202
v_mfma_f32_16x16x32_bf16 a[148:151], a[220:223], v[248:251], a[148:151]
v_exp_f32 v203, v203
v_mfma_f32_16x16x32_bf16 a[152:155], a[224:227], v[248:251], a[152:155]
ds_read_b64_tr_b16 a[66:67], v240 offset:512
v_cvt_pk_bf16_f32 v212, v200, v201
v_mfma_f32_16x16x32_bf16 a[156:159], a[228:231], v[248:251], a[156:159]
ds_read_b64_tr_b16 a[96:97], v242 offset:0
v_cvt_pk_bf16_f32 v213, v202, v203
v_mfma_f32_16x16x32_bf16 v[192:195], a[0:3], v[144:147], v[220:223]
v_exp_f32 v204, v204
v_mfma_f32_16x16x32_bf16 v[192:195], a[4:7], v[148:151], v[192:195]
v_exp_f32 v205, v205
v_mfma_f32_16x16x32_bf16 v[192:195], a[8:11], v[152:155], v[192:195]
v_exp_f32 v206, v206
v_mfma_f32_16x16x32_bf16 v[192:195], a[12:15], v[156:159], v[192:195]
v_exp_f32 v207, v207
v_mfma_f32_16x16x32_bf16 v[196:199], a[16:19], v[144:147], v[220:223]
ds_read_b64_tr_b16 a[98:99], v242 offset:512
v_cvt_pk_bf16_f32 v214, v204, v205
v_mfma_f32_16x16x32_bf16 v[196:199], a[20:23], v[148:151], v[196:199]
ds_read_b64_tr_b16 a[68:69], v240 offset:32
v_cvt_pk_bf16_f32 v215, v206, v207
v_mfma_f32_16x16x32_bf16 v[196:199], a[24:27], v[152:155], v[196:199]
ds_read_b64_tr_b16 a[70:71], v240 offset:544
ds_read_b64_tr_b16 a[100:101], v242 offset:32
v_mfma_f32_16x16x32_bf16 v[196:199], a[28:31], v[156:159], v[196:199]
s_waitcnt vmcnt(5)
buffer_load_dwordx4 v246, s[28:31], s45 offen offset:2112 nt lds
v_mfma_f32_16x16x32_bf16 v[200:203], a[32:35], v[144:147], v[220:223]
ds_read_b64_tr_b16 a[102:103], v242 offset:544
ds_read_b64_tr_b16 a[72:73], v240 offset:64
v_mfma_f32_16x16x32_bf16 v[200:203], a[36:39], v[148:151], v[200:203]
ds_read_b64_tr_b16 a[74:75], v240 offset:576
ds_read_b64_tr_b16 a[104:105], v242 offset:64
v_mfma_f32_16x16x32_bf16 v[200:203], a[40:43], v[152:155], v[200:203]
ds_read_b64_tr_b16 a[106:107], v242 offset:576
ds_read_b64_tr_b16 a[76:77], v240 offset:96
v_mfma_f32_16x16x32_bf16 v[200:203], a[44:47], v[156:159], v[200:203]
ds_read_b64_tr_b16 a[78:79], v240 offset:608
ds_read_b64_tr_b16 a[108:109], v242 offset:96
v_mfma_f32_16x16x32_bf16 v[204:207], a[48:51], v[144:147], v[220:223]
ds_read_b64_tr_b16 a[110:111], v242 offset:608
ds_read_b64_tr_b16 a[80:81], v241 offset:0
v_mfma_f32_16x16x32_bf16 v[204:207], a[52:55], v[148:151], v[204:207]
ds_read_b64_tr_b16 a[82:83], v241 offset:512
ds_read_b64_tr_b16 a[112:113], v243 offset:0
v_mfma_f32_16x16x32_bf16 v[204:207], a[56:59], v[152:155], v[204:207]
ds_read_b64_tr_b16 a[114:115], v243 offset:512
v_exp_f32 v192, v192
v_mfma_f32_16x16x32_bf16 v[204:207], a[60:63], v[156:159], v[204:207]
ds_read_b64_tr_b16 a[84:85], v241 offset:32
v_exp_f32 v193, v193
v_mfma_f32_16x16x32_bf16 a[160:163], a[196:199], v[208:211], a[160:163]
ds_read_b64_tr_b16 a[86:87], v241 offset:544
v_cvt_pk_bf16_f32 v248, v192, v193
v_mfma_f32_16x16x32_bf16 a[160:163], a[196:199], v[212:215], a[160:163]
s_waitcnt lgkmcnt(9)
ds_read_b64_tr_b16 a[116:117], v243 offset:32
v_exp_f32 v194, v194
v_mfma_f32_16x16x32_bf16 v[0:3], a[64:67], v[208:211], v[0:3]
ds_read_b64_tr_b16 a[118:119], v243 offset:544
v_exp_f32 v195, v195
v_mfma_f32_16x16x32_bf16 v[0:3], a[96:99], v[212:215], v[0:3]
ds_read_b64_tr_b16 a[88:89], v241 offset:64
v_cvt_pk_bf16_f32 v249, v194, v195
v_mfma_f32_16x16x32_bf16 v[4:7], a[68:71], v[208:211], v[4:7]
ds_read_b64_tr_b16 a[90:91], v241 offset:576
v_exp_f32 v196, v196
v_mfma_f32_16x16x32_bf16 v[4:7], a[100:103], v[212:215], v[4:7]
s_waitcnt vmcnt(5)
buffer_load_dwordx4 v247, s[28:31], s45 offen offset:3168 nt lds
v_mfma_f32_16x16x32_bf16 v[8:11], a[72:75], v[208:211], v[8:11]
ds_read_b64_tr_b16 a[120:121], v243 offset:64
v_exp_f32 v197, v197
v_mfma_f32_16x16x32_bf16 v[8:11], a[104:107], v[212:215], v[8:11]
s_waitcnt lgkmcnt(5)
ds_read_b64_tr_b16 a[122:123], v243 offset:576
v_cvt_pk_bf16_f32 v250, v196, v197
v_mfma_f32_16x16x32_bf16 v[12:15], a[76:79], v[208:211], v[12:15]
ds_read_b64_tr_b16 a[92:93], v241 offset:96
v_exp_f32 v198, v198
v_mfma_f32_16x16x32_bf16 v[12:15], a[108:111], v[212:215], v[12:15]
ds_read_b64_tr_b16 a[94:95], v241 offset:608
v_exp_f32 v199, v199
v_mfma_f32_16x16x32_bf16 v[16:19], a[80:83], v[208:211], v[16:19]
ds_read_b64_tr_b16 a[124:125], v243 offset:96
v_cvt_pk_bf16_f32 v251, v198, v199
v_mfma_f32_16x16x32_bf16 v[16:19], a[112:115], v[212:215], v[16:19]
ds_read_b64_tr_b16 a[126:127], v243 offset:608
v_exp_f32 v200, v200
v_mfma_f32_16x16x32_bf16 v[20:23], a[84:87], v[208:211], v[20:23]
s_waitcnt lgkmcnt(6)
v_exp_f32 v201, v201
v_mfma_f32_16x16x32_bf16 v[20:23], a[116:119], v[212:215], v[20:23]
v_exp_f32 v202, v202
v_mfma_f32_16x16x32_bf16 v[24:27], a[88:91], v[208:211], v[24:27]
s_waitcnt lgkmcnt(4)
v_exp_f32 v203, v203
v_mfma_f32_16x16x32_bf16 v[24:27], a[120:123], v[212:215], v[24:27]
s_waitcnt lgkmcnt(2)
v_exp_f32 v204, v204
v_mfma_f32_16x16x32_bf16 v[28:31], a[92:95], v[208:211], v[28:31]
s_waitcnt lgkmcnt(0)
v_exp_f32 v205, v205
v_mfma_f32_16x16x32_bf16 v[28:31], a[124:127], v[212:215], v[28:31]
v_cvt_pk_bf16_f32 v208, v200, v201
v_cvt_pk_bf16_f32 v209, v202, v203
v_mfma_f32_16x16x32_bf16 v[192:195], a[0:3], v[160:163], v[224:227]
v_exp_f32 v206, v206
v_mfma_f32_16x16x32_bf16 v[192:195], a[4:7], v[164:167], v[192:195]
v_exp_f32 v207, v207
v_mfma_f32_16x16x32_bf16 v[192:195], a[8:11], v[168:171], v[192:195]
s_barrier
v_accvgpr_read_b32 v244, a254
v_subrev_u32 v245, 32, v244
v_mfma_f32_16x16x32_bf16 v[192:195], a[12:15], v[172:175], v[192:195]
v_subrev_u32 v246, 64, v244
v_subrev_u32 v247, 96, v244
v_mfma_f32_16x16x32_bf16 v[196:199], a[16:19], v[160:163], v[224:227]
s_add_u32 m0, s44, 0
s_add_u32 s45, s98, 0
v_cvt_pk_bf16_f32 v210, v204, v205
v_mfma_f32_16x16x32_bf16 v[196:199], a[20:23], v[164:167], v[196:199]
s_waitcnt vmcnt(5)
buffer_load_dwordx4 v244, s[36:39], s45 offen offset:0 lds
v_mfma_f32_16x16x32_bf16 v[196:199], a[24:27], v[168:171], v[196:199]
v_cvt_pk_bf16_f32 v211, v206, v207
v_mfma_f32_16x16x32_bf16 v[196:199], a[28:31], v[172:175], v[196:199]
s_waitcnt vmcnt(5)
buffer_load_dwordx4 v245, s[36:39], s45 offen offset:1056 lds
v_mfma_f32_16x16x32_bf16 v[200:203], a[32:35], v[160:163], v[224:227]
v_exp_f32 v192, v192
v_mfma_f32_16x16x32_bf16 v[200:203], a[36:39], v[164:167], v[200:203]
v_exp_f32 v193, v193
v_mfma_f32_16x16x32_bf16 v[200:203], a[40:43], v[168:171], v[200:203]
s_waitcnt vmcnt(6)
buffer_load_dwordx4 v246, s[36:39], s45 offen offset:2112 lds
v_mfma_f32_16x16x32_bf16 v[200:203], a[44:47], v[172:175], v[200:203]
v_exp_f32 v194, v194
v_mfma_f32_16x16x32_bf16 v[204:207], a[48:51], v[160:163], v[224:227]
v_exp_f32 v195, v195
v_mfma_f32_16x16x32_bf16 v[204:207], a[52:55], v[164:167], v[204:207]
v_cvt_pk_bf16_f32 v212, v192, v193
v_cvt_pk_bf16_f32 v213, v194, v195
v_mfma_f32_16x16x32_bf16 v[204:207], a[56:59], v[168:171], v[204:207]
s_waitcnt vmcnt(6)
buffer_load_dwordx4 v247, s[36:39], s45 offen offset:3168 lds
v_mfma_f32_16x16x32_bf16 v[204:207], a[60:63], v[172:175], v[204:207]
s_add_u32 m0, s44, 17024
s_add_u32 s45, s98, 65536
v_mfma_f32_16x16x32_bf16 a[164:167], a[196:199], v[248:251], a[164:167]
v_exp_f32 v196, v196
v_mfma_f32_16x16x32_bf16 a[164:167], a[196:199], v[208:211], a[164:167]
v_exp_f32 v197, v197
v_mfma_f32_16x16x32_bf16 v[32:35], a[64:67], v[248:251], v[32:35]
s_waitcnt vmcnt(7)
buffer_load_dwordx4 v244, s[36:39], s45 offen offset:0 lds
v_mfma_f32_16x16x32_bf16 v[32:35], a[96:99], v[208:211], v[32:35]
v_exp_f32 v198, v198
v_mfma_f32_16x16x32_bf16 v[36:39], a[68:71], v[248:251], v[36:39]
v_exp_f32 v199, v199
v_mfma_f32_16x16x32_bf16 v[36:39], a[100:103], v[208:211], v[36:39]
v_cvt_pk_bf16_f32 v214, v196, v197
v_cvt_pk_bf16_f32 v215, v198, v199
v_mfma_f32_16x16x32_bf16 v[40:43], a[72:75], v[248:251], v[40:43]
v_exp_f32 v200, v200
v_mfma_f32_16x16x32_bf16 v[40:43], a[104:107], v[208:211], v[40:43]
s_waitcnt vmcnt(7)
buffer_load_dwordx4 v245, s[36:39], s45 offen offset:1056 lds
v_mfma_f32_16x16x32_bf16 v[44:47], a[76:79], v[248:251], v[44:47]
v_exp_f32 v201, v201
v_mfma_f32_16x16x32_bf16 v[44:47], a[108:111], v[208:211], v[44:47]
v_exp_f32 v202, v202
v_mfma_f32_16x16x32_bf16 v[48:51], a[80:83], v[248:251], v[48:51]
v_exp_f32 v203, v203
v_mfma_f32_16x16x32_bf16 v[48:51], a[112:115], v[208:211], v[48:51]
s_waitcnt vmcnt(7)
buffer_load_dwordx4 v246, s[36:39], s45 offen offset:2112 lds
v_mfma_f32_16x16x32_bf16 v[52:55], a[84:87], v[248:251], v[52:55]
v_exp_f32 v204, v204
v_mfma_f32_16x16x32_bf16 v[52:55], a[116:119], v[208:211], v[52:55]
v_exp_f32 v205, v205
v_mfma_f32_16x16x32_bf16 v[56:59], a[88:91], v[248:251], v[56:59]
v_exp_f32 v206, v206
v_mfma_f32_16x16x32_bf16 v[56:59], a[120:123], v[208:211], v[56:59]
s_waitcnt vmcnt(8)
buffer_load_dwordx4 v247, s[36:39], s45 offen offset:3168 lds
v_mfma_f32_16x16x32_bf16 v[60:63], a[92:95], v[248:251], v[60:63]
s_add_u32 m0, s44, 68096
s_add_u32 s45, s98, 131072
v_mfma_f32_16x16x32_bf16 v[60:63], a[124:127], v[208:211], v[60:63]
v_cvt_pk_bf16_f32 v248, v200, v201
v_cvt_pk_bf16_f32 v249, v202, v203
v_mfma_f32_16x16x32_bf16 v[192:195], a[0:3], v[176:179], v[228:231]
v_exp_f32 v207, v207
v_mfma_f32_16x16x32_bf16 v[192:195], a[4:7], v[180:183], v[192:195]
s_waitcnt vmcnt(8)
buffer_load_dwordx4 v244, s[36:39], s45 offen offset:0 lds
v_mfma_f32_16x16x32_bf16 v[192:195], a[8:11], v[184:187], v[192:195]
v_cvt_pk_bf16_f32 v250, v204, v205
v_cvt_pk_bf16_f32 v251, v206, v207
v_mfma_f32_16x16x32_bf16 v[192:195], a[12:15], v[188:191], v[192:195]
v_mfma_f32_16x16x32_bf16 v[196:199], a[16:19], v[176:179], v[228:231]
v_mfma_f32_16x16x32_bf16 v[196:199], a[20:23], v[180:183], v[196:199]
s_waitcnt vmcnt(9)
buffer_load_dwordx4 v245, s[36:39], s45 offen offset:1056 lds
v_mfma_f32_16x16x32_bf16 v[196:199], a[24:27], v[184:187], v[196:199]
s_nop 3
v_exp_f32 v192, v192
v_mfma_f32_16x16x32_bf16 v[196:199], a[28:31], v[188:191], v[196:199]
v_exp_f32 v193, v193
v_mfma_f32_16x16x32_bf16 v[200:203], a[32:35], v[176:179], v[228:231]
v_exp_f32 v194, v194
v_mfma_f32_16x16x32_bf16 v[200:203], a[36:39], v[180:183], v[200:203]
v_exp_f32 v195, v195
v_mfma_f32_16x16x32_bf16 v[200:203], a[40:43], v[184:187], v[200:203]
s_waitcnt vmcnt(9)
buffer_load_dwordx4 v246, s[36:39], s45 offen offset:2112 lds
v_mfma_f32_16x16x32_bf16 v[200:203], a[44:47], v[188:191], v[200:203]
v_cvt_pk_bf16_f32 v208, v192, v193
v_cvt_pk_bf16_f32 v209, v194, v195
v_mfma_f32_16x16x32_bf16 v[204:207], a[48:51], v[176:179], v[228:231]
v_exp_f32 v196, v196
v_mfma_f32_16x16x32_bf16 v[204:207], a[52:55], v[180:183], v[204:207]
v_exp_f32 v197, v197
v_mfma_f32_16x16x32_bf16 v[204:207], a[56:59], v[184:187], v[204:207]
s_waitcnt vmcnt(9)
buffer_load_dwordx4 v247, s[36:39], s45 offen offset:3168 lds
v_mfma_f32_16x16x32_bf16 v[204:207], a[60:63], v[188:191], v[204:207]
s_add_u32 m0, s44, 85120
s_add_u32 s45, s98, 196608
v_cvt_pk_bf16_f32 v210, v196, v197
v_mfma_f32_16x16x32_bf16 a[168:171], a[196:199], v[212:215], a[168:171]
v_exp_f32 v198, v198
v_mfma_f32_16x16x32_bf16 a[168:171], a[196:199], v[248:251], a[168:171]
v_exp_f32 v199, v199
v_mfma_f32_16x16x32_bf16 v[64:67], a[64:67], v[212:215], v[64:67]
s_waitcnt vmcnt(9)
buffer_load_dwordx4 v244, s[36:39], s45 offen offset:0 lds
v_mfma_f32_16x16x32_bf16 v[64:67], a[96:99], v[248:251], v[64:67]
v_cvt_pk_bf16_f32 v211, v198, v199
v_mfma_f32_16x16x32_bf16 v[68:71], a[68:71], v[212:215], v[68:71]
v_exp_f32 v200, v200
v_mfma_f32_16x16x32_bf16 v[68:71], a[100:103], v[248:251], v[68:71]
v_exp_f32 v201, v201
v_mfma_f32_16x16x32_bf16 v[72:75], a[72:75], v[212:215], v[72:75]
s_waitcnt vmcnt(9)
buffer_load_dwordx4 v245, s[36:39], s45 offen offset:1056 lds
v_mfma_f32_16x16x32_bf16 v[72:75], a[104:107], v[248:251], v[72:75]
v_exp_f32 v202, v202
v_mfma_f32_16x16x32_bf16 v[76:79], a[76:79], v[212:215], v[76:79]
v_exp_f32 v203, v203
v_mfma_f32_16x16x32_bf16 v[76:79], a[108:111], v[248:251], v[76:79]
v_exp_f32 v204, v204
v_mfma_f32_16x16x32_bf16 v[80:83], a[80:83], v[212:215], v[80:83]
s_waitcnt vmcnt(9)
buffer_load_dwordx4 v246, s[36:39], s45 offen offset:2112 lds
v_mfma_f32_16x16x32_bf16 v[80:83], a[112:115], v[248:251], v[80:83]
v_exp_f32 v205, v205
v_mfma_f32_16x16x32_bf16 v[84:87], a[84:87], v[212:215], v[84:87]
v_exp_f32 v206, v206
v_mfma_f32_16x16x32_bf16 v[84:87], a[116:119], v[248:251], v[84:87]
v_exp_f32 v207, v207
v_mfma_f32_16x16x32_bf16 v[88:91], a[88:91], v[212:215], v[88:91]
v_mfma_f32_16x16x32_bf16 v[88:91], a[120:123], v[248:251], v[88:91]
s_waitcnt vmcnt(9)
buffer_load_dwordx4 v247, s[36:39], s45 offen offset:3168 lds
v_mfma_f32_16x16x32_bf16 v[92:95], a[92:95], v[212:215], v[92:95]
v_accvgpr_read_b32 v244, a255
v_subrev_u32 v245, 32, v244
v_mfma_f32_16x16x32_bf16 v[92:95], a[124:127], v[248:251], v[92:95]
s_waitcnt vmcnt(16)
s_barrier
v_cvt_pk_bf16_f32 v212, v200, v201
v_mfma_f32_16x16x32_bf16 v[192:195], a[0:3], a[180:183], v[232:235]
ds_read_b128 a[0:3], v236 offset:34048
v_cvt_pk_bf16_f32 v213, v202, v203
v_mfma_f32_16x16x32_bf16 v[192:195], a[4:7], a[184:187], v[192:195]
ds_read_b128 a[4:7], v237 offset:34048
v_cvt_pk_bf16_f32 v214, v204, v205
v_mfma_f32_16x16x32_bf16 v[192:195], a[8:11], a[188:191], v[192:195]
ds_read_b128 a[8:11], v236 offset:34176
v_cvt_pk_bf16_f32 v215, v206, v207
v_mfma_f32_16x16x32_bf16 v[192:195], a[12:15], a[192:195], v[192:195]
ds_read_b128 a[12:15], v237 offset:34176
v_subrev_u32 v246, 64, v244
v_mfma_f32_16x16x32_bf16 v[196:199], a[16:19], a[180:183], v[232:235]
s_cmp_lg_u32 0, 0
Lisl7_0:
s_cbranch_scc1 Lisl7_1
ds_read_b128 a[16:19], v236 offset:34560
v_subrev_u32 v247, 96, v244
v_mfma_f32_16x16x32_bf16 v[196:199], a[20:23], a[184:187], v[196:199]
s_add_u32 m0, s44, 102144
ds_read_b128 a[20:23], v237 offset:34560
s_xor_b32 s45, s47, 114688
v_mfma_f32_16x16x32_bf16 v[196:199], a[24:27], a[188:191], v[196:199]
s_waitcnt vmcnt(8)
buffer_load_dwordx4 v244, s[32:35], s45 offen offset:0 nt lds
v_mfma_f32_16x16x32_bf16 v[196:199], a[28:31], a[192:195], v[196:199]
ds_read_b128 a[24:27], v236 offset:34688
v_mfma_f32_16x16x32_bf16 a[172:175], a[196:199], v[208:211], a[172:175]
ds_read_b128 a[28:31], v237 offset:34688
v_mfma_f32_16x16x32_bf16 a[172:175], a[196:199], v[212:215], a[172:175]
s_waitcnt vmcnt(7)
buffer_load_dwordx4 v245, s[32:35], s45 offen offset:1056 nt lds
v_mfma_f32_16x16x32_bf16 v[96:99], a[64:67], v[208:211], v[96:99]
s_cmp_lg_u32 0, 0
Lisl7_1:
s_cbranch_scc1 Lret1
ds_read_b128 a[32:35], v238 offset:34048
v_mfma_f32_16x16x32_bf16 v[96:99], a[96:99], v[212:215], v[96:99]
ds_read_b128 a[36:39], v239 offset:34048
v_mfma_f32_16x16x32_bf16 v[100:103], a[68:71], v[208:211], v[100:103]
ds_read_b128 a[40:43], v238 offset:34176
v_mfma_f32_16x16x32_bf16 v[100:103], a[100:103], v[212:215], v[100:103]
ds_read_b128 a[44:47], v239 offset:34176
v_mfma_f32_16x16x32_bf16 v[104:107], a[72:75], v[208:211], v[104:107]
ds_read_b128 a[48:51], v238 offset:34560
v_mfma_f32_16x16x32_bf16 v[104:107], a[104:107], v[212:215], v[104:107]
ds_read_b128 a[52:55], v239 offset:34560
v_mfma_f32_16x16x32_bf16 v[108:111], a[76:79], v[208:211], v[108:111]
ds_read_b128 a[56:59], v238 offset:34688
v_mfma_f32_16x16x32_bf16 v[108:111], a[108:111], v[212:215], v[108:111]
ds_read_b128 a[60:63], v239 offset:34688
v_exp_f32 v192, v192
v_mfma_f32_16x16x32_bf16 v[112:115], a[80:83], v[208:211], v[112:115]
s_waitcnt vmcnt(7)
buffer_load_dwordx4 v246, s[32:35], s45 offen offset:2112 nt lds
v_mfma_f32_16x16x32_bf16 v[112:115], a[112:115], v[212:215], v[112:115]
v_exp_f32 v193, v193
v_mfma_f32_16x16x32_bf16 v[116:119], a[84:87], v[208:211], v[116:119]
v_exp_f32 v194, v194
v_mfma_f32_16x16x32_bf16 v[116:119], a[116:119], v[212:215], v[116:119]
v_exp_f32 v195, v195
v_mfma_f32_16x16x32_bf16 v[120:123], a[88:91], v[208:211], v[120:123]
v_cvt_pk_bf16_f32 v248, v192, v193
v_cvt_pk_bf16_f32 v249, v194, v195
v_mfma_f32_16x16x32_bf16 v[120:123], a[120:123], v[212:215], v[120:123]
v_exp_f32 v196, v196
v_mfma_f32_16x16x32_bf16 v[124:127], a[92:95], v[208:211], v[124:127]
v_exp_f32 v197, v197
v_mfma_f32_16x16x32_bf16 v[124:127], a[124:127], v[212:215], v[124:127]
s_waitcnt lgkmcnt(0)
v_exp_f32 v198, v198
v_mfma_f32_16x16x32_bf16 v[200:203], a[0:3], v[128:131], v[216:219]
s_waitcnt vmcnt(6)
buffer_load_dwordx4 v247, s[32:35], s45 offen offset:3168 nt lds
v_mfma_f32_16x16x32_bf16 v[200:203], a[4:7], v[132:135], v[200:203]
v_exp_f32 v199, v199
v_mfma_f32_16x16x32_bf16 v[200:203], a[8:11], v[136:139], v[200:203]
v_cvt_pk_bf16_f32 v250, v196, v197
v_cvt_pk_bf16_f32 v251, v198, v199
v_mfma_f32_16x16x32_bf16 v[200:203], a[12:15], v[140:143], v[200:203]
v_mfma_f32_16x16x32_bf16 v[204:207], a[16:19], v[128:131], v[216:219]
v_mfma_f32_16x16x32_bf16 v[204:207], a[20:23], v[132:135], v[204:207]
s_add_u32 m0, s44, 119168
s_xor_b32 s45, s47, 122880
v_mfma_f32_16x16x32_bf16 v[204:207], a[24:27], v[136:139], v[204:207]
s_nop 2
v_exp_f32 v200, v200
v_mfma_f32_16x16x32_bf16 v[204:207], a[28:31], v[140:143], v[204:207]
v_exp_f32 v201, v201
v_mfma_f32_16x16x32_bf16 v[192:195], a[32:35], v[128:131], v[216:219]
s_waitcnt vmcnt(5)
buffer_load_dwordx4 v244, s[32:35], s45 offen offset:0 nt lds
v_mfma_f32_16x16x32_bf16 v[192:195], a[36:39], v[132:135], v[192:195]
v_exp_f32 v202, v202
v_mfma_f32_16x16x32_bf16 v[192:195], a[40:43], v[136:139], v[192:195]
s_waitcnt vmcnt(13)
s_barrier
v_cvt_pk_bf16_f32 v208, v200, v201
v_mfma_f32_16x16x32_bf16 v[192:195], a[44:47], v[140:143], v[192:195]
v_exp_f32 v203, v203
v_mfma_f32_16x16x32_bf16 v[196:199], a[48:51], v[128:131], v[216:219]
v_cvt_pk_bf16_f32 v209, v202, v203
v_bfe_u32 v237, v252, 1, 7
v_mfma_f32_16x16x32_bf16 v[196:199], a[52:55], v[132:135], v[196:199]
v_exp_f32 v204, v204
v_add_u32 v237, s59, v237
v_mfma_f32_16x16x32_bf16 v[196:199], a[56:59], v[136:139], v[196:199]
v_exp_f32 v205, v205
v_mfma_f32_16x16x32_bf16 v[196:199], a[60:63], v[140:143], v[196:199]
v_exp_f32 v206, v206
v_mfma_f32_16x16x32_bf16 a[176:179], a[196:199], v[248:251], a[176:179]
v_exp_f32 v207, v207
v_mfma_f32_16x16x32_bf16 a[128:131], a[64:67], v[248:251], a[128:131]
s_waitcnt vmcnt(5)
buffer_load_dwordx4 v245, s[32:35], s45 offen offset:1056 nt lds
v_cvt_pk_bf16_f32 v210, v204, v205
v_mfma_f32_16x16x32_bf16 a[132:135], a[68:71], v[248:251], a[132:135]
v_cvt_pk_bf16_f32 v211, v206, v207
v_exp_f32 v192, v192
v_mfma_f32_16x16x32_bf16 a[136:139], a[72:75], v[248:251], a[136:139]
ds_write_b32 v237, v232 offset:4100
v_mfma_f32_16x16x32_bf16 a[140:143], a[76:79], v[248:251], a[140:143]
v_accvgpr_read_b32 v238, a253
v_add_u32 v239, 68096, v238
v_mfma_f32_16x16x32_bf16 a[144:147], a[80:83], v[248:251], a[144:147]
v_add_u32 v236, s59, v252
v_exp_f32 v193, v193
v_mfma_f32_16x16x32_bf16 a[148:151], a[84:87], v[248:251], a[148:151]
v_exp_f32 v194, v194
v_mfma_f32_16x16x32_bf16 a[152:155], a[88:91], v[248:251], a[152:155]
v_exp_f32 v195, v195
v_mfma_f32_16x16x32_bf16 a[156:159], a[92:95], v[248:251], a[156:159]
ds_read_b64_tr_b16 a[64:65], v238 offset:0
v_cvt_pk_bf16_f32 v212, v192, v193
v_cvt_pk_bf16_f32 v213, v194, v195
v_mfma_f32_16x16x32_bf16 v[200:203], a[0:3], a[180:183], v[232:235]
s_waitcnt vmcnt(5)
buffer_load_dwordx4 v246, s[32:35], s45 offen offset:2112 nt lds
v_mfma_f32_16x16x32_bf16 v[200:203], a[4:7], a[184:187], v[200:203]
ds_read_b64_tr_b16 a[66:67], v238 offset:512
v_exp_f32 v196, v196
v_mfma_f32_16x16x32_bf16 v[200:203], a[8:11], a[188:191], v[200:203]
v_exp_f32 v197, v197
v_mfma_f32_16x16x32_bf16 v[200:203], a[12:15], a[192:195], v[200:203]
ds_read_b64_tr_b16 a[68:69], v238 offset:8448
v_exp_f32 v198, v198
v_mfma_f32_16x16x32_bf16 v[204:207], a[16:19], a[180:183], v[232:235]
ds_read_b64_tr_b16 a[70:71], v238 offset:8960
v_exp_f32 v199, v199
v_mfma_f32_16x16x32_bf16 v[204:207], a[20:23], a[184:187], v[204:207]
ds_read_b64_tr_b16 a[72:73], v238 offset:17024
v_cvt_pk_bf16_f32 v214, v196, v197
v_cvt_pk_bf16_f32 v215, v198, v199
v_mfma_f32_16x16x32_bf16 v[204:207], a[24:27], a[188:191], v[204:207]
ds_read_b64_tr_b16 a[74:75], v238 offset:17536
v_exp_f32 v200, v200
v_mfma_f32_16x16x32_bf16 v[204:207], a[28:31], a[192:195], v[204:207]
v_exp_f32 v201, v201
v_mfma_f32_16x16x32_bf16 v[192:195], a[0:3], v[144:147], v[220:223]
ds_read_b64_tr_b16 a[76:77], v238 offset:25472
v_exp_f32 v202, v202
v_mfma_f32_16x16x32_bf16 v[192:195], a[4:7], v[148:151], v[192:195]
ds_read_b64_tr_b16 a[78:79], v238 offset:25984
v_exp_f32 v203, v203
v_mfma_f32_16x16x32_bf16 v[192:195], a[8:11], v[152:155], v[192:195]
ds_read_b64_tr_b16 a[80:81], v238 offset:32
v_cvt_pk_bf16_f32 v248, v200, v201
v_cvt_pk_bf16_f32 v249, v202, v203
v_mfma_f32_16x16x32_bf16 v[192:195], a[12:15], v[156:159], v[192:195]
s_waitcnt vmcnt(5)
buffer_load_dwordx4 v247, s[32:35], s45 offen offset:3168 nt lds
v_exp_f32 v204, v204
v_mfma_f32_16x16x32_bf16 v[196:199], a[16:19], v[144:147], v[220:223]
ds_read_b64_tr_b16 a[82:83], v238 offset:544
v_exp_f32 v205, v205
v_mfma_f32_16x16x32_bf16 v[196:199], a[20:23], v[148:151], v[196:199]
ds_read_b64_tr_b16 a[84:85], v238 offset:8480
v_exp_f32 v206, v206
v_mfma_f32_16x16x32_bf16 v[196:199], a[24:27], v[152:155], v[196:199]
ds_read_b64_tr_b16 a[86:87], v238 offset:8992
v_exp_f32 v207, v207
v_mfma_f32_16x16x32_bf16 v[196:199], a[28:31], v[156:159], v[196:199]
ds_read_b64_tr_b16 a[88:89], v238 offset:17056
v_cvt_pk_bf16_f32 v250, v204, v205
v_cvt_pk_bf16_f32 v251, v206, v207
v_exp_f32 v192, v192
v_mfma_f32_16x16x32_bf16 v[200:203], a[32:35], v[144:147], v[220:223]
ds_read_b64_tr_b16 a[90:91], v238 offset:17568
v_exp_f32 v193, v193
s_nop 0
v_cvt_pk_bf16_f32 v216, v192, v193
v_mfma_f32_16x16x32_bf16 v[200:203], a[36:39], v[148:151], v[200:203]
s_waitcnt vmcnt(5)
ds_read_b64_tr_b16 a[92:93], v238 offset:25504
v_exp_f32 v194, v194
v_exp_f32 v195, v195
v_mfma_f32_16x16x32_bf16 v[200:203], a[40:43], v[152:155], v[200:203]
ds_read_b64_tr_b16 a[94:95], v238 offset:26016
v_accvgpr_read_b32 v244, a254
v_subrev_u32 v245, 32, v244
v_subrev_u32 v246, 64, v244
v_mfma_f32_16x16x32_bf16 v[200:203], a[44:47], v[156:159], v[200:203]
v_subrev_u32 v247, 96, v244
s_add_u32 m0, s44, 34048
s_add_u32 s45, s99, 0
v_cvt_pk_bf16_f32 v217, v194, v195
v_mfma_f32_16x16x32_bf16 v[204:207], a[48:51], v[144:147], v[220:223]
buffer_load_dwordx4 v244, s[36:39], s45 offen offset:0 lds
v_exp_f32 v196, v196
v_mfma_f32_16x16x32_bf16 v[204:207], a[52:55], v[148:151], v[204:207]
v_exp_f32 v197, v197
v_exp_f32 v198, v198
v_cvt_pk_bf16_f32 v218, v196, v197
v_mfma_f32_16x16x32_bf16 v[204:207], a[56:59], v[152:155], v[204:207]
buffer_load_dwordx4 v245, s[36:39], s45 offen offset:1056 lds
v_exp_f32 v199, v199
v_mfma_f32_16x16x32_bf16 v[204:207], a[60:63], v[156:159], v[204:207]
v_cvt_pk_bf16_f32 v219, v198, v199
v_exp_f32 v200, v200
v_exp_f32 v201, v201
v_mfma_f32_16x16x32_bf16 a[176:179], a[196:199], v[248:251], a[176:179]
v_exp_f32 v202, v202
v_exp_f32 v203, v203
v_cvt_pk_bf16_f32 v232, v200, v201
v_mfma_f32_16x16x32_bf16 v[192:195], a[0:3], v[160:163], v[224:227]
s_waitcnt vmcnt(6)
v_cvt_pk_bf16_f32 v233, v202, v203
v_mfma_f32_16x16x32_bf16 v[192:195], a[4:7], v[164:167], v[192:195]
buffer_load_dwordx4 v246, s[36:39], s45 offen offset:2112 lds
v_exp_f32 v204, v204
v_mfma_f32_16x16x32_bf16 v[192:195], a[8:11], v[168:171], v[192:195]
v_exp_f32 v205, v205
v_exp_f32 v206, v206
v_cvt_pk_bf16_f32 v234, v204, v205
v_mfma_f32_16x16x32_bf16 v[192:195], a[12:15], v[172:175], v[192:195]
v_exp_f32 v207, v207
s_nop 0
v_cvt_pk_bf16_f32 v235, v206, v207
v_mfma_f32_16x16x32_bf16 v[196:199], a[16:19], v[160:163], v[224:227]
buffer_load_dwordx4 v247, s[36:39], s45 offen offset:3168 lds
ds_write_b32 v237, a176 offset:4096
v_bfe_u32 v254, v252, 1, 7
v_mfma_f32_16x16x32_bf16 v[196:199], a[20:23], v[164:167], v[196:199]
v_add_u32 v254, s60, v254
v_mfma_f32_16x16x32_bf16 v[196:199], a[24:27], v[168:171], v[196:199]
v_exp_f32 v192, v192
v_exp_f32 v193, v193
s_nop 0
v_cvt_pk_bf16_f32 v220, v192, v193
v_mfma_f32_16x16x32_bf16 v[196:199], a[28:31], v[172:175], v[196:199]
v_exp_f32 v194, v194
v_exp_f32 v195, v195
v_mfma_f32_16x16x32_bf16 v[200:203], a[32:35], v[160:163], v[224:227]
s_waitcnt vmcnt(7)
v_cvt_pk_bf16_f32 v221, v194, v195
v_mfma_f32_16x16x32_bf16 v[200:203], a[36:39], v[164:167], v[200:203]
s_add_u32 m0, s44, 51072
s_add_u32 s45, s99, 65536
buffer_load_dwordx4 v244, s[36:39], s45 offen offset:0 lds
v_mfma_f32_16x16x32_bf16 v[200:203], a[40:43], v[168:171], v[200:203]
v_exp_f32 v196, v196
v_exp_f32 v197, v197
s_nop 0
v_cvt_pk_bf16_f32 v222, v196, v197
v_mfma_f32_16x16x32_bf16 v[200:203], a[44:47], v[172:175], v[200:203]
v_exp_f32 v198, v198
v_exp_f32 v199, v199
s_nop 0
v_cvt_pk_bf16_f32 v223, v198, v199
v_mfma_f32_16x16x32_bf16 v[204:207], a[48:51], v[160:163], v[224:227]
buffer_load_dwordx4 v245, s[36:39], s45 offen offset:1056 lds
v_mfma_f32_16x16x32_bf16 v[204:207], a[52:55], v[164:167], v[204:207]
v_mfma_f32_16x16x32_bf16 v[204:207], a[56:59], v[168:171], v[204:207]
v_exp_f32 v200, v200
v_exp_f32 v201, v201
s_nop 0
v_cvt_pk_bf16_f32 v224, v200, v201
v_mfma_f32_16x16x32_bf16 v[204:207], a[60:63], v[172:175], v[204:207]
v_exp_f32 v202, v202
v_exp_f32 v203, v203
s_nop 0
v_cvt_pk_bf16_f32 v225, v202, v203
v_mfma_f32_16x16x32_bf16 v[192:195], a[0:3], v[176:179], v[228:231]
s_waitcnt vmcnt(8)
v_mfma_f32_16x16x32_bf16 v[192:195], a[4:7], v[180:183], v[192:195]
buffer_load_dwordx4 v246, s[36:39], s45 offen offset:2112 lds
v_mfma_f32_16x16x32_bf16 v[192:195], a[8:11], v[184:187], v[192:195]
v_exp_f32 v204, v204
v_exp_f32 v205, v205
v_exp_f32 v206, v206
v_mfma_f32_16x16x32_bf16 v[192:195], a[12:15], v[188:191], v[192:195]
v_exp_f32 v207, v207
v_cvt_pk_bf16_f32 v226, v204, v205
v_cvt_pk_bf16_f32 v227, v206, v207
v_mfma_f32_16x16x32_bf16 v[196:199], a[16:19], v[176:179], v[228:231]
buffer_load_dwordx4 v247, s[36:39], s45 offen offset:3168 lds
v_mfma_f32_16x16x32_bf16 v[196:199], a[20:23], v[180:183], v[196:199]
v_mfma_f32_16x16x32_bf16 v[196:199], a[24:27], v[184:187], v[196:199]
s_nop 0
v_exp_f32 v192, v192
v_exp_f32 v193, v193
v_exp_f32 v194, v194
v_cvt_pk_bf16_f32 v192, v192, v193
v_mfma_f32_16x16x32_bf16 v[196:199], a[28:31], v[188:191], v[196:199]
s_waitcnt vmcnt(16) lgkmcnt(0)
s_barrier
ds_read_b64_tr_b16 a[0:1], v239 offset:0
ds_read_b64_tr_b16 a[2:3], v239 offset:512
v_exp_f32 v195, v195
s_nop 0
v_cvt_pk_bf16_f32 v193, v194, v195
v_mfma_f32_16x16x32_bf16 v[200:203], a[32:35], v[176:179], v[228:231]
s_waitcnt vmcnt(9)
ds_read_b64_tr_b16 a[4:5], v239 offset:8448
ds_read_b64_tr_b16 a[6:7], v239 offset:8960
v_mfma_f32_16x16x32_bf16 v[200:203], a[36:39], v[180:183], v[200:203]
ds_read_b64_tr_b16 a[8:9], v239 offset:17024
ds_read_b64_tr_b16 a[10:11], v239 offset:17536
v_mfma_f32_16x16x32_bf16 v[200:203], a[40:43], v[184:187], v[200:203]
ds_read_b64_tr_b16 a[12:13], v239 offset:25472
ds_read_b64_tr_b16 a[14:15], v239 offset:25984
v_exp_f32 v196, v196
v_exp_f32 v197, v197
v_exp_f32 v198, v198
v_mfma_f32_16x16x32_bf16 v[200:203], a[44:47], v[188:191], v[200:203]
ds_read_b64_tr_b16 a[16:17], v239 offset:32
ds_read_b64_tr_b16 a[18:19], v239 offset:544
v_exp_f32 v199, v199
v_cvt_pk_bf16_f32 v194, v196, v197
v_cvt_pk_bf16_f32 v195, v198, v199
v_mfma_f32_16x16x32_bf16 v[204:207], a[48:51], v[176:179], v[228:231]
ds_read_b64_tr_b16 a[20:21], v239 offset:8480
ds_read_b64_tr_b16 a[22:23], v239 offset:8992
v_mfma_f32_16x16x32_bf16 v[204:207], a[52:55], v[180:183], v[204:207]
ds_read_b64_tr_b16 a[24:25], v239 offset:17056
ds_read_b64_tr_b16 a[26:27], v239 offset:17568
v_mfma_f32_16x16x32_bf16 v[204:207], a[56:59], v[184:187], v[204:207]
ds_read_b64_tr_b16 a[28:29], v239 offset:25504
ds_read_b64_tr_b16 a[30:31], v239 offset:26016
v_exp_f32 v200, v200
v_exp_f32 v201, v201
v_exp_f32 v202, v202
v_exp_f32 v203, v203
v_cvt_pk_bf16_f32 v200, v200, v201
v_cvt_pk_bf16_f32 v201, v202, v203
v_mfma_f32_16x16x32_bf16 v[204:207], a[60:63], v[188:191], v[204:207]
ds_read_b64 v[228:229], v237 offset:4096
ds_read_b64 v[230:231], v254 offset:4096
s_nop 5
v_exp_f32 v204, v204
v_exp_f32 v205, v205
v_exp_f32 v206, v206
v_exp_f32 v207, v207
v_cvt_pk_bf16_f32 v202, v204, v205
v_cvt_pk_bf16_f32 v203, v206, v207
s_waitcnt lgkmcnt(0)
v_sub_f32 v229, v229, v231
v_exp_f32 v229, v229
s_lshl_b32 s52, s3, 2
v_fma_f32 v253, v230, v229, v228
v_rcp_f32 v230, v253
s_add_u32 s52, s52, 102144
v_add_u32 v237, s52, v252
v_mul_f32 v229, v229, v230
s_waitcnt vmcnt(8)
s_barrier
v_mfma_f32_16x16x32_bf16 a[160:163], a[196:199], v[208:211], a[160:163]
ds_read_b64_tr_b16 a[200:201], v240 offset:34048
ds_read_b64_tr_b16 a[202:203], v240 offset:34560
v_mfma_f32_16x16x32_bf16 a[160:163], a[196:199], v[212:215], a[160:163]
ds_read_b64_tr_b16 a[204:205], v240 offset:34080
ds_read_b64_tr_b16 a[206:207], v240 offset:34592
v_mfma_f32_16x16x32_bf16 a[164:167], a[196:199], v[216:219], a[164:167]
ds_read_b64_tr_b16 a[208:209], v240 offset:34112
ds_read_b64_tr_b16 a[210:211], v240 offset:34624
v_mfma_f32_16x16x32_bf16 a[164:167], a[196:199], v[232:235], a[164:167]
s_add_u32 m0, s44, 0
ds_read_b64_tr_b16 a[212:213], v240 offset:34144
ds_read_b64_tr_b16 a[214:215], v240 offset:34656
v_mfma_f32_16x16x32_bf16 a[168:171], a[196:199], v[220:223], a[168:171]
s_add_u32 s45, s99, 131072
ds_read_b64_tr_b16 a[216:217], v241 offset:34048
ds_read_b64_tr_b16 a[218:219], v241 offset:34560
v_mfma_f32_16x16x32_bf16 a[168:171], a[196:199], v[224:227], a[168:171]
ds_read_b64_tr_b16 a[220:221], v241 offset:34080
ds_read_b64_tr_b16 a[222:223], v241 offset:34592
v_mfma_f32_16x16x32_bf16 a[172:175], a[196:199], v[192:195], a[172:175]
buffer_load_dwordx4 v244, s[36:39], s45 offen offset:0 lds
v_mfma_f32_16x16x32_bf16 a[172:175], a[196:199], v[200:203], a[172:175]
s_waitcnt lgkmcnt(10)
ds_read_b64_tr_b16 a[224:225], v241 offset:34112
ds_read_b64_tr_b16 a[226:227], v241 offset:34624
v_mfma_f32_16x16x32_bf16 a[128:131], a[200:203], v[248:251], a[128:131]
s_waitcnt lgkmcnt(10)
ds_read_b64_tr_b16 a[228:229], v241 offset:34144
ds_read_b64_tr_b16 a[230:231], v241 offset:34656
v_mfma_f32_16x16x32_bf16 a[132:135], a[204:207], v[248:251], a[132:135]
s_waitcnt lgkmcnt(10)
ds_read_b64_tr_b16 a[96:97], v242 offset:34048
ds_read_b64_tr_b16 a[98:99], v242 offset:34560
v_mfma_f32_16x16x32_bf16 a[136:139], a[208:211], v[248:251], a[136:139]
s_waitcnt lgkmcnt(10)
buffer_load_dwordx4 v245, s[36:39], s45 offen offset:1056 lds
v_mfma_f32_16x16x32_bf16 a[140:143], a[212:215], v[248:251], a[140:143]
s_waitcnt lgkmcnt(8)
ds_read_b64_tr_b16 a[100:101], v242 offset:34080
ds_read_b64_tr_b16 a[102:103], v242 offset:34592
v_mfma_f32_16x16x32_bf16 a[144:147], a[216:219], v[248:251], a[144:147]
s_waitcnt lgkmcnt(8)
ds_read_b64_tr_b16 a[104:105], v242 offset:34112
ds_read_b64_tr_b16 a[106:107], v242 offset:34624
v_mfma_f32_16x16x32_bf16 a[148:151], a[220:223], v[248:251], a[148:151]
s_waitcnt lgkmcnt(8)
buffer_load_dwordx4 v246, s[36:39], s45 offen offset:2112 lds
v_mfma_f32_16x16x32_bf16 a[152:155], a[224:227], v[248:251], a[152:155]
s_waitcnt lgkmcnt(6)
ds_read_b64_tr_b16 a[108:109], v242 offset:34144
v_accvgpr_read_b32 v255, a160
v_mfma_f32_16x16x32_bf16 a[156:159], a[228:231], v[248:251], a[156:159]
ds_read_b64_tr_b16 a[110:111], v242 offset:34656
v_accvgpr_read_b32 v231, a160
v_mfma_f32_16x16x32_bf16 v[0:3], a[200:203], v[208:211], v[0:3]
s_waitcnt lgkmcnt(6)
ds_read_b64_tr_b16 a[112:113], v243 offset:34048
v_add_f32 v253, v253, v231
v_mfma_f32_16x16x32_bf16 v[0:3], a[96:99], v[212:215], v[0:3]
ds_read_b64_tr_b16 a[114:115], v243 offset:34560
v_rcp_f32 v254, v255
v_mfma_f32_16x16x32_bf16 v[4:7], a[204:207], v[208:211], v[4:7]
s_waitcnt lgkmcnt(6)
buffer_load_dwordx4 v247, s[36:39], s45 offen offset:3168 lds
s_add_u32 m0, s44, 17024
v_mfma_f32_16x16x32_bf16 v[4:7], a[100:103], v[212:215], v[4:7]
s_add_u32 s45, s99, 196608
ds_read_b64_tr_b16 a[116:117], v243 offset:34080
v_accvgpr_read_b32 v231, a164
v_add_f32 v253, v253, v231
v_mfma_f32_16x16x32_bf16 v[8:11], a[208:211], v[208:211], v[8:11]
s_waitcnt lgkmcnt(5)
ds_read_b64_tr_b16 a[118:119], v243 offset:34592
v_accvgpr_read_b32 v231, a168
v_add_f32 v253, v253, v231
v_accvgpr_read_b32 v231, a172
v_mfma_f32_16x16x32_bf16 v[8:11], a[104:107], v[212:215], v[8:11]
ds_read_b64_tr_b16 a[120:121], v243 offset:34112
v_add_f32 v253, v253, v231
v_mfma_f32_16x16x32_bf16 v[12:15], a[212:215], v[208:211], v[12:15]
s_waitcnt lgkmcnt(5)
ds_read_b64_tr_b16 a[122:123], v243 offset:34624
v_mul_f32 v0, v0, v254
v_mul_f32 v1, v1, v254
v_mfma_f32_16x16x32_bf16 v[12:15], a[108:111], v[212:215], v[12:15]
buffer_load_dwordx4 v244, s[36:39], s45 offen offset:0 lds
v_mul_f32 v2, v2, v254
v_mfma_f32_16x16x32_bf16 v[16:19], a[216:219], v[208:211], v[16:19]
s_waitcnt lgkmcnt(4)
ds_read_b64_tr_b16 a[124:125], v243 offset:34144
v_mul_f32 v3, v3, v254
v_mul_f32 v4, v4, v254
v_mfma_f32_16x16x32_bf16 v[16:19], a[112:115], v[212:215], v[16:19]
ds_read_b64_tr_b16 a[126:127], v243 offset:34656
v_add_u32 v240, s57, v252
v_add_u32 v241, s58, v252
v_mfma_f32_16x16x32_bf16 v[20:23], a[220:223], v[208:211], v[20:23]
s_waitcnt lgkmcnt(4)
buffer_load_dwordx4 v245, s[36:39], s45 offen offset:1056 lds
v_add_u32 v242, s60, v252
v_mfma_f32_16x16x32_bf16 v[20:23], a[116:119], v[212:215], v[20:23]
v_mul_f32 v5, v5, v254
v_mul_f32 v6, v6, v254
v_mul_f32 v7, v7, v254
v_mfma_f32_16x16x32_bf16 v[24:27], a[224:227], v[208:211], v[24:27]
s_waitcnt lgkmcnt(2)
buffer_load_dwordx4 v246, s[36:39], s45 offen offset:2112 lds
v_cvt_pk_bf16_f32 v0, v0, v1
v_cvt_pk_bf16_f32 v1, v2, v3
v_mfma_f32_16x16x32_bf16 v[24:27], a[120:123], v[212:215], v[24:27]
v_cvt_pk_bf16_f32 v2, v4, v5
v_cvt_pk_bf16_f32 v3, v6, v7
v_mul_f32 v8, v8, v254
v_mfma_f32_16x16x32_bf16 v[28:31], a[228:231], v[208:211], v[28:31]
s_waitcnt lgkmcnt(0)
v_mul_f32 v9, v9, v254
v_mul_f32 v10, v10, v254
v_mul_f32 v11, v11, v254
v_mfma_f32_16x16x32_bf16 v[28:31], a[124:127], v[212:215], v[28:31]
buffer_load_dwordx4 v247, s[36:39], s45 offen offset:3168 lds
v_mul_f32 v12, v12, v254
v_mfma_f32_16x16x32_bf16 v[32:35], a[200:203], v[216:219], v[32:35]
s_add_u32 m0, s44, 68096
s_waitcnt vmcnt(8)
s_barrier
s_add_u32 s45, s100, 0
v_mfma_f32_16x16x32_bf16 v[32:35], a[96:99], v[232:235], v[32:35]
ds_write_b128 v240, v[0:3] offset:0
v_mul_f32 v13, v13, v254
v_mfma_f32_16x16x32_bf16 v[36:39], a[204:207], v[216:219], v[36:39]
v_mul_f32 v14, v14, v254
v_mul_f32 v15, v15, v254
v_cvt_pk_bf16_f32 v8, v8, v9
v_mfma_f32_16x16x32_bf16 v[36:39], a[100:103], v[232:235], v[36:39]
buffer_load_dwordx4 v244, s[36:39], s45 offen offset:0 lds
v_cvt_pk_bf16_f32 v9, v10, v11
v_mfma_f32_16x16x32_bf16 v[40:43], a[208:211], v[216:219], v[40:43]
ds_read_b64_tr_b16 a[32:33], v238 offset:34048
ds_read_b64_tr_b16 a[34:35], v238 offset:34560
v_cvt_pk_bf16_f32 v10, v12, v13
v_mfma_f32_16x16x32_bf16 v[40:43], a[104:107], v[232:235], v[40:43]
ds_read_b64_tr_b16 a[36:37], v238 offset:42496
ds_read_b64_tr_b16 a[38:39], v238 offset:43008
v_cvt_pk_bf16_f32 v11, v14, v15
v_mfma_f32_16x16x32_bf16 v[44:47], a[212:215], v[216:219], v[44:47]
ds_write_b128 v240, v[8:11] offset:1024
v_mul_f32 v16, v16, v254
v_mfma_f32_16x16x32_bf16 v[44:47], a[108:111], v[232:235], v[44:47]
buffer_load_dwordx4 v245, s[36:39], s45 offen offset:1056 lds
v_mul_f32 v17, v17, v254
v_mfma_f32_16x16x32_bf16 v[48:51], a[216:219], v[216:219], v[48:51]
ds_read_b64_tr_b16 a[40:41], v238 offset:51072
v_mul_f32 v18, v18, v254
v_mul_f32 v19, v19, v254
v_mfma_f32_16x16x32_bf16 v[48:51], a[112:115], v[232:235], v[48:51]
ds_read_b64_tr_b16 a[42:43], v238 offset:51584
v_mul_f32 v20, v20, v254
v_mul_f32 v21, v21, v254
v_mfma_f32_16x16x32_bf16 v[52:55], a[220:223], v[216:219], v[52:55]
ds_read_b64_tr_b16 a[44:45], v238 offset:59520
v_mul_f32 v22, v22, v254
v_mul_f32 v23, v23, v254
v_mfma_f32_16x16x32_bf16 v[52:55], a[116:119], v[232:235], v[52:55]
buffer_load_dwordx4 v246, s[36:39], s45 offen offset:2112 lds
v_cvt_pk_bf16_f32 v16, v16, v17
v_mfma_f32_16x16x32_bf16 v[56:59], a[224:227], v[216:219], v[56:59]
ds_read_b64_tr_b16 a[46:47], v238 offset:60032
v_cvt_pk_bf16_f32 v17, v18, v19
v_cvt_pk_bf16_f32 v18, v20, v21
v_mfma_f32_16x16x32_bf16 v[56:59], a[120:123], v[232:235], v[56:59]
ds_read_b64_tr_b16 a[48:49], v238 offset:34080
v_cvt_pk_bf16_f32 v19, v22, v23
v_mfma_f32_16x16x32_bf16 v[60:63], a[228:231], v[216:219], v[60:63]
ds_write_b128 v241, v[16:19] offset:0
v_mul_f32 v24, v24, v254
v_mfma_f32_16x16x32_bf16 v[60:63], a[124:127], v[232:235], v[60:63]
buffer_load_dwordx4 v247, s[36:39], s45 offen offset:3168 lds
v_mul_f32 v25, v25, v254
v_mfma_f32_16x16x32_bf16 v[64:67], a[200:203], v[220:223], v[64:67]
s_add_u32 m0, s44, 85120
ds_read_b64_tr_b16 a[50:51], v238 offset:34592
s_add_u32 s45, s100, 65536
v_mul_f32 v26, v26, v254
v_mfma_f32_16x16x32_bf16 v[64:67], a[96:99], v[224:227], v[64:67]
ds_read_b64_tr_b16 a[52:53], v238 offset:42528
v_mul_f32 v27, v27, v254
v_mfma_f32_16x16x32_bf16 v[68:71], a[204:207], v[220:223], v[68:71]
ds_write_b32 v237, v253 offset:59520
v_mul_f32 v28, v28, v254
v_mfma_f32_16x16x32_bf16 v[68:71], a[100:103], v[224:227], v[68:71]
buffer_load_dwordx4 v244, s[36:39], s45 offen offset:0 lds
v_mul_f32 v29, v29, v254
v_mfma_f32_16x16x32_bf16 v[72:75], a[208:211], v[220:223], v[72:75]
ds_read_b64_tr_b16 a[54:55], v238 offset:43040
v_mul_f32 v30, v30, v254
v_mfma_f32_16x16x32_bf16 v[72:75], a[104:107], v[224:227], v[72:75]
ds_read_b64_tr_b16 a[56:57], v238 offset:51104
v_mul_f32 v31, v31, v254
v_cvt_pk_bf16_f32 v24, v24, v25
v_mfma_f32_16x16x32_bf16 v[76:79], a[212:215], v[220:223], v[76:79]
ds_read_b64_tr_b16 a[58:59], v238 offset:51616
v_cvt_pk_bf16_f32 v25, v26, v27
v_cvt_pk_bf16_f32 v26, v28, v29
v_mfma_f32_16x16x32_bf16 v[76:79], a[108:111], v[224:227], v[76:79]
ds_read_b64_tr_b16 a[60:61], v238 offset:59552
v_cvt_pk_bf16_f32 v27, v30, v31
v_add_u32 v249, 102144, v252
v_mfma_f32_16x16x32_bf16 v[80:83], a[216:219], v[220:223], v[80:83]
s_lshl_b32 s52, s3, 10
ds_read_b64_tr_b16 a[62:63], v238 offset:60064
v_add_u32 v243, s52, v252
v_accvgpr_read_b32 v255, a164
v_mfma_f32_16x16x32_bf16 v[80:83], a[112:115], v[224:227], v[80:83]
ds_write_b128 v241, v[24:27] offset:1024
v_rcp_f32 v254, v255
s_nop 0
v_mul_f32 v32, v32, v254
v_mfma_f32_16x16x32_bf16 v[84:87], a[220:223], v[220:223], v[84:87]
buffer_load_dwordx4 v245, s[36:39], s45 offen offset:1056 lds
v_mfma_f32_16x16x32_bf16 v[84:87], a[116:119], v[224:227], v[84:87]
v_mul_f32 v33, v33, v254
v_mul_f32 v34, v34, v254
v_mfma_f32_16x16x32_bf16 v[88:91], a[224:227], v[220:223], v[88:91]
buffer_load_dwordx4 v246, s[36:39], s45 offen offset:2112 lds
v_mfma_f32_16x16x32_bf16 v[88:91], a[120:123], v[224:227], v[88:91]
s_waitcnt vmcnt(7) lgkmcnt(0)
s_barrier
ds_read_b128 v[216:219], v249 offset:59520
v_mfma_f32_16x16x32_bf16 v[92:95], a[228:231], v[220:223], v[92:95]
ds_read_b128 v[0:3], v249 offset:0
v_mul_f32 v35, v35, v254
v_mfma_f32_16x16x32_bf16 v[92:95], a[124:127], v[224:227], v[92:95]
buffer_load_dwordx4 v247, s[36:39], s45 offen offset:3168 lds
v_mfma_f32_16x16x32_bf16 v[96:99], a[200:203], v[192:195], v[96:99]
s_add_u32 m0, s44, 34048
ds_read_b128 v[4:7], v249 offset:1024
s_add_u32 s45, s100, 131072
v_mfma_f32_16x16x32_bf16 v[96:99], a[96:99], v[200:203], v[96:99]
ds_read_b128 v[8:11], v249 offset:2048
v_mul_f32 v36, v36, v254
v_mfma_f32_16x16x32_bf16 v[100:103], a[204:207], v[192:195], v[100:103]
ds_read_b128 v[12:15], v249 offset:3072
v_mul_f32 v37, v37, v254
v_mfma_f32_16x16x32_bf16 v[100:103], a[100:103], v[200:203], v[100:103]
buffer_load_dwordx4 v244, s[36:39], s45 offen offset:0 lds
v_mfma_f32_16x16x32_bf16 v[104:107], a[208:211], v[192:195], v[104:107]
ds_read_b128 v[16:19], v249 offset:4096
v_mul_f32 v38, v38, v254
v_mfma_f32_16x16x32_bf16 v[104:107], a[104:107], v[200:203], v[104:107]
ds_read_b128 v[20:23], v249 offset:5120
v_mul_f32 v39, v39, v254
v_mfma_f32_16x16x32_bf16 v[108:111], a[212:215], v[192:195], v[108:111]
ds_read_b128 v[24:27], v249 offset:6144
v_cvt_pk_bf16_f32 v32, v32, v33
v_mfma_f32_16x16x32_bf16 v[108:111], a[108:111], v[200:203], v[108:111]
ds_read_b128 v[28:31], v249 offset:7168
v_cvt_pk_bf16_f32 v33, v34, v35
v_mfma_f32_16x16x32_bf16 v[112:115], a[216:219], v[192:195], v[112:115]
ds_read_b128 a[232:235], v249 offset:8192
v_cvt_pk_bf16_f32 v34, v36, v37
v_mfma_f32_16x16x32_bf16 v[112:115], a[112:115], v[200:203], v[112:115]
s_cmp_lg_u32 0, 0
Lisl8_0:
s_cbranch_scc1 Lisl8_1
ds_read_b128 a[236:239], v249 offset:9216
v_cvt_pk_bf16_f32 v35, v38, v39
v_mfma_f32_16x16x32_bf16 v[116:119], a[220:223], v[192:195], v[116:119]
ds_read_b128 a[240:243], v249 offset:10240
s_waitcnt lgkmcnt(7)
v_add_f32 v216, v216, v217
v_mfma_f32_16x16x32_bf16 v[116:119], a[116:119], v[200:203], v[116:119]
ds_read_b128 a[244:247], v249 offset:11264
v_add_f32 v218, v218, v219
v_add_f32 v216, v216, v218
v_cmp_nge_f32 vcc, 0x53800000, v216
s_cmp_eq_u32 s54, 0
s_cselect_b64 vcc, vcc, 0
s_cbranch_vccnz Lslow
v_mfma_f32_16x16x32_bf16 v[120:123], a[224:227], v[192:195], v[120:123]
buffer_load_dwordx4 v245, s[36:39], s45 offen offset:1056 lds
v_mfma_f32_16x16x32_bf16 v[120:123], a[120:123], v[200:203], v[120:123]
ds_read_b128 a[248:251], v249 offset:12288
v_mul_f32 v40, v40, v254
v_mfma_f32_16x16x32_bf16 v[124:127], a[228:231], v[192:195], v[124:127]
s_cmp_lg_u32 0, 0
Lisl8_1:
s_cbranch_scc1 Lret1
ds_read_b128 a[252:255], v249 offset:13312
v_mul_f32 v41, v41, v254
v_mfma_f32_16x16x32_bf16 v[124:127], a[124:127], v[200:203], v[124:127]
ds_read_b128 a[192:195], v249 offset:14336
v_mul_f32 v42, v42, v254
v_mfma_f32_16x16x32_bf16 v[192:195], a[64:67], v[0:3], 0
ds_read_b128 a[196:199], v249 offset:15360
v_mul_f32 v43, v43, v254
v_mfma_f32_16x16x32_bf16 v[192:195], a[68:71], v[4:7], v[192:195]
ds_read_b64_tr_b16 a[96:97], v238 offset:0
v_mul_f32 v44, v44, v254
v_mfma_f32_16x16x32_bf16 v[192:195], a[72:75], v[8:11], v[192:195]
ds_read_b64_tr_b16 a[98:99], v238 offset:512
v_mul_f32 v45, v45, v254
v_mfma_f32_16x16x32_bf16 v[192:195], a[76:79], v[12:15], v[192:195]
s_waitcnt lgkmcnt(6)
buffer_load_dwordx4 v246, s[36:39], s45 offen offset:2112 lds
v_mfma_f32_16x16x32_bf16 v[192:195], a[0:3], v[16:19], v[192:195]
ds_read_b64_tr_b16 a[100:101], v238 offset:8448
v_mul_f32 v46, v46, v254
v_mfma_f32_16x16x32_bf16 v[192:195], a[4:7], v[20:23], v[192:195]
ds_read_b64_tr_b16 a[102:103], v238 offset:8960
v_mul_f32 v47, v47, v254
v_mfma_f32_16x16x32_bf16 v[192:195], a[8:11], v[24:27], v[192:195]
ds_read_b64_tr_b16 a[104:105], v238 offset:17024
v_cvt_pk_bf16_f32 v40, v40, v41
v_mfma_f32_16x16x32_bf16 v[192:195], a[12:15], v[28:31], v[192:195]
ds_read_b64_tr_b16 a[106:107], v238 offset:17536
v_cvt_pk_bf16_f32 v41, v42, v43
v_mfma_f32_16x16x32_bf16 v[196:199], a[80:83], v[0:3], 0
ds_read_b64_tr_b16 a[108:109], v238 offset:25472
v_cvt_pk_bf16_f32 v42, v44, v45
v_mfma_f32_16x16x32_bf16 v[196:199], a[84:87], v[4:7], v[196:199]
ds_read_b64_tr_b16 a[110:111], v238 offset:25984
v_cvt_pk_bf16_f32 v43, v46, v47
v_mfma_f32_16x16x32_bf16 v[196:199], a[88:91], v[8:11], v[196:199]
ds_read_b64_tr_b16 a[112:113], v238 offset:32
v_mul_f32 v48, v48, v254
v_mfma_f32_16x16x32_bf16 v[196:199], a[92:95], v[12:15], v[196:199]
ds_read_b64_tr_b16 a[114:115], v238 offset:544
v_cvt_pk_bf16_f32 v208, v192, v193
v_mfma_f32_16x16x32_bf16 v[196:199], a[16:19], v[16:19], v[196:199]
ds_read_b64_tr_b16 a[116:117], v238 offset:8480
v_cvt_pk_bf16_f32 v209, v194, v195
v_mfma_f32_16x16x32_bf16 v[196:199], a[20:23], v[20:23], v[196:199]
s_mul_i32 s56, s98, 144
buffer_load_dwordx4 v247, s[36:39], s45 offen offset:3168 lds
v_mfma_f32_16x16x32_bf16 v[196:199], a[24:27], v[24:27], v[196:199]
s_add_u32 s61, s56, 0
ds_write_b128 v240, v[32:35] offset:17024
v_mfma_f32_16x16x32_bf16 v[196:199], a[28:31], v[28:31], v[196:199]
v_mul_f32 v49, v49, v254
v_mul_f32 v50, v50, v254
v_mfma_f32_16x16x32_bf16 v[200:203], a[64:67], a[232:235], 0
s_add_u32 m0, s44, 51072
ds_read_b64_tr_b16 a[118:119], v238 offset:8992
s_add_u32 s45, s100, 196608
v_mfma_f32_16x16x32_bf16 v[200:203], a[68:71], a[236:239], v[200:203]
ds_read_b64_tr_b16 a[120:121], v238 offset:17056
v_mul_f32 v51, v51, v254
v_mfma_f32_16x16x32_bf16 v[200:203], a[72:75], a[240:243], v[200:203]
ds_read_b64_tr_b16 a[122:123], v238 offset:17568
v_mul_f32 v52, v52, v254
v_mfma_f32_16x16x32_bf16 v[200:203], a[76:79], a[244:247], v[200:203]
s_waitcnt lgkmcnt(4)
ds_read_b64_tr_b16 a[124:125], v238 offset:25504
v_cvt_pk_bf16_f32 v210, v196, v197
v_mfma_f32_16x16x32_bf16 v[200:203], a[0:3], a[248:251], v[200:203]
ds_read_b64_tr_b16 a[126:127], v238 offset:26016
v_cvt_pk_bf16_f32 v211, v198, v199
v_mfma_f32_16x16x32_bf16 v[200:203], a[4:7], a[252:255], v[200:203]
buffer_load_dwordx4 v244, s[36:39], s45 offen offset:0 lds
v_mfma_f32_16x16x32_bf16 v[200:203], a[8:11], a[192:195], v[200:203]
ds_write_b128 v240, v[40:43] offset:18048
v_mfma_f32_16x16x32_bf16 v[200:203], a[12:15], a[196:199], v[200:203]
buffer_store_dwordx4 v[208:211], v243, s[40:43], s61 offen offset:0 sc1
v_mfma_f32_16x16x32_bf16 v[204:207], a[80:83], a[232:235], 0
v_lshl_add_u32 v184, v252, 4, s63
v_mov_b32 v185, 1
v_mfma_f32_16x16x32_bf16 v[204:207], a[84:87], a[236:239], v[204:207]
buffer_atomic_add v185, v184, s[16:19], 0 offen offset:0
v_mfma_f32_16x16x32_bf16 v[204:207], a[88:91], a[240:243], v[204:207]
v_mul_f32 v53, v53, v254
v_mul_f32 v54, v54, v254
v_mfma_f32_16x16x32_bf16 v[204:207], a[92:95], a[244:247], v[204:207]
buffer_load_dwordx4 v245, s[36:39], s45 offen offset:1056 lds
v_mfma_f32_16x16x32_bf16 v[204:207], a[16:19], a[248:251], v[204:207]
v_cvt_pk_bf16_f32 v212, v200, v201
v_cvt_pk_bf16_f32 v213, v202, v203
v_mfma_f32_16x16x32_bf16 v[204:207], a[20:23], a[252:255], v[204:207]
s_add_u32 s61, s56, 16384
v_mul_f32 v55, v55, v254
v_cvt_pk_bf16_f32 v48, v48, v49
v_mfma_f32_16x16x32_bf16 v[204:207], a[24:27], a[192:195], v[204:207]
v_cvt_pk_bf16_f32 v49, v50, v51
v_cvt_pk_bf16_f32 v50, v52, v53
v_mfma_f32_16x16x32_bf16 v[204:207], a[28:31], a[196:199], v[204:207]
v_cvt_pk_bf16_f32 v51, v54, v55
v_mul_f32 v56, v56, v254
v_mfma_f32_16x16x32_bf16 v[192:195], a[32:35], v[0:3], 0
ds_write_b128 v241, v[48:51] offset:17024
v_mfma_f32_16x16x32_bf16 v[192:195], a[36:39], v[4:7], v[192:195]
v_mul_f32 v57, v57, v254
v_mul_f32 v58, v58, v254
v_mfma_f32_16x16x32_bf16 v[192:195], a[40:43], v[8:11], v[192:195]
v_mul_f32 v59, v59, v254
v_mul_f32 v60, v60, v254
v_mfma_f32_16x16x32_bf16 v[192:195], a[44:47], v[12:15], v[192:195]
buffer_load_dwordx4 v246, s[36:39], s45 offen offset:2112 lds
v_mfma_f32_16x16x32_bf16 v[192:195], a[96:99], v[16:19], v[192:195]
v_mul_f32 v61, v61, v254
v_mul_f32 v62, v62, v254
v_mfma_f32_16x16x32_bf16 v[192:195], a[100:103], v[20:23], v[192:195]
v_mul_f32 v63, v63, v254
v_cvt_pk_bf16_f32 v56, v56, v57
v_mfma_f32_16x16x32_bf16 v[192:195], a[104:107], v[24:27], v[192:195]
v_cvt_pk_bf16_f32 v57, v58, v59
v_cvt_pk_bf16_f32 v58, v60, v61
v_mfma_f32_16x16x32_bf16 v[192:195], a[108:111], v[28:31], v[192:195]
v_cvt_pk_bf16_f32 v59, v62, v63
v_cvt_pk_bf16_f32 v214, v204, v205
v_mfma_f32_16x16x32_bf16 v[196:199], a[48:51], v[0:3], 0
ds_write_b128 v241, v[56:59] offset:18048
v_mfma_f32_16x16x32_bf16 v[196:199], a[52:55], v[4:7], v[196:199]
v_cvt_pk_bf16_f32 v215, v206, v207
v_accvgpr_read_b32 v255, a168
v_mfma_f32_16x16x32_bf16 v[196:199], a[56:59], v[8:11], v[196:199]
buffer_store_dwordx4 v[212:215], v243, s[40:43], s61 offen offset:0 sc1
v_mfma_f32_16x16x32_bf16 v[196:199], a[60:63], v[12:15], v[196:199]
v_cvt_pk_bf16_f32 v208, v192, v193
v_cvt_pk_bf16_f32 v209, v194, v195
v_mfma_f32_16x16x32_bf16 v[196:199], a[112:115], v[16:19], v[196:199]
s_waitcnt lgkmcnt(1)
buffer_load_dwordx4 v247, s[36:39], s45 offen offset:3168 lds
v_mfma_f32_16x16x32_bf16 v[196:199], a[116:119], v[20:23], v[196:199]
s_mul_i32 s56, s99, 144
s_add_u32 s61, s56, 0
v_rcp_f32 v254, v255
v_mfma_f32_16x16x32_bf16 v[196:199], a[120:123], v[24:27], v[196:199]
v_mul_f32 v64, v64, v254
v_mul_f32 v65, v65, v254
v_mfma_f32_16x16x32_bf16 v[196:199], a[124:127], v[28:31], v[196:199]
v_mul_f32 v66, v66, v254
v_mul_f32 v67, v67, v254
v_mfma_f32_16x16x32_bf16 v[200:203], a[32:35], a[232:235], 0
v_mul_f32 v68, v68, v254
v_mul_f32 v69, v69, v254
v_mfma_f32_16x16x32_bf16 v[200:203], a[36:39], a[236:239], v[200:203]
v_mul_f32 v70, v70, v254
v_mul_f32 v71, v71, v254
v_mfma_f32_16x16x32_bf16 v[200:203], a[40:43], a[240:243], v[200:203]
v_cvt_pk_bf16_f32 v64, v64, v65
v_cvt_pk_bf16_f32 v65, v66, v67
v_mfma_f32_16x16x32_bf16 v[200:203], a[44:47], a[244:247], v[200:203]
v_cvt_pk_bf16_f32 v210, v196, v197
v_cvt_pk_bf16_f32 v211, v198, v199
v_mfma_f32_16x16x32_bf16 v[200:203], a[96:99], a[248:251], v[200:203]
buffer_store_dwordx4 v[208:211], v243, s[40:43], s61 offen offset:0 sc1
v_mfma_f32_16x16x32_bf16 v[200:203], a[100:103], a[252:255], v[200:203]
s_waitcnt lgkmcnt(0)
s_barrier
ds_read_b128 v[32:35], v249 offset:17024
v_mfma_f32_16x16x32_bf16 v[200:203], a[104:107], a[192:195], v[200:203]
s_add_u32 m0, s44, 0
ds_read_b128 v[36:39], v249 offset:18048
s_add_u32 s45, s101, 0
v_mfma_f32_16x16x32_bf16 v[200:203], a[108:111], a[196:199], v[200:203]
ds_read_b128 v[40:43], v249 offset:19072
v_cvt_pk_bf16_f32 v66, v68, v69
v_cvt_pk_bf16_f32 v67, v70, v71
v_mfma_f32_16x16x32_bf16 v[204:207], a[48:51], a[232:235], 0
ds_read_b128 v[44:47], v249 offset:20096
v_mul_f32 v72, v72, v254
v_mfma_f32_16x16x32_bf16 v[204:207], a[52:55], a[236:239], v[204:207]
ds_read_b128 v[48:51], v249 offset:21120
v_mul_f32 v73, v73, v254
v_mul_f32 v74, v74, v254
v_mfma_f32_16x16x32_bf16 v[204:207], a[56:59], a[240:243], v[204:207]
ds_read_b128 v[52:55], v249 offset:22144
v_mul_f32 v75, v75, v254
v_mfma_f32_16x16x32_bf16 v[204:207], a[60:63], a[244:247], v[204:207]
ds_read_b128 v[56:59], v249 offset:23168
v_cvt_pk_bf16_f32 v212, v200, v201
v_cvt_pk_bf16_f32 v213, v202, v203
v_mfma_f32_16x16x32_bf16 v[204:207], a[112:115], a[248:251], v[204:207]
s_add_u32 s61, s56, 16384
ds_read_b128 v[60:63], v249 offset:24192
v_mul_f32 v76, v76, v254
v_mfma_f32_16x16x32_bf16 v[204:207], a[116:119], a[252:255], v[204:207]
buffer_load_dwordx4 v244, s[36:39], s45 offen offset:0 lds
v_mul_f32 v77, v77, v254
v_mfma_f32_16x16x32_bf16 v[204:207], a[120:123], a[192:195], v[204:207]
ds_read_b128 a[200:203], v249 offset:25216
v_mul_f32 v78, v78, v254
v_mfma_f32_16x16x32_bf16 v[204:207], a[124:127], a[196:199], v[204:207]
s_waitcnt lgkmcnt(5)
ds_read_b128 a[204:207], v249 offset:26240
v_mul_f32 v79, v79, v254
v_cvt_pk_bf16_f32 v72, v72, v73
v_mfma_f32_16x16x32_bf16 v[192:195], a[64:67], v[32:35], 0
ds_read_b128 a[208:211], v249 offset:27264
v_cvt_pk_bf16_f32 v73, v74, v75
v_mfma_f32_16x16x32_bf16 v[192:195], a[68:71], v[36:39], v[192:195]
ds_write_b128 v236, a[144:147] offset:0
v_cvt_pk_bf16_f32 v74, v76, v77
v_cvt_pk_bf16_f32 v75, v78, v79
v_mul_f32 v80, v80, v254
v_mfma_f32_16x16x32_bf16 v[192:195], a[72:75], v[40:43], v[192:195]
v_mul_f32 v81, v81, v254
v_mul_f32 v82, v82, v254
v_mul_f32 v83, v83, v254
v_mfma_f32_16x16x32_bf16 v[192:195], a[76:79], v[44:47], v[192:195]
s_waitcnt lgkmcnt(4)
ds_read_b128 a[212:215], v249 offset:28288
v_cvt_pk_bf16_f32 v214, v204, v205
v_mfma_f32_16x16x32_bf16 v[192:195], a[0:3], v[48:51], v[192:195]
ds_read_b128 a[216:219], v249 offset:29312
v_cvt_pk_bf16_f32 v215, v206, v207
v_mul_f32 v84, v84, v254
v_mfma_f32_16x16x32_bf16 v[192:195], a[4:7], v[52:55], v[192:195]
ds_write_b128 v236, a[148:151] offset:1024
v_mfma_f32_16x16x32_bf16 v[192:195], a[8:11], v[56:59], v[192:195]
buffer_store_dwordx4 v[212:215], v243, s[40:43], s61 offen offset:0 sc1
v_mfma_f32_16x16x32_bf16 v[192:195], a[12:15], v[60:63], v[192:195]
ds_read_b128 a[220:223], v249 offset:30336
v_mul_f32 v85, v85, v254
v_mul_f32 v86, v86, v254
v_mfma_f32_16x16x32_bf16 v[196:199], a[80:83], v[32:35], 0
ds_read_b128 a[224:227], v249 offset:31360
v_mul_f32 v87, v87, v254
v_mfma_f32_16x16x32_bf16 v[196:199], a[84:87], v[36:39], v[196:199]
ds_write_b128 v236, a[152:155] offset:2048
v_mfma_f32_16x16x32_bf16 v[196:199], a[88:91], v[40:43], v[196:199]
buffer_load_dwordx4 v245, s[36:39], s45 offen offset:1056 lds
v_mfma_f32_16x16x32_bf16 v[196:199], a[92:95], v[44:47], v[196:199]
ds_read_b128 a[228:231], v249 offset:32384
v_cvt_pk_bf16_f32 v208, v192, v193
v_cvt_pk_bf16_f32 v209, v194, v195
v_mfma_f32_16x16x32_bf16 v[196:199], a[16:19], v[48:51], v[196:199]
s_mul_i32 s56, s98, 144
s_add_u32 s61, s56, 4096
v_cvt_pk_bf16_f32 v80, v80, v81
v_mfma_f32_16x16x32_bf16 v[196:199], a[20:23], v[52:55], v[196:199]
ds_write_b128 v236, a[156:159] offset:3072
v_mfma_f32_16x16x32_bf16 v[196:199], a[24:27], v[56:59], v[196:199]
v_cvt_pk_bf16_f32 v81, v82, v83
v_cvt_pk_bf16_f32 v82, v84, v85
v_mfma_f32_16x16x32_bf16 v[196:199], a[28:31], v[60:63], v[196:199]
s_waitcnt lgkmcnt(3)
v_cvt_pk_bf16_f32 v83, v86, v87
v_mul_f32 v88, v88, v254
v_mfma_f32_16x16x32_bf16 v[200:203], a[64:67], a[200:203], 0
v_mul_f32 v89, v89, v254
v_mul_f32 v90, v90, v254
v_mfma_f32_16x16x32_bf16 v[200:203], a[68:71], a[204:207], v[200:203]
ds_write_b128 v240, v[64:67] offset:0
v_mfma_f32_16x16x32_bf16 v[200:203], a[72:75], a[208:211], v[200:203]
v_mul_f32 v91, v91, v254
v_mul_f32 v92, v92, v254
v_mfma_f32_16x16x32_bf16 v[200:203], a[76:79], a[212:215], v[200:203]
v_cvt_pk_bf16_f32 v210, v196, v197
v_cvt_pk_bf16_f32 v211, v198, v199
v_mfma_f32_16x16x32_bf16 v[200:203], a[0:3], a[216:219], v[200:203]
buffer_store_dwordx4 v[208:211], v243, s[40:43], s61 offen offset:0 sc1
v_mfma_f32_16x16x32_bf16 v[200:203], a[4:7], a[220:223], v[200:203]
ds_write_b128 v240, v[72:75] offset:1024
v_mfma_f32_16x16x32_bf16 v[200:203], a[8:11], a[224:227], v[200:203]
s_waitcnt lgkmcnt(2)
v_mul_f32 v93, v93, v254
v_mul_f32 v94, v94, v254
v_mfma_f32_16x16x32_bf16 v[200:203], a[12:15], a[228:231], v[200:203]
v_mul_f32 v95, v95, v254
v_cvt_pk_bf16_f32 v88, v88, v89
v_mfma_f32_16x16x32_bf16 v[204:207], a[80:83], a[200:203], 0
v_cvt_pk_bf16_f32 v89, v90, v91
v_cvt_pk_bf16_f32 v90, v92, v93
v_mfma_f32_16x16x32_bf16 v[204:207], a[84:87], a[204:207], v[204:207]
ds_write_b128 v241, v[80:83] offset:0
v_mfma_f32_16x16x32_bf16 v[204:207], a[88:91], a[208:211], v[204:207]
v_cvt_pk_bf16_f32 v91, v94, v95
v_accvgpr_read_b32 v255, a172
v_mfma_f32_16x16x32_bf16 v[204:207], a[92:95], a[212:215], v[204:207]
v_cvt_pk_bf16_f32 v212, v200, v201
v_cvt_pk_bf16_f32 v213, v202, v203
v_mfma_f32_16x16x32_bf16 v[204:207], a[16:19], a[216:219], v[204:207]
s_add_u32 s61, s56, 20480
buffer_load_dwordx4 v246, s[36:39], s45 offen offset:2112 lds
v_mfma_f32_16x16x32_bf16 v[204:207], a[20:23], a[220:223], v[204:207]
ds_write_b128 v241, v[88:91] offset:1024
v_mfma_f32_16x16x32_bf16 v[204:207], a[24:27], a[224:227], v[204:207]
v_rcp_f32 v254, v255
v_mfma_f32_16x16x32_bf16 v[204:207], a[28:31], a[228:231], v[204:207]
v_mul_f32 v96, v96, v254
v_mul_f32 v97, v97, v254
v_mfma_f32_16x16x32_bf16 v[192:195], a[32:35], v[32:35], 0
v_mul_f32 v98, v98, v254
v_mul_f32 v99, v99, v254
v_mfma_f32_16x16x32_bf16 v[192:195], a[36:39], v[36:39], v[192:195]
v_mul_f32 v100, v100, v254
v_mul_f32 v101, v101, v254
v_mfma_f32_16x16x32_bf16 v[192:195], a[40:43], v[40:43], v[192:195]
v_mul_f32 v102, v102, v254
v_mul_f32 v103, v103, v254
v_mfma_f32_16x16x32_bf16 v[192:195], a[44:47], v[44:47], v[192:195]
v_cvt_pk_bf16_f32 v214, v204, v205
v_cvt_pk_bf16_f32 v215, v206, v207
v_mfma_f32_16x16x32_bf16 v[192:195], a[96:99], v[48:51], v[192:195]
buffer_store_dwordx4 v[212:215], v243, s[40:43], s61 offen offset:0 sc1
v_mfma_f32_16x16x32_bf16 v[192:195], a[100:103], v[52:55], v[192:195]
s_waitcnt lgkmcnt(0)
s_barrier
ds_read_b128 v[64:67], v249 offset:0
v_mfma_f32_16x16x32_bf16 v[192:195], a[104:107], v[56:59], v[192:195]
ds_read_b128 v[68:71], v249 offset:1024
v_cvt_pk_bf16_f32 v96, v96, v97
v_mfma_f32_16x16x32_bf16 v[192:195], a[108:111], v[60:63], v[192:195]
ds_read_b128 v[72:75], v249 offset:2048
v_cvt_pk_bf16_f32 v97, v98, v99
v_mfma_f32_16x16x32_bf16 v[196:199], a[48:51], v[32:35], 0
ds_read_b128 v[76:79], v249 offset:3072
v_cvt_pk_bf16_f32 v98, v100, v101
v_mfma_f32_16x16x32_bf16 v[196:199], a[52:55], v[36:39], v[196:199]
ds_read_b128 v[80:83], v249 offset:4096
v_cvt_pk_bf16_f32 v99, v102, v103
v_mfma_f32_16x16x32_bf16 v[196:199], a[56:59], v[40:43], v[196:199]
ds_read_b128 v[84:87], v249 offset:5120
v_mul_f32 v104, v104, v254
v_mfma_f32_16x16x32_bf16 v[196:199], a[60:63], v[44:47], v[196:199]
ds_read_b128 v[88:91], v249 offset:6144
v_cvt_pk_bf16_f32 v208, v192, v193
v_mfma_f32_16x16x32_bf16 v[196:199], a[112:115], v[48:51], v[196:199]
ds_read_b128 v[92:95], v249 offset:7168
v_cvt_pk_bf16_f32 v209, v194, v195
v_mfma_f32_16x16x32_bf16 v[196:199], a[116:119], v[52:55], v[196:199]
s_mul_i32 s56, s99, 144
buffer_load_dwordx4 v247, s[36:39], s45 offen offset:3168 lds
v_mfma_f32_16x16x32_bf16 v[196:199], a[120:123], v[56:59], v[196:199]
s_add_u32 s61, s56, 4096
ds_read_b128 v[128:131], v249 offset:8192
v_mul_f32 v105, v105, v254
v_mfma_f32_16x16x32_bf16 v[196:199], a[124:127], v[60:63], v[196:199]
s_waitcnt lgkmcnt(5)
ds_read_b128 v[132:135], v249 offset:9216
v_mul_f32 v106, v106, v254
v_mfma_f32_16x16x32_bf16 v[200:203], a[64:67], v[64:67], 0
ds_read_b128 v[136:139], v249 offset:10240
v_mul_f32 v107, v107, v254
v_mfma_f32_16x16x32_bf16 v[200:203], a[68:71], v[68:71], v[200:203]
ds_read_b128 v[140:143], v249 offset:11264
v_mul_f32 v108, v108, v254
v_mfma_f32_16x16x32_bf16 v[200:203], a[72:75], v[72:75], v[200:203]
ds_read_b128 v[144:147], v249 offset:12288
v_mul_f32 v109, v109, v254
v_mfma_f32_16x16x32_bf16 v[200:203], a[76:79], v[76:79], v[200:203]
s_waitcnt lgkmcnt(5)
ds_read_b128 v[148:151], v249 offset:13312
v_cvt_pk_bf16_f32 v210, v196, v197
v_mfma_f32_16x16x32_bf16 v[200:203], a[0:3], v[80:83], v[200:203]
s_add_u32 m0, s44, 17024
ds_read_b128 v[152:155], v249 offset:14336
v_cvt_pk_bf16_f32 v211, v198, v199
v_mfma_f32_16x16x32_bf16 v[200:203], a[4:7], v[84:87], v[200:203]
s_add_u32 s45, s101, 65536
buffer_store_dwordx4 v[208:211], v243, s[40:43], s61 offen offset:0 sc1
v_mfma_f32_16x16x32_bf16 v[200:203], a[8:11], v[88:91], v[200:203]
ds_read_b128 v[156:159], v249 offset:15360
v_mul_f32 v110, v110, v254
v_mfma_f32_16x16x32_bf16 v[200:203], a[12:15], v[92:95], v[200:203]
buffer_load_dwordx4 v244, s[36:39], s45 offen offset:0 lds
v_mfma_f32_16x16x32_bf16 v[204:207], a[80:83], v[64:67], 0
ds_write_b128 v240, v[96:99] offset:17024
v_mfma_f32_16x16x32_bf16 v[204:207], a[84:87], v[68:71], v[204:207]
v_mul_f32 v111, v111, v254
v_cvt_pk_bf16_f32 v104, v104, v105
v_mfma_f32_16x16x32_bf16 v[204:207], a[88:91], v[72:75], v[204:207]
v_cvt_pk_bf16_f32 v105, v106, v107
v_cvt_pk_bf16_f32 v106, v108, v109
v_mfma_f32_16x16x32_bf16 v[204:207], a[92:95], v[76:79], v[204:207]
v_cvt_pk_bf16_f32 v212, v200, v201
v_cvt_pk_bf16_f32 v213, v202, v203
v_mfma_f32_16x16x32_bf16 v[204:207], a[16:19], v[80:83], v[204:207]
s_mul_i32 s56, s98, 144
s_add_u32 s61, s56, 8192
v_cvt_pk_bf16_f32 v107, v110, v111
v_mfma_f32_16x16x32_bf16 v[204:207], a[20:23], v[84:87], v[204:207]
ds_write_b128 v240, v[104:107] offset:18048
v_mfma_f32_16x16x32_bf16 v[204:207], a[24:27], v[88:91], v[204:207]
v_mul_f32 v112, v112, v254
v_mul_f32 v113, v113, v254
v_mfma_f32_16x16x32_bf16 v[204:207], a[28:31], v[92:95], v[204:207]
s_waitcnt lgkmcnt(1)
v_mul_f32 v114, v114, v254
v_mul_f32 v115, v115, v254
v_mfma_f32_16x16x32_bf16 v[192:195], a[64:67], v[128:131], 0
v_mul_f32 v116, v116, v254
v_mul_f32 v117, v117, v254
v_mfma_f32_16x16x32_bf16 v[192:195], a[68:71], v[132:135], v[192:195]
v_mul_f32 v118, v118, v254
v_mul_f32 v119, v119, v254
v_mfma_f32_16x16x32_bf16 v[192:195], a[72:75], v[136:139], v[192:195]
v_cvt_pk_bf16_f32 v112, v112, v113
v_cvt_pk_bf16_f32 v113, v114, v115
v_mfma_f32_16x16x32_bf16 v[192:195], a[76:79], v[140:143], v[192:195]
v_cvt_pk_bf16_f32 v214, v204, v205
v_cvt_pk_bf16_f32 v215, v206, v207
v_mfma_f32_16x16x32_bf16 v[192:195], a[0:3], v[144:147], v[192:195]
buffer_store_dwordx4 v[212:215], v243, s[40:43], s61 offen offset:0 sc1
v_mfma_f32_16x16x32_bf16 v[192:195], a[4:7], v[148:151], v[192:195]
v_cvt_pk_bf16_f32 v114, v116, v117
v_cvt_pk_bf16_f32 v115, v118, v119
v_mfma_f32_16x16x32_bf16 v[192:195], a[8:11], v[152:155], v[192:195]
buffer_load_dwordx4 v245, s[36:39], s45 offen offset:1056 lds
v_mfma_f32_16x16x32_bf16 v[192:195], a[12:15], v[156:159], v[192:195]
ds_write_b128 v241, v[112:115] offset:17024
v_mfma_f32_16x16x32_bf16 v[196:199], a[80:83], v[128:131], 0
v_mul_f32 v120, v120, v254
v_mul_f32 v121, v121, v254
v_mfma_f32_16x16x32_bf16 v[196:199], a[84:87], v[132:135], v[196:199]
v_mul_f32 v122, v122, v254
v_mul_f32 v123, v123, v254
v_mfma_f32_16x16x32_bf16 v[196:199], a[88:91], v[136:139], v[196:199]
v_mul_f32 v124, v124, v254
v_mul_f32 v125, v125, v254
v_mfma_f32_16x16x32_bf16 v[196:199], a[92:95], v[140:143], v[196:199]
v_cvt_pk_bf16_f32 v208, v192, v193
v_cvt_pk_bf16_f32 v209, v194, v195
v_mfma_f32_16x16x32_bf16 v[196:199], a[16:19], v[144:147], v[196:199]
s_add_u32 s61, s56, 24576
v_mul_f32 v126, v126, v254
v_mul_f32 v127, v127, v254
v_mfma_f32_16x16x32_bf16 v[196:199], a[20:23], v[148:151], v[196:199]
v_cvt_pk_bf16_f32 v120, v120, v121
v_cvt_pk_bf16_f32 v121, v122, v123
v_mfma_f32_16x16x32_bf16 v[196:199], a[24:27], v[152:155], v[196:199]
v_cvt_pk_bf16_f32 v122, v124, v125
v_cvt_pk_bf16_f32 v123, v126, v127
v_mfma_f32_16x16x32_bf16 v[196:199], a[28:31], v[156:159], v[196:199]
ds_write_b128 v241, v[120:123] offset:18048
v_mfma_f32_16x16x32_bf16 v[200:203], a[32:35], a[200:203], 0
v_mfma_f32_16x16x32_bf16 v[200:203], a[36:39], a[204:207], v[200:203]
v_mfma_f32_16x16x32_bf16 v[200:203], a[40:43], a[208:211], v[200:203]
v_mfma_f32_16x16x32_bf16 v[200:203], a[44:47], a[212:215], v[200:203]
s_nop 2
v_cvt_pk_bf16_f32 v210, v196, v197
v_cvt_pk_bf16_f32 v211, v198, v199
v_mfma_f32_16x16x32_bf16 v[200:203], a[96:99], a[216:219], v[200:203]
buffer_store_dwordx4 v[208:211], v243, s[40:43], s61 offen offset:0 sc1
v_mfma_f32_16x16x32_bf16 v[200:203], a[100:103], a[220:223], v[200:203]
v_mfma_f32_16x16x32_bf16 v[200:203], a[104:107], a[224:227], v[200:203]
buffer_load_dwordx4 v246, s[36:39], s45 offen offset:2112 lds
v_mfma_f32_16x16x32_bf16 v[200:203], a[108:111], a[228:231], v[200:203]
v_mfma_f32_16x16x32_bf16 v[204:207], a[48:51], a[200:203], 0
v_mfma_f32_16x16x32_bf16 v[204:207], a[52:55], a[204:207], v[204:207]
v_mfma_f32_16x16x32_bf16 v[204:207], a[56:59], a[208:211], v[204:207]
v_mfma_f32_16x16x32_bf16 v[204:207], a[60:63], a[212:215], v[204:207]
s_nop 3
v_cvt_pk_bf16_f32 v212, v200, v201
v_cvt_pk_bf16_f32 v213, v202, v203
v_mfma_f32_16x16x32_bf16 v[204:207], a[112:115], a[216:219], v[204:207]
s_mul_i32 s56, s99, 144
s_add_u32 s61, s56, 20480
v_mfma_f32_16x16x32_bf16 v[204:207], a[116:119], a[220:223], v[204:207]
v_mfma_f32_16x16x32_bf16 v[204:207], a[120:123], a[224:227], v[204:207]
v_mfma_f32_16x16x32_bf16 v[204:207], a[124:127], a[228:231], v[204:207]
v_mfma_f32_16x16x32_bf16 v[192:195], a[32:35], v[64:67], 0
v_mfma_f32_16x16x32_bf16 v[192:195], a[36:39], v[68:71], v[192:195]
v_mfma_f32_16x16x32_bf16 v[192:195], a[40:43], v[72:75], v[192:195]
v_mfma_f32_16x16x32_bf16 v[192:195], a[44:47], v[76:79], v[192:195]
s_nop 3
v_cvt_pk_bf16_f32 v214, v204, v205
v_cvt_pk_bf16_f32 v215, v206, v207
v_mfma_f32_16x16x32_bf16 v[192:195], a[96:99], v[80:83], v[192:195]
buffer_store_dwordx4 v[212:215], v243, s[40:43], s61 offen offset:0 sc1
v_mfma_f32_16x16x32_bf16 v[192:195], a[100:103], v[84:87], v[192:195]
s_waitcnt lgkmcnt(0)
s_barrier
ds_read_b128 v[96:99], v249 offset:17024
v_mfma_f32_16x16x32_bf16 v[192:195], a[104:107], v[88:91], v[192:195]
ds_read_b128 v[100:103], v249 offset:18048
v_mfma_f32_16x16x32_bf16 v[192:195], a[108:111], v[92:95], v[192:195]
ds_read_b128 v[104:107], v249 offset:19072
v_mfma_f32_16x16x32_bf16 v[196:199], a[48:51], v[64:67], 0
ds_read_b128 v[108:111], v249 offset:20096
v_mfma_f32_16x16x32_bf16 v[196:199], a[52:55], v[68:71], v[196:199]
ds_read_b128 v[112:115], v249 offset:21120
v_mfma_f32_16x16x32_bf16 v[196:199], a[56:59], v[72:75], v[196:199]
ds_read_b128 v[116:119], v249 offset:22144
v_mfma_f32_16x16x32_bf16 v[196:199], a[60:63], v[76:79], v[196:199]
ds_read_b128 v[120:123], v249 offset:23168
v_cvt_pk_bf16_f32 v208, v192, v193
v_cvt_pk_bf16_f32 v209, v194, v195
v_mfma_f32_16x16x32_bf16 v[196:199], a[112:115], v[80:83], v[196:199]
s_add_u32 s61, s56, 8192
ds_read_b128 v[124:127], v249 offset:24192
v_mfma_f32_16x16x32_bf16 v[196:199], a[116:119], v[84:87], v[196:199]
buffer_load_dwordx4 v247, s[36:39], s45 offen offset:3168 lds
v_mfma_f32_16x16x32_bf16 v[196:199], a[120:123], v[88:91], v[196:199]
ds_read_b128 a[160:163], v249 offset:25216
v_mfma_f32_16x16x32_bf16 v[196:199], a[124:127], v[92:95], v[196:199]
s_waitcnt lgkmcnt(5)
ds_read_b128 v[168:171], v242 offset:0
v_mfma_f32_16x16x32_bf16 v[200:203], a[64:67], v[96:99], 0
ds_read_b128 v[172:175], v242 offset:1024
v_mfma_f32_16x16x32_bf16 v[200:203], a[68:71], v[100:103], v[200:203]
ds_read_b128 v[176:179], v242 offset:2048
v_mfma_f32_16x16x32_bf16 v[200:203], a[72:75], v[104:107], v[200:203]
ds_read_b128 v[180:183], v242 offset:3072
s_lshl_b32 s52, s3, 11
v_add_u32 v242, s52, v249
v_mfma_f32_16x16x32_bf16 v[200:203], a[76:79], v[108:111], v[200:203]
s_waitcnt lgkmcnt(5)
ds_read_b128 a[164:167], v249 offset:26240
v_cvt_pk_bf16_f32 v210, v196, v197
v_cvt_pk_bf16_f32 v211, v198, v199
v_mfma_f32_16x16x32_bf16 v[200:203], a[0:3], v[112:115], v[200:203]
ds_read_b128 a[168:171], v249 offset:27264
v_accvgpr_read_b32 v255, a128
v_mfma_f32_16x16x32_bf16 v[200:203], a[4:7], v[116:119], v[200:203]
ds_read_b128 a[172:175], v249 offset:28288
s_waitcnt lgkmcnt(6)
v_mul_f32 v168, v168, v229
v_mfma_f32_16x16x32_bf16 v[200:203], a[8:11], v[120:123], v[200:203]
buffer_store_dwordx4 v[208:211], v243, s[40:43], s61 offen offset:0 sc1
v_fma_f32 v168, v255, v230, v168
v_mfma_f32_16x16x32_bf16 v[200:203], a[12:15], v[124:127], v[200:203]
ds_read_b128 a[176:179], v249 offset:29312
v_accvgpr_read_b32 v231, a129
v_mul_f32 v169, v169, v229
v_mfma_f32_16x16x32_bf16 v[204:207], a[80:83], v[96:99], 0
ds_read_b128 a[180:183], v249 offset:30336
v_fma_f32 v169, v231, v230, v169
v_accvgpr_read_b32 v255, a130
v_mfma_f32_16x16x32_bf16 v[204:207], a[84:87], v[100:103], v[204:207]
ds_read_b128 a[184:187], v249 offset:31360
v_mul_f32 v170, v170, v229
v_mfma_f32_16x16x32_bf16 v[204:207], a[88:91], v[104:107], v[204:207]
ds_read_b128 a[188:191], v249 offset:32384
v_fma_f32 v170, v255, v230, v170
v_accvgpr_read_b32 v231, a131
v_mfma_f32_16x16x32_bf16 v[204:207], a[92:95], v[108:111], v[204:207]
v_cvt_pk_bf16_f32 v212, v200, v201
v_cvt_pk_bf16_f32 v213, v202, v203
s_mul_i32 s56, s98, 144
v_mfma_f32_16x16x32_bf16 v[204:207], a[16:19], v[112:115], v[204:207]
s_add_u32 s61, s56, 12288
v_mul_f32 v171, v171, v229
v_fma_f32 v171, v231, v230, v171
v_accvgpr_read_b32 v255, a132
v_mfma_f32_16x16x32_bf16 v[204:207], a[20:23], v[116:119], v[204:207]
s_waitcnt lgkmcnt(4)
v_mul_f32 v172, v172, v229
v_fma_f32 v172, v255, v230, v172
v_mfma_f32_16x16x32_bf16 v[204:207], a[24:27], v[120:123], v[204:207]
v_accvgpr_read_b32 v231, a133
v_mul_f32 v173, v173, v229
v_fma_f32 v173, v231, v230, v173
v_mfma_f32_16x16x32_bf16 v[204:207], a[28:31], v[124:127], v[204:207]
s_cmp_lg_u32 0, 0
Lisl9_0:
s_cbranch_scc1 Lisl9_1
v_accvgpr_read_b32 v255, a134
v_mul_f32 v174, v174, v229
v_fma_f32 v174, v255, v230, v174
v_mfma_f32_16x16x32_bf16 v[192:195], a[64:67], a[160:163], 0
v_accvgpr_read_b32 v231, a135
v_mul_f32 v175, v175, v229
v_fma_f32 v175, v231, v230, v175
v_mfma_f32_16x16x32_bf16 v[192:195], a[68:71], a[164:167], v[192:195]
v_cvt_pk_bf16_f32 v168, v168, v169
v_cvt_pk_bf16_f32 v169, v170, v171
v_cvt_pk_bf16_f32 v170, v172, v173
v_mfma_f32_16x16x32_bf16 v[192:195], a[72:75], a[168:171], v[192:195]
v_cvt_pk_bf16_f32 v171, v174, v175
v_accvgpr_read_b32 v255, a136
v_mul_f32 v176, v176, v229
v_mfma_f32_16x16x32_bf16 v[192:195], a[76:79], a[172:175], v[192:195]
s_cmp_lg_u32 0, 0
Lisl9_1:
s_cbranch_scc1 Lret1
s_waitcnt lgkmcnt(0)
v_cvt_pk_bf16_f32 v214, v204, v205
v_cvt_pk_bf16_f32 v215, v206, v207
v_mfma_f32_16x16x32_bf16 v[192:195], a[0:3], a[176:179], v[192:195]
buffer_store_dwordx4 v[212:215], v243, s[40:43], s61 offen offset:0 sc1
v_fma_f32 v176, v255, v230, v176
v_mfma_f32_16x16x32_bf16 v[192:195], a[4:7], a[180:183], v[192:195]
ds_write_b128 v242, v[168:171] offset:51072
v_accvgpr_read_b32 v231, a137
v_mfma_f32_16x16x32_bf16 v[192:195], a[8:11], a[184:187], v[192:195]
v_mul_f32 v177, v177, v229
v_fma_f32 v177, v231, v230, v177
v_accvgpr_read_b32 v255, a138
v_mfma_f32_16x16x32_bf16 v[192:195], a[12:15], a[188:191], v[192:195]
v_mul_f32 v178, v178, v229
v_fma_f32 v178, v255, v230, v178
v_mfma_f32_16x16x32_bf16 v[196:199], a[80:83], a[160:163], 0
v_accvgpr_read_b32 v231, a139
v_mul_f32 v179, v179, v229
v_fma_f32 v179, v231, v230, v179
v_mfma_f32_16x16x32_bf16 v[196:199], a[84:87], a[164:167], v[196:199]
v_accvgpr_read_b32 v255, a140
v_mul_f32 v180, v180, v229
v_mfma_f32_16x16x32_bf16 v[196:199], a[88:91], a[168:171], v[196:199]
v_fma_f32 v180, v255, v230, v180
v_accvgpr_read_b32 v231, a141
v_mul_f32 v181, v181, v229
v_mfma_f32_16x16x32_bf16 v[196:199], a[92:95], a[172:175], v[196:199]
v_fma_f32 v181, v231, v230, v181
v_accvgpr_read_b32 v255, a142
v_mul_f32 v182, v182, v229
v_mfma_f32_16x16x32_bf16 v[196:199], a[16:19], a[176:179], v[196:199]
v_fma_f32 v182, v255, v230, v182
v_accvgpr_read_b32 v231, a143
v_mfma_f32_16x16x32_bf16 v[196:199], a[20:23], a[180:183], v[196:199]
v_mul_f32 v183, v183, v229
v_fma_f32 v183, v231, v230, v183
v_cvt_pk_bf16_f32 v176, v176, v177
v_mfma_f32_16x16x32_bf16 v[196:199], a[24:27], a[184:187], v[196:199]
v_cvt_pk_bf16_f32 v177, v178, v179
v_cvt_pk_bf16_f32 v178, v180, v181
v_mfma_f32_16x16x32_bf16 v[196:199], a[28:31], a[188:191], v[196:199]
v_cvt_pk_bf16_f32 v179, v182, v183
v_cvt_pk_bf16_f32 v208, v192, v193
v_cvt_pk_bf16_f32 v209, v194, v195
v_mfma_f32_16x16x32_bf16 v[200:203], a[32:35], v[128:131], 0
s_add_u32 s61, s56, 28672
ds_write_b128 v242, v[176:179] offset:52096
v_mfma_f32_16x16x32_bf16 v[200:203], a[36:39], v[132:135], v[200:203]
v_mfma_f32_16x16x32_bf16 v[200:203], a[40:43], v[136:139], v[200:203]
v_mfma_f32_16x16x32_bf16 v[200:203], a[44:47], v[140:143], v[200:203]
v_cvt_pk_bf16_f32 v210, v196, v197
v_cvt_pk_bf16_f32 v211, v198, v199
v_mfma_f32_16x16x32_bf16 v[200:203], a[96:99], v[144:147], v[200:203]
buffer_store_dwordx4 v[208:211], v243, s[40:43], s61 offen offset:0 sc1
v_mfma_f32_16x16x32_bf16 v[200:203], a[100:103], v[148:151], v[200:203]
s_lshl_b32 s53, s50, 4
s_waitcnt vmcnt(19) lgkmcnt(0)
s_barrier
v_mfma_f32_16x16x32_bf16 v[200:203], a[104:107], v[152:155], v[200:203]
s_add_u32 m0, s44, 102144
ds_read_b128 a[128:131], v249 offset:51072
s_add_u32 s45, s101, 131072
v_mfma_f32_16x16x32_bf16 v[200:203], a[108:111], v[156:159], v[200:203]
ds_read_b128 a[132:135], v249 offset:52096
v_mov_b32 v227, s53
v_mfma_f32_16x16x32_bf16 v[204:207], a[48:51], v[128:131], 0
s_lshl4_add_u32 s52, s3, s51
ds_read_b128 a[136:139], v249 offset:53120
s_lshl_b32 s52, s52, 7
v_mfma_f32_16x16x32_bf16 v[204:207], a[52:55], v[132:135], v[204:207]
ds_read_b128 a[140:143], v249 offset:54144
v_lshrrev_b32 v220, 9, v252
v_mfma_f32_16x16x32_bf16 v[204:207], a[56:59], v[136:139], v[204:207]
ds_read_b128 a[144:147], v249 offset:55168
v_lshl_add_u32 v220, v220, 15, s52
v_mfma_f32_16x16x32_bf16 v[204:207], a[60:63], v[140:143], v[204:207]
ds_read_b128 a[148:151], v249 offset:56192
v_cvt_pk_bf16_f32 v212, v200, v201
v_mfma_f32_16x16x32_bf16 v[204:207], a[112:115], v[144:147], v[204:207]
ds_read_b128 a[152:155], v249 offset:57216
v_cvt_pk_bf16_f32 v213, v202, v203
v_mfma_f32_16x16x32_bf16 v[204:207], a[116:119], v[148:151], v[204:207]
s_mul_i32 s56, s99, 144
ds_read_b128 a[156:159], v249 offset:58240
s_add_u32 s61, s56, 24576
v_mfma_f32_16x16x32_bf16 v[204:207], a[120:123], v[152:155], v[204:207]
buffer_load_dwordx4 v244, s[36:39], s45 offen offset:0 lds
v_mfma_f32_16x16x32_bf16 v[204:207], a[124:127], v[156:159], v[204:207]
s_waitcnt lgkmcnt(5)
v_lshrrev_b32 v221, 2, v252
v_add_u32 v220, v220, v221
v_mfma_f32_16x16x32_bf16 v[192:195], a[64:67], a[128:131], 0
ds_read_b64_tr_b16 a[64:65], v239 offset:0
v_mov_b32 v221, 1
v_mfma_f32_16x16x32_bf16 v[192:195], a[68:71], a[132:135], v[192:195]
ds_read_b64_tr_b16 a[66:67], v239 offset:512
v_mfma_f32_16x16x32_bf16 v[192:195], a[72:75], a[136:139], v[192:195]
s_waitcnt lgkmcnt(4)
buffer_load_dwordx4 v245, s[36:39], s45 offen offset:1056 lds
v_mfma_f32_16x16x32_bf16 v[192:195], a[76:79], a[140:143], v[192:195]
ds_read_b64_tr_b16 a[68:69], v239 offset:8448
v_cvt_pk_bf16_f32 v214, v204, v205
v_mfma_f32_16x16x32_bf16 v[192:195], a[0:3], a[144:147], v[192:195]
ds_read_b64_tr_b16 a[70:71], v239 offset:8960
v_cvt_pk_bf16_f32 v215, v206, v207
v_mfma_f32_16x16x32_bf16 v[192:195], a[4:7], a[148:151], v[192:195]
s_waitcnt lgkmcnt(4)
buffer_store_dwordx4 v[212:215], v243, s[40:43], s61 offen offset:0 sc1
v_mfma_f32_16x16x32_bf16 v[192:195], a[8:11], a[152:155], v[192:195]
ds_read_b64_tr_b16 a[72:73], v239 offset:17024
v_mfma_f32_16x16x32_bf16 v[192:195], a[12:15], a[156:159], v[192:195]
ds_read_b64_tr_b16 a[74:75], v239 offset:17536
v_mfma_f32_16x16x32_bf16 v[196:199], a[80:83], a[128:131], 0
ds_read_b64_tr_b16 a[76:77], v239 offset:25472
v_mfma_f32_16x16x32_bf16 v[196:199], a[84:87], a[132:135], v[196:199]
ds_read_b64_tr_b16 a[78:79], v239 offset:25984
v_mfma_f32_16x16x32_bf16 v[196:199], a[88:91], a[136:139], v[196:199]
ds_read_b64_tr_b16 a[0:1], v238 offset:34048
v_mfma_f32_16x16x32_bf16 v[196:199], a[92:95], a[140:143], v[196:199]
ds_read_b64_tr_b16 a[2:3], v238 offset:34560
v_cvt_pk_bf16_f32 v208, v192, v193
v_mfma_f32_16x16x32_bf16 v[196:199], a[16:19], a[144:147], v[196:199]
ds_read_b64_tr_b16 a[4:5], v238 offset:42496
v_cvt_pk_bf16_f32 v209, v194, v195
v_mfma_f32_16x16x32_bf16 v[196:199], a[20:23], a[148:151], v[196:199]
s_mul_i32 s56, s98, 144
ds_read_b64_tr_b16 a[6:7], v238 offset:43008
s_add_u32 s61, s56, 32768
v_mfma_f32_16x16x32_bf16 v[196:199], a[24:27], a[152:155], v[196:199]
buffer_load_dwordx4 v246, s[36:39], s45 offen offset:2112 lds
v_mfma_f32_16x16x32_bf16 v[196:199], a[28:31], a[156:159], v[196:199]
ds_read_b64_tr_b16 a[8:9], v238 offset:51072
v_mfma_f32_16x16x32_bf16 v[200:203], a[32:35], v[96:99], 0
ds_read_b64_tr_b16 a[10:11], v238 offset:51584
v_mfma_f32_16x16x32_bf16 v[200:203], a[36:39], v[100:103], v[200:203]
ds_read_b64_tr_b16 a[12:13], v238 offset:59520
v_mfma_f32_16x16x32_bf16 v[200:203], a[40:43], v[104:107], v[200:203]
ds_read_b64_tr_b16 a[14:15], v238 offset:60032
v_mfma_f32_16x16x32_bf16 v[200:203], a[44:47], v[108:111], v[200:203]
ds_read_b64_tr_b16 a[80:81], v239 offset:32
v_cvt_pk_bf16_f32 v210, v196, v197
v_mfma_f32_16x16x32_bf16 v[200:203], a[96:99], v[112:115], v[200:203]
ds_read_b64_tr_b16 a[82:83], v239 offset:544
v_cvt_pk_bf16_f32 v211, v198, v199
v_mfma_f32_16x16x32_bf16 v[200:203], a[100:103], v[116:119], v[200:203]
buffer_store_dwordx4 v[208:211], v243, s[40:43], s61 offen offset:0 sc1
v_mfma_f32_16x16x32_bf16 v[200:203], a[104:107], v[120:123], v[200:203]
ds_read_b64_tr_b16 a[84:85], v239 offset:8480
v_mfma_f32_16x16x32_bf16 v[200:203], a[108:111], v[124:127], v[200:203]
ds_read_b64_tr_b16 a[86:87], v239 offset:8992
v_mfma_f32_16x16x32_bf16 v[204:207], a[48:51], v[96:99], 0
ds_read_b64_tr_b16 a[88:89], v239 offset:17056
v_mfma_f32_16x16x32_bf16 v[204:207], a[52:55], v[100:103], v[204:207]
ds_read_b64_tr_b16 a[90:91], v239 offset:17568
v_mfma_f32_16x16x32_bf16 v[204:207], a[56:59], v[104:107], v[204:207]
buffer_load_dwordx4 v247, s[36:39], s45 offen offset:3168 lds
v_mfma_f32_16x16x32_bf16 v[204:207], a[60:63], v[108:111], v[204:207]
ds_read_b64_tr_b16 a[92:93], v239 offset:25504
v_mfma_f32_16x16x32_bf16 v[204:207], a[112:115], v[112:115], v[204:207]
ds_read_b64_tr_b16 a[94:95], v239 offset:26016
v_mfma_f32_16x16x32_bf16 v[204:207], a[116:119], v[116:119], v[204:207]
ds_read_b64_tr_b16 a[16:17], v238 offset:34080
v_mfma_f32_16x16x32_bf16 v[204:207], a[120:123], v[120:123], v[204:207]
ds_read_b64_tr_b16 a[18:19], v238 offset:34592
v_mfma_f32_16x16x32_bf16 v[204:207], a[124:127], v[124:127], v[204:207]
ds_read_b64_tr_b16 a[20:21], v238 offset:42528
v_cvt_pk_bf16_f32 v212, v200, v201
v_mfma_f32_16x16x32_bf16 v[192:195], a[32:35], a[160:163], 0
ds_read_b64_tr_b16 a[22:23], v238 offset:43040
v_cvt_pk_bf16_f32 v213, v202, v203
v_mfma_f32_16x16x32_bf16 v[192:195], a[36:39], a[164:167], v[192:195]
s_mul_i32 s56, s99, 144
ds_read_b64_tr_b16 a[24:25], v238 offset:51104
s_add_u32 s61, s56, 12288
v_mfma_f32_16x16x32_bf16 v[192:195], a[40:43], a[168:171], v[192:195]
ds_read_b64_tr_b16 a[26:27], v238 offset:51616
v_mfma_f32_16x16x32_bf16 v[192:195], a[44:47], a[172:175], v[192:195]
s_add_u32 m0, s44, 119168
ds_read_b64_tr_b16 a[28:29], v238 offset:59552
s_add_u32 s45, s101, 196608
v_mfma_f32_16x16x32_bf16 v[192:195], a[96:99], a[176:179], v[192:195]
ds_read_b64_tr_b16 a[30:31], v238 offset:60064
v_mfma_f32_16x16x32_bf16 v[192:195], a[100:103], a[180:183], v[192:195]
v_mfma_f32_16x16x32_bf16 v[192:195], a[104:107], a[184:187], v[192:195]
buffer_load_dwordx4 v244, s[36:39], s45 offen offset:0 lds
v_mfma_f32_16x16x32_bf16 v[192:195], a[108:111], a[188:191], v[192:195]
v_cvt_pk_bf16_f32 v214, v204, v205
v_cvt_pk_bf16_f32 v215, v206, v207
v_mfma_f32_16x16x32_bf16 v[196:199], a[48:51], a[160:163], 0
buffer_store_dwordx4 v[212:215], v243, s[40:43], s61 offen offset:0 sc1
v_mfma_f32_16x16x32_bf16 v[196:199], a[52:55], a[164:167], v[196:199]
v_mfma_f32_16x16x32_bf16 v[196:199], a[56:59], a[168:171], v[196:199]
v_mfma_f32_16x16x32_bf16 v[196:199], a[60:63], a[172:175], v[196:199]
v_mfma_f32_16x16x32_bf16 v[196:199], a[112:115], a[176:179], v[196:199]
v_mfma_f32_16x16x32_bf16 v[196:199], a[116:119], a[180:183], v[196:199]
v_mfma_f32_16x16x32_bf16 v[196:199], a[120:123], a[184:187], v[196:199]
v_mfma_f32_16x16x32_bf16 v[196:199], a[124:127], a[188:191], v[196:199]
v_cvt_pk_bf16_f32 v208, v192, v193
v_cvt_pk_bf16_f32 v209, v194, v195
v_mfma_f32_16x16x32_bf16 v[200:203], a[32:35], a[128:131], 0
s_add_u32 s61, s56, 28672
v_mfma_f32_16x16x32_bf16 v[200:203], a[36:39], a[132:135], v[200:203]
v_mfma_f32_16x16x32_bf16 v[200:203], a[40:43], a[136:139], v[200:203]
buffer_load_dwordx4 v245, s[36:39], s45 offen offset:1056 lds
v_mfma_f32_16x16x32_bf16 v[200:203], a[44:47], a[140:143], v[200:203]
v_mfma_f32_16x16x32_bf16 v[200:203], a[96:99], a[144:147], v[200:203]
v_mfma_f32_16x16x32_bf16 v[200:203], a[100:103], a[148:151], v[200:203]
v_mfma_f32_16x16x32_bf16 v[200:203], a[104:107], a[152:155], v[200:203]
v_mfma_f32_16x16x32_bf16 v[200:203], a[108:111], a[156:159], v[200:203]
v_cvt_pk_bf16_f32 v210, v196, v197
v_cvt_pk_bf16_f32 v211, v198, v199
v_mfma_f32_16x16x32_bf16 v[204:207], a[48:51], a[128:131], 0
buffer_store_dwordx4 v[208:211], v243, s[40:43], s61 offen offset:0 sc1
v_mfma_f32_16x16x32_bf16 v[204:207], a[52:55], a[132:135], v[204:207]
v_mfma_f32_16x16x32_bf16 v[204:207], a[56:59], a[136:139], v[204:207]
v_mfma_f32_16x16x32_bf16 v[204:207], a[60:63], a[140:143], v[204:207]
v_mfma_f32_16x16x32_bf16 v[204:207], a[112:115], a[144:147], v[204:207]
v_mfma_f32_16x16x32_bf16 v[204:207], a[116:119], a[148:151], v[204:207]
v_mfma_f32_16x16x32_bf16 v[204:207], a[120:123], a[152:155], v[204:207]
buffer_load_dwordx4 v246, s[36:39], s45 offen offset:2112 lds
v_mfma_f32_16x16x32_bf16 v[204:207], a[124:127], a[156:159], v[204:207]
s_waitcnt lgkmcnt(0)
v_cvt_pk_bf16_f32 v212, v200, v201
v_cvt_pk_bf16_f32 v213, v202, v203
v_mfma_f32_16x16x32_bf16 v[192:195], a[64:67], v[0:3], 0
s_add_u32 s61, s56, 32768
s_lshr_b32 s55, s101, 6
s_and_b32 s52, s51, 3
v_mfma_f32_16x16x32_bf16 v[192:195], a[68:71], v[4:7], v[192:195]
s_add_u32 s55, s55, s52
v_bfe_u32 v223, v252, 4, 2
v_lshrrev_b32 v168, 8, v252
v_mfma_f32_16x16x32_bf16 v[192:195], a[72:75], v[8:11], v[192:195]
s_lshl_b32 s52, s55, 11
v_lshl_add_u32 v223, v223, 7, s52
s_add_u32 s97, s51, 12
v_mfma_f32_16x16x32_bf16 v[192:195], a[76:79], v[12:15], v[192:195]
s_and_b32 s97, s97, 12
s_lshl_b32 s97, s97, 7
s_lshr_b32 s52, s55, 2
v_mfma_f32_16x16x32_bf16 v[192:195], a[0:3], v[16:19], v[192:195]
s_mul_i32 s52, s52, 9
s_add_u32 s52, s52, s3
s_and_b32 s53, s51, 3
v_mfma_f32_16x16x32_bf16 v[192:195], a[4:7], v[20:23], v[192:195]
s_lshl2_add_u32 s52, s52, s53
s_lshl_b32 s52, s52, 10
v_add_u32 v224, s52, v252
v_mfma_f32_16x16x32_bf16 v[192:195], a[8:11], v[24:27], v[192:195]
v_add_u32 v225, 16384, v224
s_lshl_b32 s53, s3, 28
v_mfma_f32_16x16x32_bf16 v[192:195], a[12:15], v[28:31], v[192:195]
s_add_u32 s52, s53, 32768
v_cvt_pk_bf16_f32 v214, v204, v205
v_cvt_pk_bf16_f32 v215, v206, v207
v_mfma_f32_16x16x32_bf16 v[196:199], a[80:83], v[0:3], 0
buffer_store_dwordx4 v[212:215], v243, s[40:43], s61 offen offset:0 sc1
v_mfma_f32_16x16x32_bf16 v[196:199], a[84:87], v[4:7], v[196:199]
v_add_u32 v226, s52, v224
v_bfe_u32 v169, v252, 4, 4
v_mfma_f32_16x16x32_bf16 v[196:199], a[88:91], v[8:11], v[196:199]
buffer_load_dwordx4 v247, s[36:39], s45 offen offset:3168 lds
v_mfma_f32_16x16x32_bf16 v[196:199], a[92:95], v[12:15], v[196:199]
v_lshlrev_b32 v228, 10, v169
v_lshl_add_u32 v228, v168, 4, v228
v_mfma_f32_16x16x32_bf16 v[196:199], a[16:19], v[16:19], v[196:199]
s_lshl_b32 s52, s3, 14
s_lshl_b32 s62, s55, 6
s_add_u32 s52, s52, s62
v_mfma_f32_16x16x32_bf16 v[196:199], a[20:23], v[20:23], v[196:199]
v_add_u32 v228, s52, v228
v_add_u32 v229, 65536, v228
v_mfma_f32_16x16x32_bf16 v[196:199], a[24:27], v[24:27], v[196:199]
s_add_u32 s52, s53, 131072
v_add_u32 v230, s52, v228
v_and_b32 v170, 1, v169
v_mfma_f32_16x16x32_bf16 v[196:199], a[28:31], v[28:31], v[196:199]
v_cvt_pk_bf16_f32 v208, v192, v193
v_cvt_pk_bf16_f32 v209, v194, v195
v_mfma_f32_16x16x32_bf16 v[200:203], a[64:67], a[232:235], 0
s_mul_i32 s56, s100, 144
s_add_u32 s61, s56, 0
v_lshlrev_b32 v170, 4, v170
v_mfma_f32_16x16x32_bf16 v[200:203], a[68:71], a[236:239], v[200:203]
v_mov_b32 v171, 0x3f80
v_lshlrev_b32 v170, v170, v171
v_mfma_f32_16x16x32_bf16 v[200:203], a[72:75], a[240:243], v[200:203]
v_bfe_u32 v171, v169, 2, 1
v_xor_b32 v171, v171, v168
v_mfma_f32_16x16x32_bf16 v[200:203], a[76:79], a[244:247], v[200:203]
v_and_b32 v168, 1, v171
v_lshlrev_b32 v168, 3, v168
v_mfma_f32_16x16x32_bf16 v[200:203], a[0:3], a[248:251], v[200:203]
v_lshrrev_b32 v171, 1, v171
v_lshl_add_u32 v168, v171, 2, v168
v_mfma_f32_16x16x32_bf16 v[200:203], a[4:7], a[252:255], v[200:203]
v_lshrrev_b32 v171, 3, v169
v_lshl_add_u32 v168, v171, 1, v168
v_mfma_f32_16x16x32_bf16 v[200:203], a[8:11], a[192:195], v[200:203]
v_bfe_u32 v171, v169, 1, 1
v_add_u32 v168, v168, v171
v_mfma_f32_16x16x32_bf16 v[200:203], a[12:15], a[196:199], v[200:203]
v_cvt_pk_bf16_f32 v210, v196, v197
v_cvt_pk_bf16_f32 v211, v198, v199
v_mfma_f32_16x16x32_bf16 v[204:207], a[80:83], a[232:235], 0
buffer_store_dwordx4 v[208:211], v243, s[40:43], s61 offen offset:0 sc1
v_mfma_f32_16x16x32_bf16 v[204:207], a[84:87], a[236:239], v[204:207]
v_lshlrev_b32_e64 v168, v168, 1
v_bfe_i32 v160, v168, 0, 1
v_mfma_f32_16x16x32_bf16 v[204:207], a[88:91], a[240:243], v[204:207]
v_and_b32 v160, v160, v170
v_bfe_i32 v161, v168, 1, 1
v_mfma_f32_16x16x32_bf16 v[204:207], a[92:95], a[244:247], v[204:207]
v_and_b32 v161, v161, v170
v_bfe_i32 v162, v168, 2, 1
v_mfma_f32_16x16x32_bf16 v[204:207], a[16:19], a[248:251], v[204:207]
v_and_b32 v162, v162, v170
v_bfe_i32 v163, v168, 3, 1
v_mfma_f32_16x16x32_bf16 v[204:207], a[20:23], a[252:255], v[204:207]
v_and_b32 v163, v163, v170
v_bfe_i32 v164, v168, 4, 1
v_mfma_f32_16x16x32_bf16 v[204:207], a[24:27], a[192:195], v[204:207]
v_and_b32 v164, v164, v170
v_bfe_i32 v165, v168, 5, 1
v_mfma_f32_16x16x32_bf16 v[204:207], a[28:31], a[196:199], v[204:207]
v_cvt_pk_bf16_f32 v212, v200, v201
v_cvt_pk_bf16_f32 v213, v202, v203
v_mfma_f32_16x16x32_bf16 v[192:195], a[64:67], v[32:35], 0
s_add_u32 s61, s56, 16384
v_and_b32 v165, v165, v170
v_bfe_i32 v166, v168, 6, 1
v_mfma_f32_16x16x32_bf16 v[192:195], a[68:71], v[36:39], v[192:195]
v_and_b32 v166, v166, v170
v_bfe_i32 v167, v168, 7, 1
v_mfma_f32_16x16x32_bf16 v[192:195], a[72:75], v[40:43], v[192:195]
v_and_b32 v167, v167, v170
v_mfma_f32_16x16x32_bf16 v[192:195], a[76:79], v[44:47], v[192:195]
v_mfma_f32_16x16x32_bf16 v[192:195], a[0:3], v[48:51], v[192:195]
v_mfma_f32_16x16x32_bf16 v[192:195], a[4:7], v[52:55], v[192:195]
v_mfma_f32_16x16x32_bf16 v[192:195], a[8:11], v[56:59], v[192:195]
v_mfma_f32_16x16x32_bf16 v[192:195], a[12:15], v[60:63], v[192:195]
v_cvt_pk_bf16_f32 v214, v204, v205
v_cvt_pk_bf16_f32 v215, v206, v207
v_mfma_f32_16x16x32_bf16 v[196:199], a[80:83], v[32:35], 0
buffer_store_dwordx4 v[212:215], v243, s[40:43], s61 offen offset:0 sc1
v_mfma_f32_16x16x32_bf16 v[196:199], a[84:87], v[36:39], v[196:199]
v_mfma_f32_16x16x32_bf16 v[196:199], a[88:91], v[40:43], v[196:199]
v_mfma_f32_16x16x32_bf16 v[196:199], a[92:95], v[44:47], v[196:199]
v_mfma_f32_16x16x32_bf16 v[196:199], a[16:19], v[48:51], v[196:199]
v_mfma_f32_16x16x32_bf16 v[196:199], a[20:23], v[52:55], v[196:199]
v_mfma_f32_16x16x32_bf16 v[196:199], a[24:27], v[56:59], v[196:199]
v_mfma_f32_16x16x32_bf16 v[196:199], a[28:31], v[60:63], v[196:199]
v_cvt_pk_bf16_f32 v208, v192, v193
v_cvt_pk_bf16_f32 v209, v194, v195
v_mfma_f32_16x16x32_bf16 v[200:203], a[64:67], a[200:203], 0
s_add_u32 s61, s56, 4096
v_mfma_f32_16x16x32_bf16 v[200:203], a[68:71], a[204:207], v[200:203]
v_mfma_f32_16x16x32_bf16 v[200:203], a[72:75], a[208:211], v[200:203]
v_mfma_f32_16x16x32_bf16 v[200:203], a[76:79], a[212:215], v[200:203]
v_mfma_f32_16x16x32_bf16 v[200:203], a[0:3], a[216:219], v[200:203]
buffer_load_dword v222, v227, s[16:19], 0 offen offset:0 sc1
v_mfma_f32_16x16x32_bf16 v[200:203], a[4:7], a[220:223], v[200:203]
v_mfma_f32_16x16x32_bf16 v[200:203], a[8:11], a[224:227], v[200:203]
v_mfma_f32_16x16x32_bf16 v[200:203], a[12:15], a[228:231], v[200:203]
v_cvt_pk_bf16_f32 v210, v196, v197
v_cvt_pk_bf16_f32 v211, v198, v199
v_mfma_f32_16x16x32_bf16 v[204:207], a[80:83], a[200:203], 0
buffer_store_dwordx4 v[208:211], v243, s[40:43], s61 offen offset:0 sc1
v_mfma_f32_16x16x32_bf16 v[204:207], a[84:87], a[204:207], v[204:207]
v_mfma_f32_16x16x32_bf16 v[204:207], a[88:91], a[208:211], v[204:207]
v_mfma_f32_16x16x32_bf16 v[204:207], a[92:95], a[212:215], v[204:207]
v_mfma_f32_16x16x32_bf16 v[204:207], a[16:19], a[216:219], v[204:207]
v_mfma_f32_16x16x32_bf16 v[204:207], a[20:23], a[220:223], v[204:207]
v_mfma_f32_16x16x32_bf16 v[204:207], a[24:27], a[224:227], v[204:207]
v_mfma_f32_16x16x32_bf16 v[204:207], a[28:31], a[228:231], v[204:207]
v_cvt_pk_bf16_f32 v212, v200, v201
v_cvt_pk_bf16_f32 v213, v202, v203
v_mfma_f32_16x16x32_bf16 v[192:195], a[64:67], v[64:67], 0
s_add_u32 s61, s56, 20480
v_mfma_f32_16x16x32_bf16 v[192:195], a[68:71], v[68:71], v[192:195]
v_mfma_f32_16x16x32_bf16 v[192:195], a[72:75], v[72:75], v[192:195]
v_mfma_f32_16x16x32_bf16 v[192:195], a[76:79], v[76:79], v[192:195]
v_mfma_f32_16x16x32_bf16 v[192:195], a[0:3], v[80:83], v[192:195]
v_mfma_f32_16x16x32_bf16 v[192:195], a[4:7], v[84:87], v[192:195]
v_mfma_f32_16x16x32_bf16 v[192:195], a[8:11], v[88:91], v[192:195]
v_mfma_f32_16x16x32_bf16 v[192:195], a[12:15], v[92:95], v[192:195]
v_cvt_pk_bf16_f32 v214, v204, v205
v_cvt_pk_bf16_f32 v215, v206, v207
v_mfma_f32_16x16x32_bf16 v[196:199], a[80:83], v[64:67], 0
buffer_store_dwordx4 v[212:215], v243, s[40:43], s61 offen offset:0 sc1
v_mfma_f32_16x16x32_bf16 v[196:199], a[84:87], v[68:71], v[196:199]
v_mfma_f32_16x16x32_bf16 v[196:199], a[88:91], v[72:75], v[196:199]
v_mfma_f32_16x16x32_bf16 v[196:199], a[92:95], v[76:79], v[196:199]
v_mfma_f32_16x16x32_bf16 v[196:199], a[16:19], v[80:83], v[196:199]
v_mfma_f32_16x16x32_bf16 v[196:199], a[20:23], v[84:87], v[196:199]
v_mfma_f32_16x16x32_bf16 v[196:199], a[24:27], v[88:91], v[196:199]
v_mfma_f32_16x16x32_bf16 v[196:199], a[28:31], v[92:95], v[196:199]
v_cvt_pk_bf16_f32 v208, v192, v193
v_cvt_pk_bf16_f32 v209, v194, v195
v_mfma_f32_16x16x32_bf16 v[200:203], a[64:67], v[128:131], 0
s_add_u32 s61, s56, 8192
v_mfma_f32_16x16x32_bf16 v[200:203], a[68:71], v[132:135], v[200:203]
v_mfma_f32_16x16x32_bf16 v[200:203], a[72:75], v[136:139], v[200:203]
v_mfma_f32_16x16x32_bf16 v[200:203], a[76:79], v[140:143], v[200:203]
v_mfma_f32_16x16x32_bf16 v[200:203], a[0:3], v[144:147], v[200:203]
v_mfma_f32_16x16x32_bf16 v[200:203], a[4:7], v[148:151], v[200:203]
v_mfma_f32_16x16x32_bf16 v[200:203], a[8:11], v[152:155], v[200:203]
v_mfma_f32_16x16x32_bf16 v[200:203], a[12:15], v[156:159], v[200:203]
v_cvt_pk_bf16_f32 v210, v196, v197
v_cvt_pk_bf16_f32 v211, v198, v199
v_mfma_f32_16x16x32_bf16 v[204:207], a[80:83], v[128:131], 0
buffer_store_dwordx4 v[208:211], v243, s[40:43], s61 offen offset:0 sc1
v_mfma_f32_16x16x32_bf16 v[204:207], a[84:87], v[132:135], v[204:207]
v_mfma_f32_16x16x32_bf16 v[204:207], a[88:91], v[136:139], v[204:207]
v_mfma_f32_16x16x32_bf16 v[204:207], a[92:95], v[140:143], v[204:207]
v_mfma_f32_16x16x32_bf16 v[204:207], a[16:19], v[144:147], v[204:207]
v_mfma_f32_16x16x32_bf16 v[204:207], a[20:23], v[148:151], v[204:207]
v_mfma_f32_16x16x32_bf16 v[204:207], a[24:27], v[152:155], v[204:207]
v_mfma_f32_16x16x32_bf16 v[204:207], a[28:31], v[156:159], v[204:207]
v_cvt_pk_bf16_f32 v212, v200, v201
v_cvt_pk_bf16_f32 v213, v202, v203
v_mfma_f32_16x16x32_bf16 v[192:195], a[64:67], v[96:99], 0
s_add_u32 s61, s56, 24576
v_mfma_f32_16x16x32_bf16 v[192:195], a[68:71], v[100:103], v[192:195]
v_mfma_f32_16x16x32_bf16 v[192:195], a[72:75], v[104:107], v[192:195]
v_mfma_f32_16x16x32_bf16 v[192:195], a[76:79], v[108:111], v[192:195]
v_mfma_f32_16x16x32_bf16 v[192:195], a[0:3], v[112:115], v[192:195]
s_waitcnt vmcnt(6)
s_barrier
ds_read_b64_tr_b16 a[32:33], v238 offset:0
v_mfma_f32_16x16x32_bf16 v[192:195], a[4:7], v[116:119], v[192:195]
ds_read_b64_tr_b16 a[34:35], v238 offset:512
v_mfma_f32_16x16x32_bf16 v[192:195], a[8:11], v[120:123], v[192:195]
ds_read_b64_tr_b16 a[36:37], v238 offset:8448
v_mfma_f32_16x16x32_bf16 v[192:195], a[12:15], v[124:127], v[192:195]
ds_read_b64_tr_b16 a[38:39], v238 offset:8960
v_cvt_pk_bf16_f32 v214, v204, v205
v_mfma_f32_16x16x32_bf16 v[196:199], a[80:83], v[96:99], 0
ds_read_b64_tr_b16 a[40:41], v238 offset:17024
v_cvt_pk_bf16_f32 v215, v206, v207
v_mfma_f32_16x16x32_bf16 v[196:199], a[84:87], v[100:103], v[196:199]
buffer_store_dwordx4 v[212:215], v243, s[40:43], s61 offen offset:0 sc1
v_mfma_f32_16x16x32_bf16 v[196:199], a[88:91], v[104:107], v[196:199]
ds_read_b64_tr_b16 a[42:43], v238 offset:17536
v_mfma_f32_16x16x32_bf16 v[196:199], a[92:95], v[108:111], v[196:199]
ds_read_b64_tr_b16 a[44:45], v238 offset:25472
v_mfma_f32_16x16x32_bf16 v[196:199], a[16:19], v[112:115], v[196:199]
ds_read_b64_tr_b16 a[46:47], v238 offset:25984
v_mfma_f32_16x16x32_bf16 v[196:199], a[20:23], v[116:119], v[196:199]
ds_read_b64_tr_b16 a[96:97], v239 offset:34048
v_mfma_f32_16x16x32_bf16 v[196:199], a[24:27], v[120:123], v[196:199]
ds_read_b64_tr_b16 a[98:99], v239 offset:34560
v_mfma_f32_16x16x32_bf16 v[196:199], a[28:31], v[124:127], v[196:199]
ds_read_b64_tr_b16 a[100:101], v239 offset:42496
v_cvt_pk_bf16_f32 v208, v192, v193
v_mfma_f32_16x16x32_bf16 v[200:203], a[64:67], a[160:163], 0
s_xor_b32 s96, s51, s3
ds_read_b64_tr_b16 a[102:103], v239 offset:43008
v_cvt_pk_bf16_f32 v209, v194, v195
v_mfma_f32_16x16x32_bf16 v[200:203], a[68:71], a[164:167], v[200:203]
s_add_u32 s61, s56, 12288
ds_read_b64_tr_b16 a[104:105], v239 offset:51072
v_mfma_f32_16x16x32_bf16 v[200:203], a[72:75], a[168:171], v[200:203]
ds_read_b64_tr_b16 a[106:107], v239 offset:51584
v_mfma_f32_16x16x32_bf16 v[200:203], a[76:79], a[172:175], v[200:203]
ds_read_b64_tr_b16 a[108:109], v239 offset:59520
v_mfma_f32_16x16x32_bf16 v[200:203], a[0:3], a[176:179], v[200:203]
ds_read_b64_tr_b16 a[110:111], v239 offset:60032
v_mfma_f32_16x16x32_bf16 v[200:203], a[4:7], a[180:183], v[200:203]
ds_read_b64_tr_b16 a[48:49], v238 offset:32
v_mfma_f32_16x16x32_bf16 v[200:203], a[8:11], a[184:187], v[200:203]
ds_read_b64_tr_b16 a[50:51], v238 offset:544
v_mfma_f32_16x16x32_bf16 v[200:203], a[12:15], a[188:191], v[200:203]
ds_read_b64_tr_b16 a[52:53], v238 offset:8480
v_cvt_pk_bf16_f32 v210, v196, v197
v_mfma_f32_16x16x32_bf16 v[204:207], a[80:83], a[160:163], 0
ds_read_b64_tr_b16 a[54:55], v238 offset:8992
v_cvt_pk_bf16_f32 v211, v198, v199
v_mfma_f32_16x16x32_bf16 v[204:207], a[84:87], a[164:167], v[204:207]
buffer_store_dwordx4 v[208:211], v243, s[40:43], s61 offen offset:0 sc1
v_mfma_f32_16x16x32_bf16 v[204:207], a[88:91], a[168:171], v[204:207]
s_and_b32 s96, s96, 3
s_cselect_b32 s96, 0, 0x10000000
v_mfma_f32_16x16x32_bf16 v[204:207], a[92:95], a[172:175], v[204:207]
ds_read_b64_tr_b16 a[56:57], v238 offset:17056
v_add_u32 v232, s96, v243
v_mfma_f32_16x16x32_bf16 v[204:207], a[16:19], a[176:179], v[204:207]
s_lshr_b32 s96, s96, 12
ds_read_b64_tr_b16 a[58:59], v238 offset:17568
s_xor_b32 s96, s96, 65536
v_mfma_f32_16x16x32_bf16 v[204:207], a[20:23], a[180:183], v[204:207]
s_add_u32 s96, s96, 136192
ds_read_b64_tr_b16 a[60:61], v238 offset:25504
v_add_u32 v233, s96, v252
v_mfma_f32_16x16x32_bf16 v[204:207], a[24:27], a[184:187], v[204:207]
ds_read_b64_tr_b16 a[62:63], v238 offset:26016
v_add_u32 v234, 136192, v243
v_mfma_f32_16x16x32_bf16 v[204:207], a[28:31], a[188:191], v[204:207]
ds_read_b64_tr_b16 a[112:113], v239 offset:34080
v_cvt_pk_bf16_f32 v212, v200, v201
v_mfma_f32_16x16x32_bf16 v[192:195], a[64:67], a[128:131], 0
ds_read_b64_tr_b16 a[114:115], v239 offset:34592
v_cvt_pk_bf16_f32 v213, v202, v203
v_mfma_f32_16x16x32_bf16 v[192:195], a[68:71], a[132:135], v[192:195]
s_add_u32 s61, s56, 28672
ds_read_b64_tr_b16 a[116:117], v239 offset:42528
v_mfma_f32_16x16x32_bf16 v[192:195], a[72:75], a[136:139], v[192:195]
ds_read_b64_tr_b16 a[118:119], v239 offset:43040
v_mfma_f32_16x16x32_bf16 v[192:195], a[76:79], a[140:143], v[192:195]
ds_read_b64_tr_b16 a[120:121], v239 offset:51104
v_mfma_f32_16x16x32_bf16 v[192:195], a[0:3], a[144:147], v[192:195]
ds_read_b64_tr_b16 a[122:123], v239 offset:51616
v_mfma_f32_16x16x32_bf16 v[192:195], a[4:7], a[148:151], v[192:195]
ds_read_b64_tr_b16 a[124:125], v239 offset:59552
v_mfma_f32_16x16x32_bf16 v[192:195], a[8:11], a[152:155], v[192:195]
ds_read_b64_tr_b16 a[126:127], v239 offset:60064
v_mfma_f32_16x16x32_bf16 v[192:195], a[12:15], a[156:159], v[192:195]
v_cvt_pk_bf16_f32 v214, v204, v205
v_cvt_pk_bf16_f32 v215, v206, v207
v_mfma_f32_16x16x32_bf16 v[196:199], a[80:83], a[128:131], 0
buffer_store_dwordx4 v[212:215], v243, s[40:43], s61 offen offset:0 sc1
v_mfma_f32_16x16x32_bf16 v[196:199], a[84:87], a[132:135], v[196:199]
v_mfma_f32_16x16x32_bf16 v[196:199], a[88:91], a[136:139], v[196:199]
v_mfma_f32_16x16x32_bf16 v[196:199], a[92:95], a[140:143], v[196:199]
v_mfma_f32_16x16x32_bf16 v[196:199], a[16:19], a[144:147], v[196:199]
v_mfma_f32_16x16x32_bf16 v[196:199], a[20:23], a[148:151], v[196:199]
v_mfma_f32_16x16x32_bf16 v[196:199], a[24:27], a[152:155], v[196:199]
s_waitcnt vmcnt(6)
v_cmp_gt_u32 vcc, 16, v222
s_cbranch_vccnz Lrdy_spin
Lrdy_back:
v_mfma_f32_16x16x32_bf16 v[196:199], a[28:31], a[156:159], v[196:199]
s_cmp_lg_u32 0, 0
Lisl10_0:
s_cbranch_scc1 Lisl10_1
s_waitcnt lgkmcnt(0)
s_lshl_b32 s63, s98, 5
v_cvt_pk_bf16_f32 v208, v192, v193
v_mfma_f32_16x16x32_bf16 v[200:203], a[32:35], v[0:3], 0
buffer_store_dword v221, v220, s[4:7], s63 offen offset:0 sc1
v_mfma_f32_16x16x32_bf16 v[200:203], a[36:39], v[4:7], v[200:203]
v_cvt_pk_bf16_f32 v209, v194, v195
s_add_u32 s61, s56, 32768
v_mfma_f32_16x16x32_bf16 v[200:203], a[40:43], v[8:11], v[200:203]
v_mfma_f32_16x16x32_bf16 v[200:203], a[44:47], v[12:15], v[200:203]
v_mfma_f32_16x16x32_bf16 v[200:203], a[96:99], v[16:19], v[200:203]
v_mfma_f32_16x16x32_bf16 v[200:203], a[100:103], v[20:23], v[200:203]
v_mfma_f32_16x16x32_bf16 v[200:203], a[104:107], v[24:27], v[200:203]
v_mfma_f32_16x16x32_bf16 v[200:203], a[108:111], v[28:31], v[200:203]
v_cvt_pk_bf16_f32 v210, v196, v197
v_cvt_pk_bf16_f32 v211, v198, v199
v_mfma_f32_16x16x32_bf16 v[204:207], a[48:51], v[0:3], 0
s_cmp_lg_u32 0, 0
Lisl10_1:
s_cbranch_scc1 Lret1
buffer_store_dwordx4 v[208:211], v243, s[40:43], s61 offen offset:0 sc1
v_mfma_f32_16x16x32_bf16 v[204:207], a[52:55], v[4:7], v[204:207]
v_mfma_f32_16x16x32_bf16 v[204:207], a[56:59], v[8:11], v[204:207]
v_mfma_f32_16x16x32_bf16 v[204:207], a[60:63], v[12:15], v[204:207]
v_mfma_f32_16x16x32_bf16 v[204:207], a[112:115], v[16:19], v[204:207]
v_mfma_f32_16x16x32_bf16 v[204:207], a[116:119], v[20:23], v[204:207]
v_mfma_f32_16x16x32_bf16 v[204:207], a[120:123], v[24:27], v[204:207]
v_mfma_f32_16x16x32_bf16 v[204:207], a[124:127], v[28:31], v[204:207]
v_cvt_pk_bf16_f32 v212, v200, v201
v_cvt_pk_bf16_f32 v213, v202, v203
v_mfma_f32_16x16x32_bf16 v[192:195], a[32:35], a[232:235], 0
s_lshl_b32 s63, s99, 5
buffer_store_dword v221, v220, s[4:7], s63 offen offset:0 sc1
v_mfma_f32_16x16x32_bf16 v[192:195], a[36:39], a[236:239], v[192:195]
s_mul_i32 s56, s101, 144
s_add_u32 s61, s56, 0
v_mfma_f32_16x16x32_bf16 v[192:195], a[40:43], a[240:243], v[192:195]
v_mfma_f32_16x16x32_bf16 v[192:195], a[44:47], a[244:247], v[192:195]
v_mfma_f32_16x16x32_bf16 v[192:195], a[96:99], a[248:251], v[192:195]
v_mfma_f32_16x16x32_bf16 v[192:195], a[100:103], a[252:255], v[192:195]
v_mfma_f32_16x16x32_bf16 v[192:195], a[104:107], a[192:195], v[192:195]
v_mfma_f32_16x16x32_bf16 v[192:195], a[108:111], a[196:199], v[192:195]
v_cvt_pk_bf16_f32 v214, v204, v205
v_cvt_pk_bf16_f32 v215, v206, v207
v_mfma_f32_16x16x32_bf16 v[196:199], a[48:51], a[232:235], 0
buffer_store_dwordx4 v[212:215], v232, s[40:43], s61 offen offset:0 sc1
v_mfma_f32_16x16x32_bf16 v[196:199], a[52:55], a[236:239], v[196:199]
ds_write_b128 v233, v[212:215] offset:0
v_mfma_f32_16x16x32_bf16 v[196:199], a[56:59], a[240:243], v[196:199]
v_mfma_f32_16x16x32_bf16 v[196:199], a[60:63], a[244:247], v[196:199]
v_mfma_f32_16x16x32_bf16 v[196:199], a[112:115], a[248:251], v[196:199]
v_mfma_f32_16x16x32_bf16 v[196:199], a[116:119], a[252:255], v[196:199]
v_mfma_f32_16x16x32_bf16 v[196:199], a[120:123], a[192:195], v[196:199]
v_mfma_f32_16x16x32_bf16 v[196:199], a[124:127], a[196:199], v[196:199]
v_cvt_pk_bf16_f32 v208, v192, v193
v_cvt_pk_bf16_f32 v209, v194, v195
v_mfma_f32_16x16x32_bf16 v[200:203], a[32:35], v[32:35], 0
s_add_u32 s61, s56, 16384
v_mfma_f32_16x16x32_bf16 v[200:203], a[36:39], v[36:39], v[200:203]
v_mfma_f32_16x16x32_bf16 v[200:203], a[40:43], v[40:43], v[200:203]
v_mfma_f32_16x16x32_bf16 v[200:203], a[44:47], v[44:47], v[200:203]
v_mfma_f32_16x16x32_bf16 v[200:203], a[96:99], v[48:51], v[200:203]
v_mfma_f32_16x16x32_bf16 v[200:203], a[100:103], v[52:55], v[200:203]
v_mfma_f32_16x16x32_bf16 v[200:203], a[104:107], v[56:59], v[200:203]
v_mfma_f32_16x16x32_bf16 v[200:203], a[108:111], v[60:63], v[200:203]
v_cvt_pk_bf16_f32 v210, v196, v197
v_cvt_pk_bf16_f32 v211, v198, v199
v_mfma_f32_16x16x32_bf16 v[204:207], a[48:51], v[32:35], 0
buffer_store_dwordx4 v[208:211], v232, s[40:43], s61 offen offset:0 sc1
v_mfma_f32_16x16x32_bf16 v[204:207], a[52:55], v[36:39], v[204:207]
ds_write_b128 v233, v[208:211] offset:4096
v_mfma_f32_16x16x32_bf16 v[204:207], a[56:59], v[40:43], v[204:207]
v_mfma_f32_16x16x32_bf16 v[204:207], a[60:63], v[44:47], v[204:207]
v_mfma_f32_16x16x32_bf16 v[204:207], a[112:115], v[48:51], v[204:207]
v_mfma_f32_16x16x32_bf16 v[204:207], a[116:119], v[52:55], v[204:207]
v_mfma_f32_16x16x32_bf16 v[204:207], a[120:123], v[56:59], v[204:207]
v_mfma_f32_16x16x32_bf16 v[204:207], a[124:127], v[60:63], v[204:207]
v_cvt_pk_bf16_f32 v212, v200, v201
v_cvt_pk_bf16_f32 v213, v202, v203
v_mfma_f32_16x16x32_bf16 v[192:195], a[32:35], a[200:203], 0
s_add_u32 s61, s56, 4096
v_mfma_f32_16x16x32_bf16 v[192:195], a[36:39], a[204:207], v[192:195]
v_mfma_f32_16x16x32_bf16 v[192:195], a[40:43], a[208:211], v[192:195]
v_mfma_f32_16x16x32_bf16 v[192:195], a[44:47], a[212:215], v[192:195]
v_mfma_f32_16x16x32_bf16 v[192:195], a[96:99], a[216:219], v[192:195]
v_mfma_f32_16x16x32_bf16 v[192:195], a[100:103], a[220:223], v[192:195]
v_mfma_f32_16x16x32_bf16 v[192:195], a[104:107], a[224:227], v[192:195]
v_mfma_f32_16x16x32_bf16 v[192:195], a[108:111], a[228:231], v[192:195]
v_cvt_pk_bf16_f32 v214, v204, v205
v_cvt_pk_bf16_f32 v215, v206, v207
v_mfma_f32_16x16x32_bf16 v[196:199], a[48:51], a[200:203], 0
buffer_store_dwordx4 v[212:215], v232, s[40:43], s61 offen offset:0 sc1
v_mfma_f32_16x16x32_bf16 v[196:199], a[52:55], a[204:207], v[196:199]
ds_write_b128 v233, v[212:215] offset:1024
v_mfma_f32_16x16x32_bf16 v[196:199], a[56:59], a[208:211], v[196:199]
v_mfma_f32_16x16x32_bf16 v[196:199], a[60:63], a[212:215], v[196:199]
v_mfma_f32_16x16x32_bf16 v[196:199], a[112:115], a[216:219], v[196:199]
v_mfma_f32_16x16x32_bf16 v[196:199], a[116:119], a[220:223], v[196:199]
v_mfma_f32_16x16x32_bf16 v[196:199], a[120:123], a[224:227], v[196:199]
v_mfma_f32_16x16x32_bf16 v[196:199], a[124:127], a[228:231], v[196:199]
v_cvt_pk_bf16_f32 v208, v192, v193
v_cvt_pk_bf16_f32 v209, v194, v195
v_mfma_f32_16x16x32_bf16 v[200:203], a[32:35], v[64:67], 0
s_add_u32 s61, s56, 20480
v_mfma_f32_16x16x32_bf16 v[200:203], a[36:39], v[68:71], v[200:203]
v_mfma_f32_16x16x32_bf16 v[200:203], a[40:43], v[72:75], v[200:203]
v_mfma_f32_16x16x32_bf16 v[200:203], a[44:47], v[76:79], v[200:203]
v_mfma_f32_16x16x32_bf16 v[200:203], a[96:99], v[80:83], v[200:203]
v_mfma_f32_16x16x32_bf16 v[200:203], a[100:103], v[84:87], v[200:203]
v_mfma_f32_16x16x32_bf16 v[200:203], a[104:107], v[88:91], v[200:203]
v_mfma_f32_16x16x32_bf16 v[200:203], a[108:111], v[92:95], v[200:203]
v_cvt_pk_bf16_f32 v210, v196, v197
v_cvt_pk_bf16_f32 v211, v198, v199
v_mfma_f32_16x16x32_bf16 v[204:207], a[48:51], v[64:67], 0
buffer_store_dwordx4 v[208:211], v232, s[40:43], s61 offen offset:0 sc1
v_mfma_f32_16x16x32_bf16 v[204:207], a[52:55], v[68:71], v[204:207]
ds_write_b128 v233, v[208:211] offset:5120
v_mfma_f32_16x16x32_bf16 v[204:207], a[56:59], v[72:75], v[204:207]
v_mfma_f32_16x16x32_bf16 v[204:207], a[60:63], v[76:79], v[204:207]
v_mfma_f32_16x16x32_bf16 v[204:207], a[112:115], v[80:83], v[204:207]
v_mfma_f32_16x16x32_bf16 v[204:207], a[116:119], v[84:87], v[204:207]
v_mfma_f32_16x16x32_bf16 v[204:207], a[120:123], v[88:91], v[204:207]
v_mfma_f32_16x16x32_bf16 v[204:207], a[124:127], v[92:95], v[204:207]
v_cvt_pk_bf16_f32 v212, v200, v201
v_cvt_pk_bf16_f32 v213, v202, v203
v_mfma_f32_16x16x32_bf16 v[192:195], a[32:35], v[128:131], 0
s_add_u32 s61, s56, 8192
v_mfma_f32_16x16x32_bf16 v[192:195], a[36:39], v[132:135], v[192:195]
v_mfma_f32_16x16x32_bf16 v[192:195], a[40:43], v[136:139], v[192:195]
v_mfma_f32_16x16x32_bf16 v[192:195], a[44:47], v[140:143], v[192:195]
v_mfma_f32_16x16x32_bf16 v[192:195], a[96:99], v[144:147], v[192:195]
v_mfma_f32_16x16x32_bf16 v[192:195], a[100:103], v[148:151], v[192:195]
v_mfma_f32_16x16x32_bf16 v[192:195], a[104:107], v[152:155], v[192:195]
v_mfma_f32_16x16x32_bf16 v[192:195], a[108:111], v[156:159], v[192:195]
v_cvt_pk_bf16_f32 v214, v204, v205
v_cvt_pk_bf16_f32 v215, v206, v207
v_mfma_f32_16x16x32_bf16 v[196:199], a[48:51], v[128:131], 0
buffer_store_dwordx4 v[212:215], v232, s[40:43], s61 offen offset:0 sc1
v_mfma_f32_16x16x32_bf16 v[196:199], a[52:55], v[132:135], v[196:199]
ds_write_b128 v233, v[212:215] offset:2048
v_mfma_f32_16x16x32_bf16 v[196:199], a[56:59], v[136:139], v[196:199]
v_mfma_f32_16x16x32_bf16 v[196:199], a[60:63], v[140:143], v[196:199]
v_mfma_f32_16x16x32_bf16 v[196:199], a[112:115], v[144:147], v[196:199]
v_mfma_f32_16x16x32_bf16 v[196:199], a[116:119], v[148:151], v[196:199]
v_mfma_f32_16x16x32_bf16 v[196:199], a[120:123], v[152:155], v[196:199]
v_mfma_f32_16x16x32_bf16 v[196:199], a[124:127], v[156:159], v[196:199]
v_cvt_pk_bf16_f32 v208, v192, v193
v_cvt_pk_bf16_f32 v209, v194, v195
v_mfma_f32_16x16x32_bf16 v[200:203], a[32:35], v[96:99], 0
s_add_u32 s61, s56, 24576
v_mfma_f32_16x16x32_bf16 v[200:203], a[36:39], v[100:103], v[200:203]
v_mfma_f32_16x16x32_bf16 v[200:203], a[40:43], v[104:107], v[200:203]
v_mfma_f32_16x16x32_bf16 v[200:203], a[44:47], v[108:111], v[200:203]
v_mfma_f32_16x16x32_bf16 v[200:203], a[96:99], v[112:115], v[200:203]
v_mfma_f32_16x16x32_bf16 v[200:203], a[100:103], v[116:119], v[200:203]
v_mfma_f32_16x16x32_bf16 v[200:203], a[104:107], v[120:123], v[200:203]
v_mfma_f32_16x16x32_bf16 v[200:203], a[108:111], v[124:127], v[200:203]
v_cvt_pk_bf16_f32 v210, v196, v197
v_cvt_pk_bf16_f32 v211, v198, v199
v_mfma_f32_16x16x32_bf16 v[204:207], a[48:51], v[96:99], 0
s_waitcnt vmcnt(6)
s_lshl_b32 s63, s100, 5
v_mfma_f32_16x16x32_bf16 v[204:207], a[52:55], v[100:103], v[204:207]
buffer_store_dword v221, v220, s[4:7], s63 offen offset:0 sc1
v_mfma_f32_16x16x32_bf16 v[204:207], a[56:59], v[104:107], v[204:207]
v_mfma_f32_16x16x32_bf16 v[204:207], a[60:63], v[108:111], v[204:207]
buffer_load_dword v222, v223, s[4:7], s97 offen offset:0 sc1
v_mfma_f32_16x16x32_bf16 v[204:207], a[112:115], v[112:115], v[204:207]
v_mfma_f32_16x16x32_bf16 v[204:207], a[116:119], v[116:119], v[204:207]
buffer_store_dwordx4 v[208:211], v232, s[40:43], s61 offen offset:0 sc1
v_mfma_f32_16x16x32_bf16 v[204:207], a[120:123], v[120:123], v[204:207]
ds_write_b128 v233, v[208:211] offset:6144
v_mfma_f32_16x16x32_bf16 v[204:207], a[124:127], v[124:127], v[204:207]
v_cvt_pk_bf16_f32 v212, v200, v201
v_cvt_pk_bf16_f32 v213, v202, v203
v_mfma_f32_16x16x32_bf16 v[192:195], a[32:35], a[160:163], 0
s_add_u32 s61, s56, 12288
v_mfma_f32_16x16x32_bf16 v[192:195], a[36:39], a[164:167], v[192:195]
v_mfma_f32_16x16x32_bf16 v[192:195], a[40:43], a[168:171], v[192:195]
v_mfma_f32_16x16x32_bf16 v[192:195], a[44:47], a[172:175], v[192:195]
v_mfma_f32_16x16x32_bf16 v[192:195], a[96:99], a[176:179], v[192:195]
v_mfma_f32_16x16x32_bf16 v[192:195], a[100:103], a[180:183], v[192:195]
v_mfma_f32_16x16x32_bf16 v[192:195], a[104:107], a[184:187], v[192:195]
v_mfma_f32_16x16x32_bf16 v[192:195], a[108:111], a[188:191], v[192:195]
v_cvt_pk_bf16_f32 v214, v204, v205
v_cvt_pk_bf16_f32 v215, v206, v207
v_mfma_f32_16x16x32_bf16 v[196:199], a[48:51], a[160:163], 0
buffer_store_dwordx4 v[212:215], v232, s[40:43], s61 offen offset:0 sc1
v_mfma_f32_16x16x32_bf16 v[196:199], a[52:55], a[164:167], v[196:199]
ds_write_b128 v233, v[212:215] offset:3072
v_mfma_f32_16x16x32_bf16 v[196:199], a[56:59], a[168:171], v[196:199]
v_mfma_f32_16x16x32_bf16 v[196:199], a[60:63], a[172:175], v[196:199]
v_mfma_f32_16x16x32_bf16 v[196:199], a[112:115], a[176:179], v[196:199]
v_mfma_f32_16x16x32_bf16 v[196:199], a[116:119], a[180:183], v[196:199]
v_mfma_f32_16x16x32_bf16 v[196:199], a[120:123], a[184:187], v[196:199]
v_mfma_f32_16x16x32_bf16 v[196:199], a[124:127], a[188:191], v[196:199]
v_cvt_pk_bf16_f32 v208, v192, v193
v_cvt_pk_bf16_f32 v209, v194, v195
v_mfma_f32_16x16x32_bf16 v[200:203], a[32:35], a[128:131], 0
s_add_u32 s61, s56, 28672
v_mfma_f32_16x16x32_bf16 v[200:203], a[36:39], a[132:135], v[200:203]
v_mfma_f32_16x16x32_bf16 v[200:203], a[40:43], a[136:139], v[200:203]
v_mfma_f32_16x16x32_bf16 v[200:203], a[44:47], a[140:143], v[200:203]
v_mfma_f32_16x16x32_bf16 v[200:203], a[96:99], a[144:147], v[200:203]
v_mfma_f32_16x16x32_bf16 v[200:203], a[100:103], a[148:151], v[200:203]
v_mfma_f32_16x16x32_bf16 v[200:203], a[104:107], a[152:155], v[200:203]
v_mfma_f32_16x16x32_bf16 v[200:203], a[108:111], a[156:159], v[200:203]
v_cvt_pk_bf16_f32 v210, v196, v197
v_cvt_pk_bf16_f32 v211, v198, v199
v_mfma_f32_16x16x32_bf16 v[204:207], a[48:51], a[128:131], 0
buffer_store_dwordx4 v[208:211], v232, s[40:43], s61 offen offset:0 sc1
v_mfma_f32_16x16x32_bf16 v[204:207], a[52:55], a[132:135], v[204:207]
ds_write_b128 v233, v[208:211] offset:7168
v_mfma_f32_16x16x32_bf16 v[204:207], a[56:59], a[136:139], v[204:207]
v_mfma_f32_16x16x32_bf16 v[204:207], a[60:63], a[140:143], v[204:207]
v_mfma_f32_16x16x32_bf16 v[204:207], a[112:115], a[144:147], v[204:207]
v_mfma_f32_16x16x32_bf16 v[204:207], a[116:119], a[148:151], v[204:207]
v_mfma_f32_16x16x32_bf16 v[204:207], a[120:123], a[152:155], v[204:207]
v_mfma_f32_16x16x32_bf16 v[204:207], a[124:127], a[156:159], v[204:207]
v_cvt_pk_bf16_f32 v212, v200, v201
v_cvt_pk_bf16_f32 v213, v202, v203
s_add_u32 s61, s56, 32768
s_nop 4
v_cvt_pk_bf16_f32 v214, v204, v205
v_cvt_pk_bf16_f32 v215, v206, v207
buffer_store_dwordx4 v[212:215], v232, s[40:43], s61 offen offset:0 sc1
ds_write_b128 v233, v[212:215] offset:8192
s_waitcnt vmcnt(4)
s_lshl_b32 s61, s101, 5
s_mov_b32 s63, 0
s_mul_i32 s45, s97, 1152
Lpoll0:
v_cmp_eq_u32 vcc, 0, v222
s_cbranch_vccz Lgo0
buffer_load_dword v222, v223, s[4:7], s97 offen sc1
s_add_u32 s63, s63, 1
s_waitcnt vmcnt(0)
s_cmp_lt_u32 s63, 0x40000
s_cbranch_scc1 Lpoll0
Lgo0:
s_sub_u32 s97, s97, 512
s_and_b32 s97, s97, 0x600
buffer_load_dwordx4 a[0:3], v224, s[8:11], s45 offen sc1
buffer_load_dwordx4 a[4:7], v225, s[8:11], s45 offen sc1
s_waitcnt vmcnt(5)
buffer_load_dwordx4 a[8:11], v226, s[8:11], s45 offen sc1
s_add_u32 s45, s45, 147456
s_waitcnt vmcnt(5)
buffer_load_dwordx4 a[12:15], v224, s[8:11], s45 offen sc1
s_waitcnt vmcnt(5)
buffer_load_dwordx4 a[16:19], v225, s[8:11], s45 offen sc1
s_waitcnt vmcnt(5)
buffer_load_dwordx4 a[20:23], v226, s[8:11], s45 offen sc1
buffer_store_dword v221, v220, s[4:7], s61 offen sc1
s_add_u32 s45, s45, 147456
buffer_load_dword v222, v223, s[4:7], s97 offen sc1
s_waitcnt vmcnt(5)
buffer_load_dwordx4 a[24:27], v224, s[8:11], s45 offen sc1
v_mfma_f32_16x16x32_bf16 v[0:3], v[160:163], a[0:3], 0
v_mfma_f32_16x16x32_bf16 v[4:7], v[164:167], a[0:3], 0
v_mfma_f32_16x16x32_bf16 v[8:11], v[160:163], a[4:7], 0
v_mfma_f32_16x16x32_bf16 v[12:15], v[164:167], a[4:7], 0
v_mfma_f32_16x16x32_bf16 v[16:19], v[160:163], a[8:11], 0
v_mfma_f32_16x16x32_bf16 v[20:23], v[164:167], a[8:11], 0
s_waitcnt vmcnt(5)
buffer_load_dwordx4 a[28:31], v225, s[8:11], s45 offen sc1
v_mfma_f32_16x16x32_bf16 v[0:3], v[160:163], a[12:15], v[0:3]
v_mfma_f32_16x16x32_bf16 v[4:7], v[164:167], a[12:15], v[4:7]
s_waitcnt vmcnt(5)
buffer_load_dwordx4 a[64:67], v226, s[8:11], s45 offen sc1
v_mfma_f32_16x16x32_bf16 v[8:11], v[160:163], a[16:19], v[8:11]
v_mfma_f32_16x16x32_bf16 v[12:15], v[164:167], a[16:19], v[12:15]
s_add_u32 s45, s45, 147456
s_waitcnt vmcnt(5)
buffer_load_dwordx4 a[68:71], v224, s[8:11], s45 offen sc1
v_mfma_f32_16x16x32_bf16 v[16:19], v[160:163], a[20:23], v[16:19]
v_mfma_f32_16x16x32_bf16 v[20:23], v[164:167], a[20:23], v[20:23]
s_waitcnt vmcnt(5)
buffer_load_dwordx4 a[72:75], v225, s[8:11], s45 offen sc1
s_waitcnt vmcnt(5)
buffer_load_dwordx4 a[76:79], v226, s[8:11], s45 offen sc1
s_mul_i32 s45, s97, 1152
Lpoll1:
v_cmp_eq_u32 vcc, 0, v222
s_cbranch_vccz Lgo1
buffer_load_dword v222, v223, s[4:7], s97 offen sc1
s_add_u32 s63, s63, 1
s_waitcnt vmcnt(0)
s_cmp_lt_u32 s63, 0x40000
s_cbranch_scc1 Lpoll1
Lgo1:
s_sub_u32 s97, s97, 512
s_and_b32 s97, s97, 0x600
s_waitcnt vmcnt(5)
buffer_load_dwordx4 a[80:83], v224, s[8:11], s45 offen sc1
v_mfma_f32_16x16x32_bf16 v[0:3], v[160:163], a[24:27], v[0:3]
v_mfma_f32_16x16x32_bf16 v[4:7], v[164:167], a[24:27], v[4:7]
s_waitcnt vmcnt(5)
buffer_load_dwordx4 a[84:87], v225, s[8:11], s45 offen sc1
v_mfma_f32_16x16x32_bf16 v[8:11], v[160:163], a[28:31], v[8:11]
v_mfma_f32_16x16x32_bf16 v[12:15], v[164:167], a[28:31], v[12:15]
s_waitcnt vmcnt(5)
buffer_load_dwordx4 a[88:91], v226, s[8:11], s45 offen sc1
v_mfma_f32_16x16x32_bf16 v[16:19], v[160:163], a[64:67], v[16:19]
v_mfma_f32_16x16x32_bf16 v[20:23], v[164:167], a[64:67], v[20:23]
s_add_u32 s45, s45, 147456
s_waitcnt vmcnt(5)
buffer_load_dwordx4 a[92:95], v224, s[8:11], s45 offen sc1
v_mfma_f32_16x16x32_bf16 v[0:3], v[160:163], a[68:71], v[0:3]
v_mfma_f32_16x16x32_bf16 v[4:7], v[164:167], a[68:71], v[4:7]
s_waitcnt vmcnt(5)
buffer_load_dwordx4 a[32:35], v225, s[8:11], s45 offen sc1
v_mfma_f32_16x16x32_bf16 v[8:11], v[160:163], a[72:75], v[8:11]
v_mfma_f32_16x16x32_bf16 v[12:15], v[164:167], a[72:75], v[12:15]
s_waitcnt vmcnt(5)
buffer_load_dwordx4 a[36:39], v226, s[8:11], s45 offen sc1
v_mfma_f32_16x16x32_bf16 v[16:19], v[160:163], a[76:79], v[16:19]
v_mfma_f32_16x16x32_bf16 v[20:23], v[164:167], a[76:79], v[20:23]
s_add_u32 s45, s45, 147456
s_waitcnt lgkmcnt(0)
s_barrier
ds_read_b128 a[180:183], v234 offset:0
ds_read_b128 a[184:187], v234 offset:4096
ds_read_b128 a[188:191], v234 offset:8192
buffer_load_dword v222, v223, s[4:7], s97 offen sc1
s_waitcnt vmcnt(5)
buffer_load_dwordx4 a[40:43], v224, s[8:11], s45 offen sc1
v_mfma_f32_16x16x32_bf16 v[0:3], v[160:163], a[80:83], v[0:3]
v_mfma_f32_16x16x32_bf16 v[4:7], v[164:167], a[80:83], v[4:7]
v_mfma_f32_16x16x32_bf16 v[8:11], v[160:163], a[84:87], v[8:11]
v_mfma_f32_16x16x32_bf16 v[12:15], v[164:167], a[84:87], v[12:15]
s_waitcnt vmcnt(5)
buffer_load_dwordx4 a[44:47], v225, s[8:11], s45 offen sc1
v_mfma_f32_16x16x32_bf16 v[16:19], v[160:163], a[88:91], v[16:19]
v_mfma_f32_16x16x32_bf16 v[20:23], v[164:167], a[88:91], v[20:23]
s_waitcnt vmcnt(5)
buffer_load_dwordx4 a[48:51], v226, s[8:11], s45 offen sc1
v_mfma_f32_16x16x32_bf16 v[0:3], v[160:163], a[92:95], v[0:3]
v_mfma_f32_16x16x32_bf16 v[4:7], v[164:167], a[92:95], v[4:7]
s_add_u32 s45, s45, 147456
s_waitcnt vmcnt(5)
buffer_load_dwordx4 a[52:55], v224, s[8:11], s45 offen sc1
v_mfma_f32_16x16x32_bf16 v[8:11], v[160:163], a[32:35], v[8:11]
v_mfma_f32_16x16x32_bf16 v[12:15], v[164:167], a[32:35], v[12:15]
s_waitcnt vmcnt(5)
buffer_load_dwordx4 a[56:59], v225, s[8:11], s45 offen sc1
v_mfma_f32_16x16x32_bf16 v[16:19], v[160:163], a[36:39], v[16:19]
v_mfma_f32_16x16x32_bf16 v[20:23], v[164:167], a[36:39], v[20:23]
s_waitcnt vmcnt(5)
buffer_load_dwordx4 a[60:63], v226, s[8:11], s45 offen sc1
s_waitcnt lgkmcnt(0)
v_mfma_f32_16x16x32_bf16 v[0:3], v[160:163], a[180:183], v[0:3]
v_mfma_f32_16x16x32_bf16 v[4:7], v[164:167], a[180:183], v[4:7]
v_mfma_f32_16x16x32_bf16 v[8:11], v[160:163], a[184:187], v[8:11]
v_mfma_f32_16x16x32_bf16 v[12:15], v[164:167], a[184:187], v[12:15]
v_mfma_f32_16x16x32_bf16 v[16:19], v[160:163], a[188:191], v[16:19]
v_mfma_f32_16x16x32_bf16 v[20:23], v[164:167], a[188:191], v[20:23]
s_mul_i32 s45, s97, 1152
Lpoll2:
v_cmp_eq_u32 vcc, 0, v222
s_cbranch_vccz Lgo2
buffer_load_dword v222, v223, s[4:7], s97 offen sc1
s_add_u32 s63, s63, 1
s_waitcnt vmcnt(0)
s_cmp_lt_u32 s63, 0x40000
s_cbranch_scc1 Lpoll2
Lgo2:
s_sub_u32 s97, s97, 512
s_and_b32 s97, s97, 0x600
s_waitcnt vmcnt(5)
buffer_load_dwordx4 a[96:99], v224, s[8:11], s45 offen sc1
v_mfma_f32_16x16x32_bf16 v[0:3], v[160:163], a[40:43], v[0:3]
v_mfma_f32_16x16x32_bf16 v[4:7], v[164:167], a[40:43], v[4:7]
s_waitcnt vmcnt(5)
buffer_load_dwordx4 a[100:103], v225, s[8:11], s45 offen sc1
v_mfma_f32_16x16x32_bf16 v[8:11], v[160:163], a[44:47], v[8:11]
v_mfma_f32_16x16x32_bf16 v[12:15], v[164:167], a[44:47], v[12:15]
s_waitcnt vmcnt(5)
buffer_load_dwordx4 a[104:107], v226, s[8:11], s45 offen sc1
v_mfma_f32_16x16x32_bf16 v[16:19], v[160:163], a[48:51], v[16:19]
v_mfma_f32_16x16x32_bf16 v[20:23], v[164:167], a[48:51], v[20:23]
s_add_u32 s45, s45, 147456
s_waitcnt vmcnt(5)
buffer_load_dwordx4 a[108:111], v224, s[8:11], s45 offen sc1
v_mfma_f32_16x16x32_bf16 v[0:3], v[160:163], a[52:55], v[0:3]
v_mfma_f32_16x16x32_bf16 v[4:7], v[164:167], a[52:55], v[4:7]
s_waitcnt vmcnt(5)
buffer_load_dwordx4 a[112:115], v225, s[8:11], s45 offen sc1
v_mfma_f32_16x16x32_bf16 v[8:11], v[160:163], a[56:59], v[8:11]
v_mfma_f32_16x16x32_bf16 v[12:15], v[164:167], a[56:59], v[12:15]
s_waitcnt vmcnt(5)
buffer_load_dwordx4 a[116:119], v226, s[8:11], s45 offen sc1
v_mfma_f32_16x16x32_bf16 v[16:19], v[160:163], a[60:63], v[16:19]
v_mfma_f32_16x16x32_bf16 v[20:23], v[164:167], a[60:63], v[20:23]
s_add_u32 s45, s45, 147456
buffer_load_dword v222, v223, s[4:7], s97 offen sc1
s_waitcnt vmcnt(5)
buffer_load_dwordx4 a[120:123], v224, s[8:11], s45 offen sc1
v_mfma_f32_16x16x32_bf16 v[0:3], v[160:163], a[96:99], v[0:3]
v_mfma_f32_16x16x32_bf16 v[4:7], v[164:167], a[96:99], v[4:7]
v_mfma_f32_16x16x32_bf16 v[8:11], v[160:163], a[100:103], v[8:11]
v_mfma_f32_16x16x32_bf16 v[12:15], v[164:167], a[100:103], v[12:15]
s_waitcnt vmcnt(5)
buffer_load_dwordx4 a[124:127], v225, s[8:11], s45 offen sc1
v_mfma_f32_16x16x32_bf16 v[16:19], v[160:163], a[104:107], v[16:19]
v_mfma_f32_16x16x32_bf16 v[20:23], v[164:167], a[104:107], v[20:23]
s_waitcnt vmcnt(5)
buffer_load_dwordx4 a[128:131], v226, s[8:11], s45 offen sc1
v_mfma_f32_16x16x32_bf16 v[0:3], v[160:163], a[108:111], v[0:3]
v_mfma_f32_16x16x32_bf16 v[4:7], v[164:167], a[108:111], v[4:7]
s_add_u32 s45, s45, 147456
s_waitcnt vmcnt(5)
buffer_load_dwordx4 a[132:135], v224, s[8:11], s45 offen sc1
v_mfma_f32_16x16x32_bf16 v[8:11], v[160:163], a[112:115], v[8:11]
v_mfma_f32_16x16x32_bf16 v[12:15], v[164:167], a[112:115], v[12:15]
s_waitcnt vmcnt(5)
buffer_load_dwordx4 a[136:139], v225, s[8:11], s45 offen sc1
v_mfma_f32_16x16x32_bf16 v[16:19], v[160:163], a[116:119], v[16:19]
v_mfma_f32_16x16x32_bf16 v[20:23], v[164:167], a[116:119], v[20:23]
s_waitcnt vmcnt(5)
buffer_load_dwordx4 a[140:143], v226, s[8:11], s45 offen sc1
s_mul_i32 s45, s97, 1152
s_mov_b32 s62, s45
Lpoll3:
v_cmp_eq_u32 vcc, 0, v222
s_cbranch_vccz Lgo3
buffer_load_dword v222, v223, s[4:7], s97 offen sc1
s_add_u32 s63, s63, 1
s_waitcnt vmcnt(0)
s_cmp_lt_u32 s63, 0x40000
s_cbranch_scc1 Lpoll3
Lgo3:
s_sub_u32 s97, s97, 512
s_and_b32 s97, s97, 0x600
s_add_u32 s52, s51, 1
s_and_b32 s52, s52, 3
s_mul_i32 s52, s52, 147456
s_add_u32 s45, s62, s52
s_waitcnt vmcnt(5)
buffer_load_dwordx4 a[144:147], v224, s[8:11], s45 offen sc1
v_mfma_f32_16x16x32_bf16 v[0:3], v[160:163], a[120:123], v[0:3]
v_mfma_f32_16x16x32_bf16 v[4:7], v[164:167], a[120:123], v[4:7]
s_waitcnt vmcnt(5)
buffer_load_dwordx4 a[148:151], v225, s[8:11], s45 offen sc1
v_mfma_f32_16x16x32_bf16 v[8:11], v[160:163], a[124:127], v[8:11]
v_mfma_f32_16x16x32_bf16 v[12:15], v[164:167], a[124:127], v[12:15]
s_waitcnt vmcnt(5)
buffer_load_dwordx4 a[152:155], v226, s[8:11], s45 offen sc1
v_mfma_f32_16x16x32_bf16 v[16:19], v[160:163], a[128:131], v[16:19]
v_mfma_f32_16x16x32_bf16 v[20:23], v[164:167], a[128:131], v[20:23]
s_add_u32 s52, s51, 2
s_and_b32 s52, s52, 3
s_mul_i32 s52, s52, 147456
s_add_u32 s45, s62, s52
s_waitcnt vmcnt(5)
buffer_load_dwordx4 a[156:159], v224, s[8:11], s45 offen sc1
v_mfma_f32_16x16x32_bf16 v[0:3], v[160:163], a[132:135], v[0:3]
v_mfma_f32_16x16x32_bf16 v[4:7], v[164:167], a[132:135], v[4:7]
s_waitcnt vmcnt(5)
buffer_load_dwordx4 a[160:163], v225, s[8:11], s45 offen sc1
v_mfma_f32_16x16x32_bf16 v[8:11], v[160:163], a[136:139], v[8:11]
v_mfma_f32_16x16x32_bf16 v[12:15], v[164:167], a[136:139], v[12:15]
s_waitcnt vmcnt(5)
buffer_load_dwordx4 a[164:167], v226, s[8:11], s45 offen sc1
v_mfma_f32_16x16x32_bf16 v[16:19], v[160:163], a[140:143], v[16:19]
v_mfma_f32_16x16x32_bf16 v[20:23], v[164:167], a[140:143], v[20:23]
s_add_u32 s52, s51, 3
s_and_b32 s52, s52, 3
s_mul_i32 s52, s52, 147456
s_add_u32 s45, s62, s52
s_waitcnt vmcnt(5)
buffer_load_dwordx4 a[168:171], v224, s[8:11], s45 offen sc1
v_mfma_f32_16x16x32_bf16 v[0:3], v[160:163], a[144:147], v[0:3]
v_mfma_f32_16x16x32_bf16 v[4:7], v[164:167], a[144:147], v[4:7]
s_waitcnt vmcnt(5)
buffer_load_dwordx4 a[172:175], v225, s[8:11], s45 offen sc1
v_mfma_f32_16x16x32_bf16 v[8:11], v[160:163], a[148:151], v[8:11]
v_mfma_f32_16x16x32_bf16 v[12:15], v[164:167], a[148:151], v[12:15]
s_waitcnt vmcnt(5)
buffer_load_dwordx4 a[176:179], v226, s[8:11], s45 offen sc1
v_mfma_f32_16x16x32_bf16 v[16:19], v[160:163], a[152:155], v[16:19]
v_mfma_f32_16x16x32_bf16 v[20:23], v[164:167], a[152:155], v[20:23]
s_waitcnt vmcnt(5)
v_mfma_f32_16x16x32_bf16 v[0:3], v[160:163], a[156:159], v[0:3]
v_mfma_f32_16x16x32_bf16 v[4:7], v[164:167], a[156:159], v[4:7]
s_waitcnt vmcnt(4)
v_mfma_f32_16x16x32_bf16 v[8:11], v[160:163], a[160:163], v[8:11]
v_mfma_f32_16x16x32_bf16 v[12:15], v[164:167], a[160:163], v[12:15]
s_waitcnt vmcnt(3)
v_mfma_f32_16x16x32_bf16 v[16:19], v[160:163], a[164:167], v[16:19]
v_mfma_f32_16x16x32_bf16 v[20:23], v[164:167], a[164:167], v[20:23]
s_waitcnt vmcnt(2)
v_mfma_f32_16x16x32_bf16 v[0:3], v[160:163], a[168:171], v[0:3]
v_mfma_f32_16x16x32_bf16 v[4:7], v[164:167], a[168:171], v[4:7]
s_waitcnt vmcnt(1)
v_mfma_f32_16x16x32_bf16 v[8:11], v[160:163], a[172:175], v[8:11]
v_mfma_f32_16x16x32_bf16 v[12:15], v[164:167], a[172:175], v[12:15]
s_waitcnt vmcnt(0)
v_mfma_f32_16x16x32_bf16 v[16:19], v[160:163], a[176:179], v[16:19]
v_mfma_f32_16x16x32_bf16 v[20:23], v[164:167], a[176:179], v[20:23]
s_nop 3
v_cvt_pk_bf16_f32 v32, v0, v1
v_cvt_pk_bf16_f32 v33, v2, v3
v_cvt_pk_bf16_f32 v34, v4, v5
v_cvt_pk_bf16_f32 v35, v6, v7
buffer_store_dwordx4 v[32:35], v228, s[12:15], 0 offen sc1
s_nop 1
v_cvt_pk_bf16_f32 v36, v8, v9
v_cvt_pk_bf16_f32 v37, v10, v11
v_cvt_pk_bf16_f32 v38, v12, v13
v_cvt_pk_bf16_f32 v39, v14, v15
buffer_store_dwordx4 v[36:39], v229, s[12:15], 0 offen sc1
s_nop 1
v_cvt_pk_bf16_f32 v40, v16, v17
v_cvt_pk_bf16_f32 v41, v18, v19
v_cvt_pk_bf16_f32 v42, v20, v21
v_cvt_pk_bf16_f32 v43, v22, v23
buffer_store_dwordx4 v[40:43], v230, s[12:15], 0 offen sc1
Lend:
s_endpgm
Lrdy_spin:
s_mov_b32 s63, 0
Lrdy_loop:
buffer_load_dword v222, v227, s[16:19], 0 offen sc1
s_add_u32 s63, s63, 1
s_waitcnt vmcnt(0)
v_cmp_gt_u32 vcc, 16, v222
s_cmp_lt_u32 s63, 0x40000
s_cselect_b64 vcc, vcc, 0
s_cbranch_vccnz Lrdy_loop
s_branch Lrdy_back
Lslow:
s_waitcnt vmcnt(0) lgkmcnt(0)
s_nop 7
s_barrier
v_mbcnt_lo_u32_b32 v0, -1, 0
v_mbcnt_hi_u32_b32 v0, -1, v0
v_and_b32 v1, 15, v0
v_lshlrev_b32 v1, 8, v1
v_lshrrev_b32 v2, 4, v0
v_lshl_add_u32 v1, v2, 4, v1
s_lshl_b32 s52, s48, 17
s_add_u32 s52, s52, 128
s_lshl_b32 s53, s49, 6
s_add_u32 s62, s52, s53
v_add_u32 v2, s62, v1
s_xor_b32 s53, s53, 64
s_add_u32 s62, s52, s53
v_add_u32 v3, s62, v1
v_mov_b32 v8, 0xff800000
v_mov_b32 v9, 0xff800000
v_mov_b32 v10, 0xff800000
v_mov_b32 v11, 0xff800000
v_mov_b32 v12, 0xff800000
s_mov_b32 s45, 0
Lslow_loop:
buffer_load_dwordx4 v[16:19], v2, s[28:31], s45 offen offset:0
buffer_load_dwordx4 v[20:23], v3, s[28:31], s45 offen offset:0
buffer_load_dwordx4 v[24:27], v2, s[28:31], s45 offen offset:128
buffer_load_dwordx4 v[28:31], v3, s[28:31], s45 offen offset:128
s_waitcnt vmcnt(0)
v_mfma_f32_16x16x32_bf16 v[216:219], v[16:19], v[128:131], 0
v_mfma_f32_16x16x32_bf16 v[216:219], v[20:23], v[132:135], v[216:219]
v_mfma_f32_16x16x32_bf16 v[216:219], v[24:27], v[136:139], v[216:219]
v_mfma_f32_16x16x32_bf16 v[216:219], v[28:31], v[140:143], v[216:219]
v_mfma_f32_16x16x32_bf16 v[220:223], v[16:19], v[144:147], 0
v_mfma_f32_16x16x32_bf16 v[220:223], v[20:23], v[148:151], v[220:223]
v_mfma_f32_16x16x32_bf16 v[220:223], v[24:27], v[152:155], v[220:223]
v_mfma_f32_16x16x32_bf16 v[220:223], v[28:31], v[156:159], v[220:223]
v_mfma_f32_16x16x32_bf16 v[224:227], v[16:19], v[160:163], 0
v_mfma_f32_16x16x32_bf16 v[224:227], v[20:23], v[164:167], v[224:227]
v_mfma_f32_16x16x32_bf16 v[224:227], v[24:27], v[168:171], v[224:227]
v_mfma_f32_16x16x32_bf16 v[224:227], v[28:31], v[172:175], v[224:227]
v_mfma_f32_16x16x32_bf16 v[228:231], v[16:19], v[176:179], 0
v_mfma_f32_16x16x32_bf16 v[228:231], v[20:23], v[180:183], v[228:231]
v_mfma_f32_16x16x32_bf16 v[228:231], v[24:27], v[184:187], v[228:231]
v_mfma_f32_16x16x32_bf16 v[228:231], v[28:31], v[188:191], v[228:231]
v_mfma_f32_16x16x32_bf16 v[232:235], v[16:19], a[180:183], 0
v_mfma_f32_16x16x32_bf16 v[232:235], v[20:23], a[184:187], v[232:235]
v_mfma_f32_16x16x32_bf16 v[232:235], v[24:27], a[188:191], v[232:235]
v_mfma_f32_16x16x32_bf16 v[232:235], v[28:31], a[192:195], v[232:235]
s_nop 7
s_nop 1
v_max3_f32 v8, v8, v216, v217
v_max3_f32 v8, v8, v218, v219
v_max3_f32 v9, v9, v220, v221
v_max3_f32 v9, v9, v222, v223
v_max3_f32 v10, v10, v224, v225
v_max3_f32 v10, v10, v226, v227
v_max3_f32 v11, v11, v228, v229
v_max3_f32 v11, v11, v230, v231
v_max3_f32 v12, v12, v232, v233
v_max3_f32 v12, v12, v234, v235
s_add_u32 s45, s45, 4096
s_cmp_lt_u32 s45, 131072
s_cbranch_scc1 Lslow_loop
v_accvgpr_write_b32 a248, v8
v_accvgpr_write_b32 a249, v9
v_accvgpr_write_b32 a250, v10
v_accvgpr_write_b32 a251, v11
v_accvgpr_write_b32 a252, v12
s_load_dwordx16 s[4:19], s[0:1], 0
s_mov_b32 s54, 1
s_branch Lrestart
Lcode_end:
.section .rodata,"a"
.p2align 6
.amdhsa_kernel standalone__mha_block_cached__near_ridge_kernel
  .amdhsa_next_free_vgpr 512
  .amdhsa_next_free_sgpr 102
  .amdhsa_accum_offset 256
  .amdhsa_group_segment_fixed_size 0
  .amdhsa_kernarg_size 64
  .amdhsa_user_sgpr_count 2
  .amdhsa_user_sgpr_kernarg_segment_ptr 1
  .amdhsa_system_sgpr_workgroup_id_x 1
  .amdhsa_float_denorm_mode_32 3
.end_amdhsa_kernel
```
